```python
import torch

def _softmax(x, axis=-1):
    return torch.softmax(x, dim=axis)
def _gelu(x):
    return torch.nn.functional.gelu(x, approximate="tanh")
def _silu(x):
    return torch.nn.functional.silu(x)
def _sigmoid(x):
    return torch.sigmoid(x)
def _layernorm(x, axis=-1, eps=1e-5):
    m = x.mean(dim=axis, keepdim=True)
    v = x.var(dim=axis, keepdim=True, unbiased=False)
    return (x - m) / torch.sqrt(v + eps)
def _scatter_add(tgt, idx, src, axis=0):
    return tgt.clone().index_add_(axis, idx, src)
def _segment_sum(src, seg, n):
    out = torch.zeros((n,) + src.shape[1:], dtype=src.dtype)
    return out.index_add_(0, seg, src)
def _pad(x, pw):
    flat = tuple(v for pair in reversed(pw) for v in pair)
    return torch.nn.functional.pad(x, flat)

kernel_name = 'standalone__gqa_block_cached__near_ridge'

def setup_inputs():

    _w = (lambda a: (lambda t: t.to(torch.bfloat16) if t.is_floating_point() else t)(torch.as_tensor(a)))
    B, Sq, D = 16, 144, 512
    Hq, Hkv, Sk, Dh = 32, 32, 1024, 128
    assert Hq % Hkv == 0, (Hq, Hkv)
    return {
        "x": _w((lambda *s: torch.randn(*s, dtype=torch.bfloat16) * 0.8)(B, Sq, D)),
        "k_cache": _w((lambda *s: torch.randn(*s, dtype=torch.bfloat16) * 0.8)(B, Hkv, Sk, Dh)),
        "v_cache": _w((lambda *s: torch.randn(*s, dtype=torch.bfloat16) * 0.05)(B, Hkv, Sk, Dh)),
        "wq": _w((lambda *s: torch.randn(*s, dtype=torch.bfloat16) * 0.8)(D, Hq * Dh) * (D ** -0.5)),
        "wo": _w((lambda *s: torch.randn(*s, dtype=torch.bfloat16) * 0.05)(Hq * Dh, D) * ((Hq * Dh) ** -0.5)),
    }

def reference(x, k_cache, v_cache, wq, wo):
    B, Sq, D = x.shape
    Hq, Dh = 32, 128
    Hkv = k_cache.shape[1]
    rep = Hq // Hkv
    q = (lambda x, *d: x.permute(*d))((x @ wq).reshape(B, Sq, Hq, Dh), 0, 2, 1, 3)
    k = (lambda x, n, axis: torch.repeat_interleave(x, n, dim=axis))(k_cache, rep, axis=1)
    v = (lambda x, n, axis: torch.repeat_interleave(x, n, dim=axis))(v_cache, rep, axis=1)
    scores = torch.einsum("bhqd,bhkd->bhqk", q, k) * (Dh ** -0.5)
    p = _softmax(scores, axis=-1)
    o = torch.einsum("bhqk,bhkd->bhqd", p, v)
    return (lambda x, *d: x.permute(*d))(o, 0, 2, 1, 3).reshape(B, Sq, Hq * Dh) @ wo
```

```asm
; @launch grid=(256,1,1) block=(256,1,1) lds=163840
.amdgcn_target "amdgcn-amd-amdhsa--gfx950"
.text
.globl standalone__gqa_block_cached__near_ridge_kernel
.p2align 8
.type standalone__gqa_block_cached__near_ridge_kernel,@function
standalone__gqa_block_cached__near_ridge_kernel:
    s_cmp_ge_u32 s2, 256
    s_cbranch_scc1 L_end
    s_load_dwordx16 s[4:19], s[0:1], 0
    s_getpc_b64 s[36:37]
    s_lshr_b32 s60, s2, 3
    s_and_b32 s36, s36, 0xffffff00
    s_and_b32 s37, s37, 0xffff
    s_mov_b32 s38, L_end-standalone__gqa_block_cached__near_ridge_kernel
    s_mov_b32 s39, 0x00020000
    s_mul_i32 s60, s60, 2304
    v_lshlrev_b32 v1, 7, v0
    v_cmp_gt_u32 vcc, 18, v0
    s_and_saveexec_b64 s[62:63], vcc
    s_cbranch_execz L_nopf
    buffer_load_dword v232, v1, s[36:39], s60 offen
L_nopf:
    s_mov_b64 exec, -1
    v_lshrrev_b32 v2, 6, v0
    v_and_b32 v1, 63, v0
    s_bfe_u32 s61, s2, 0x30003
    v_readfirstlane_b32 s3, v2
    s_and_b32 s60, s2, 1
    s_lshl_b32 s60, s60, 3
    s_add_u32 s78, s60, s61
    s_lshr_b32 s77, s2, 6
    s_bfe_u32 s76, s2, 0x20001
    s_lshl_b32 s61, s61, 1
    s_lshl_b32 s62, s77, 2
    s_add_u32 s71, s61, s62
    s_lshl_b32 s62, s76, 2
    s_add_u32 s62, s62, s77
    s_lshl_b32 s79, s78, 4
    s_add_u32 s79, s79, s62
    v_lshrrev_b32 v2, 4, v1
    v_bfe_u32 v3, v1, 2, 2
    v_and_b32 v4, 3, v1
    s_mov_b32 s75, 4194304
    v_lshrrev_b32 v30, 3, v1
    v_and_b32 v31, 7, v1
    v_xor_b32 v31, v31, v30
    v_lshlrev_b32 v31, 4, v31
    v_lshl_add_u32 v19, v30, 10, v31
    v_lshlrev_b32 v30, 13, v3
    v_lshl_add_u32 v30, v2, 6, v30
    v_xor_b32 v31, 2, v4
    v_lshl_add_u32 v31, v31, 4, v30
    v_lshl_add_u32 v30, v4, 4, v30
    s_mul_i32 s60, s78, 147456
    s_mul_i32 s61, s3, 49152
    s_add_u32 s60, s60, s61
    s_lshl_b32 s62, s62, 9
    s_mul_i32 s65, s3, 6144
    s_lshr_b32 s67, s71, 1
    s_cmp_ge_u32 s67, 7
    s_cselect_b32 s61, 6, -1
    s_sub_u32 s67, s67, s61
    s_add_u32 m0, s65, 92928
    s_mov_b32 s64, 7168
    s_mov_b32 s34, 49152
    s_mov_b32 s61, 32768
    s_cmp_eq_u32 s3, 3
    s_cselect_b64 vcc, -1, 0
    s_cselect_b32 s60, s62, s60
    s_cselect_b32 s64, 31744, s64
    s_cselect_b32 s34, 4186624, s34
    s_cselect_b32 s61, 131072, s61
    v_cndmask_b32 v20, v19, v31, vcc
    v_cndmask_b32 v19, v19, v30, vcc
    s_mov_b32 s35, 0x00020000
    v_add_u32 v20, s64, v20
    s_lshl_b32 s64, s64, 1
    v_add_u32 v21, s64, v19
    v_add_u32 v22, s64, v20
    s_cmp_eq_u32 s3, 3
    s_waitcnt lgkmcnt(0)
    s_cselect_b32 s32, s10, s4
    s_cselect_b32 s33, s11, s5
    s_add_u32 s32, s32, s60
    s_addc_u32 s33, s33, 0
    s_and_b32 s33, s33, 0xffff
    buffer_load_dwordx4 v19, s[32:35], 0 offen offset:0 lds
    buffer_load_dwordx4 v20, s[32:35], 0 offen offset:1024 lds
    buffer_load_dwordx4 v21, s[32:35], 0 offen offset:2048 lds
    buffer_load_dwordx4 v22, s[32:35], 0 offen offset:3072 lds
    s_add_u32 m0, s65, 97024
    s_cmp_lg_u32 s3, 3
    buffer_load_dwordx4 v19, s[32:35], s61 offen offset:0 lds
    buffer_load_dwordx4 v20, s[32:35], s61 offen offset:1024 lds
    s_cbranch_scc1 L_attn
    buffer_load_dwordx4 v21, s[32:35], s61 offen offset:2048 lds
    buffer_load_dwordx4 v22, s[32:35], s61 offen offset:3072 lds
    s_mov_b32 s63, 0
    s_mov_b32 m0, 119552
    s_add_u32 s64, s63, 262144
    buffer_load_dwordx4 v19, s[32:35], s64 offen offset:0 lds
    buffer_load_dwordx4 v20, s[32:35], s64 offen offset:1024 lds
    buffer_load_dwordx4 v21, s[32:35], s64 offen offset:2048 lds
    buffer_load_dwordx4 v22, s[32:35], s64 offen offset:3072 lds
    s_mov_b32 m0, 123648
    s_add_u32 s64, s63, 393216
    buffer_load_dwordx4 v19, s[32:35], s64 offen offset:0 lds
    buffer_load_dwordx4 v20, s[32:35], s64 offen offset:1024 lds
    buffer_load_dwordx4 v21, s[32:35], s64 offen offset:2048 lds
    buffer_load_dwordx4 v22, s[32:35], s64 offen offset:3072 lds
    s_lshl_b32 s63, s67, 19
    s_mov_b32 s101, 131072
    v_lshlrev_b32 v5, 4, v1
    v_mov_b32 v248, 0
    v_mov_b32 v249, 0
    v_mov_b32 v250, 0
    v_mov_b32 v251, 0
    v_add_u32 v30, 162816, v5
    v_lshlrev_b32 v6, 2, v1
    v_add_u32 v6, 162560, v6
    ds_write_b128 v30, v[248:251]
    ds_write_b32 v6, v248
    s_lshl_b32 s60, s79, 19
    s_add_u32 s24, s6, s60
    s_addc_u32 s25, s7, 0
    s_and_b32 s25, s25, 0xffff
    s_mov_b32 s26, 524288
    s_mov_b32 s27, 0x00020000
    s_add_u32 s28, s8, s60
    s_addc_u32 s29, s9, 0
    s_and_b32 s29, s29, 0xffff
    s_mov_b32 s30, 524288
    s_mov_b32 s31, 0x00020000
    v_lshlrev_b32 v30, 8, v3
    v_lshl_add_u32 v30, v2, 6, v30
    v_xor_b32 v31, 2, v4
    v_min_u32 v7, 2, v4
    v_lshl_add_u32 v3, v31, 4, v30
    v_lshl_add_u32 v2, v4, 4, v30
    v_lshlrev_b32 v7, 8, v7
    v_add_u32 v7, 162816, v7
    s_mov_b32 s65, 0
    s_mov_b32 s66, 0
    s_mov_b32 s67, 10
    s_mov_b32 s71, 0
    s_mul_i32 s60, s78, 147456
    s_add_u32 s20, s4, s60
    s_addc_u32 s21, s5, 0
    s_and_b32 s21, s21, 0xffff
    s_mov_b32 s22, 147456
    s_mov_b32 s23, 0x00020000
    v_lshrrev_b32 v30, 3, v1
    v_and_b32 v31, 7, v1
    v_xor_b32 v31, v31, v30
    v_lshlrev_b32 v31, 4, v31
    v_lshl_add_u32 v10, v30, 10, v31
    v_add_u32 v11, 7168, v10
    v_add_u32 v12, 14336, v10
    v_add_u32 v13, 21504, v10
    s_mov_b32 s80, 256
    s_mov_b32 s81, 64
    s_mov_b32 s82, 1048576
    s_mov_b32 s83, 262144
    s_add_u32 s52, s18, 41943040
    s_addc_u32 s53, s19, 0
    s_and_b32 s53, s53, 0xffff
    s_mov_b32 s54, 2105344
    s_mov_b32 s55, 0x00020000
    s_add_u32 s44, s18, 25165824
    s_addc_u32 s45, s19, 0
    s_and_b32 s45, s45, 0xffff
    s_mov_b32 s46, 12582912
    s_mov_b32 s47, 0x00020000
    s_lshl_b32 s60, s78, 2
    s_add_u32 s60, s60, s76
    s_mul_i32 s60, s60, 294912
    s_add_u32 s40, s18, s60
    s_addc_u32 s41, s19, 0
    s_and_b32 s41, s41, 0xffff
    s_mov_b32 s42, 299008
    s_mov_b32 s43, 0x00020000
    s_mul_i32 s60, s78, 147456
    s_lshl_b32 s61, s77, 8
    s_add_u32 s60, s60, s61
    s_add_u32 s48, s14, s60
    s_addc_u32 s49, s15, 0
    s_and_b32 s49, s49, 0xffff
    s_mov_b32 s50, 147456
    s_mov_b32 s51, 0x00020000
    s_sub_u32 s50, s50, s61
    s_mov_b32 s68, 0
    s_mov_b32 s70, 0
    s_mov_b32 s72, 0x3e0293ee
    v_lshrrev_b32 v30, 4, v1
    v_and_b32 v31, 7, v1
    v_xor_b32 v30, v30, v31
    v_lshlrev_b32 v30, 4, v30
    v_and_b32 v31, 15, v1
    v_lshl_add_u32 v30, v31, 7, v30
    v_xor_b32 v31, 64, v30
    v_add_u32 v25, 127744, v30
    v_add_u32 v14, 127744, v31
    v_lshrrev_b32 v30, 4, v1
    v_lshlrev_b32 v30, 11, v30
    v_bfe_u32 v31, v1, 2, 2
    v_lshl_add_u32 v30, v31, 6, v30
    v_add_u32 v30, 146176, v30
    v_and_b32 v31, 3, v1
    v_lshl_add_u32 v23, v31, 4, v30
    v_xor_b32 v31, 2, v31
    v_lshl_add_u32 v24, v31, 4, v30
    v_add_u32 v24, 1024, v24
    v_mov_b32 v26, s72
    v_mov_b32 v27, s72
    s_add_u32 m0, s66, 0
    s_add_u32 s60, s65, 0
    s_mov_b32 s100, 256
    s_mov_b32 s36, 0
    s_mov_b32 s37, 32768
    s_mov_b32 s38, 65536
    s_mov_b32 s39, 98304
    s_mov_b32 s74, 131072
    s_waitcnt lgkmcnt(0)
    s_barrier
    s_waitcnt vmcnt(8)
    v_mov_b32 v9, 1
    ds_write_b32 v6, v9
    s_mov_b32 m0, 146176
    s_add_u32 s64, s63, 0
    buffer_load_dwordx4 v19, s[32:35], s64 offen offset:0 lds
    buffer_load_dwordx4 v20, s[32:35], s64 offen offset:1024 lds
    buffer_load_dwordx4 v21, s[32:35], s64 offen offset:2048 lds
    buffer_load_dwordx4 v22, s[32:35], s64 offen offset:3072 lds
    s_mov_b32 m0, 150272
    s_add_u32 s64, s63, 131072
    buffer_load_dwordx4 v19, s[32:35], s64 offen offset:0 lds
    buffer_load_dwordx4 v20, s[32:35], s64 offen offset:1024 lds
    buffer_load_dwordx4 v21, s[32:35], s64 offen offset:2048 lds
    buffer_load_dwordx4 v22, s[32:35], s64 offen offset:3072 lds
    s_waitcnt vmcnt(8)
    v_mov_b32 v9, 2
    ds_write_b32 v6, v9
    s_mov_b32 m0, 154368
    s_add_u32 s64, s63, 262144
    buffer_load_dwordx4 v19, s[32:35], s64 offen offset:0 lds
    buffer_load_dwordx4 v20, s[32:35], s64 offen offset:1024 lds
    buffer_load_dwordx4 v21, s[32:35], s64 offen offset:2048 lds
    buffer_load_dwordx4 v22, s[32:35], s64 offen offset:3072 lds
    s_mov_b32 m0, 158464
    s_add_u32 s64, s63, 393216
    buffer_load_dwordx4 v19, s[32:35], s64 offen offset:0 lds
    buffer_load_dwordx4 v20, s[32:35], s64 offen offset:1024 lds
    buffer_load_dwordx4 v21, s[32:35], s64 offen offset:2048 lds
    buffer_load_dwordx4 v22, s[32:35], s64 offen offset:3072 lds
    s_add_u32 s63, s63, 524288
    s_cmp_eq_u32 s63, 4194304
    s_cselect_b32 s63, 524288, s63
    s_mov_b32 m0, 76544
    s_add_u32 s64, s63, 0
    buffer_load_dwordx4 v19, s[32:35], s64 offen offset:0 lds
    buffer_load_dwordx4 v20, s[32:35], s64 offen offset:1024 lds
    buffer_load_dwordx4 v21, s[32:35], s64 offen offset:2048 lds
    buffer_load_dwordx4 v22, s[32:35], s64 offen offset:3072 lds
    s_mov_b32 m0, 80640
    s_add_u32 s64, s63, 131072
    buffer_load_dwordx4 v19, s[32:35], s64 offen offset:0 lds
    buffer_load_dwordx4 v20, s[32:35], s64 offen offset:1024 lds
    buffer_load_dwordx4 v21, s[32:35], s64 offen offset:2048 lds
    buffer_load_dwordx4 v22, s[32:35], s64 offen offset:3072 lds
    s_mov_b32 m0, 84736
    s_add_u32 s64, s63, 262144
    buffer_load_dwordx4 v19, s[32:35], s64 offen offset:0 lds
    buffer_load_dwordx4 v20, s[32:35], s64 offen offset:1024 lds
    buffer_load_dwordx4 v21, s[32:35], s64 offen offset:2048 lds
    buffer_load_dwordx4 v22, s[32:35], s64 offen offset:3072 lds
    s_mov_b32 m0, 88832
    s_add_u32 s64, s63, 393216
    buffer_load_dwordx4 v19, s[32:35], s64 offen offset:0 lds
    buffer_load_dwordx4 v20, s[32:35], s64 offen offset:1024 lds
    buffer_load_dwordx4 v21, s[32:35], s64 offen offset:2048 lds
    buffer_load_dwordx4 v22, s[32:35], s64 offen offset:3072 lds
    s_waitcnt vmcnt(24)
    v_mov_b32 v9, 3
    ds_write_b32 v6, v9
    ds_read_b32 v8, v7
    s_waitcnt lgkmcnt(0)
    v_cmp_gt_u32 vcc, 1, v8
    s_cbranch_vccnz L_pc84
L_pc84r:
    s_add_u32 s63, s63, 524288
    s_cmp_eq_u32 s63, 4194304
    s_cselect_b32 s63, 524288, s63
    s_mov_b32 m0, 111360
    s_add_u32 s64, s63, 0
    buffer_load_dwordx4 v19, s[32:35], s64 offen offset:0 lds
    buffer_load_dwordx4 v20, s[32:35], s64 offen offset:1024 lds
    buffer_load_dwordx4 v21, s[32:35], s64 offen offset:2048 lds
    buffer_load_dwordx4 v22, s[32:35], s64 offen offset:3072 lds
    s_mov_b32 m0, 115456
    s_add_u32 s64, s63, 131072
    buffer_load_dwordx4 v19, s[32:35], s64 offen offset:0 lds
    buffer_load_dwordx4 v20, s[32:35], s64 offen offset:1024 lds
    buffer_load_dwordx4 v21, s[32:35], s64 offen offset:2048 lds
    buffer_load_dwordx4 v22, s[32:35], s64 offen offset:3072 lds
    s_waitcnt vmcnt(24)
    v_mov_b32 v9, 4
    ds_write_b32 v6, v9
    v_accvgpr_write_b32 a0, 0
    v_accvgpr_write_b32 a1, 0
    v_accvgpr_write_b32 a2, 0
    v_accvgpr_write_b32 a3, 0
    v_accvgpr_write_b32 a4, 0
    v_accvgpr_write_b32 a5, 0
    v_accvgpr_write_b32 a6, 0
    v_accvgpr_write_b32 a7, 0
    v_accvgpr_write_b32 a8, 0
    v_accvgpr_write_b32 a9, 0
    v_accvgpr_write_b32 a10, 0
    v_accvgpr_write_b32 a11, 0
    v_accvgpr_write_b32 a12, 0
    v_accvgpr_write_b32 a13, 0
    v_accvgpr_write_b32 a14, 0
    v_accvgpr_write_b32 a15, 0
    v_accvgpr_write_b32 a16, 0
    v_accvgpr_write_b32 a17, 0
    v_accvgpr_write_b32 a18, 0
    v_accvgpr_write_b32 a19, 0
    v_accvgpr_write_b32 a20, 0
    v_accvgpr_write_b32 a21, 0
    v_accvgpr_write_b32 a22, 0
    v_accvgpr_write_b32 a23, 0
    v_accvgpr_write_b32 a24, 0
    v_accvgpr_write_b32 a25, 0
    v_accvgpr_write_b32 a26, 0
    v_accvgpr_write_b32 a27, 0
    v_accvgpr_write_b32 a28, 0
    ds_read_b32 v8, v7
    s_waitcnt lgkmcnt(0)
    v_cmp_gt_u32 vcc, 2, v8
    s_cbranch_vccnz L_pc85
L_pc85r:
    s_mov_b32 m0, 119552
    s_add_u32 s64, s63, 262144
    buffer_load_dwordx4 v19, s[32:35], s64 offen offset:0 lds
    buffer_load_dwordx4 v20, s[32:35], s64 offen offset:1024 lds
    buffer_load_dwordx4 v21, s[32:35], s64 offen offset:2048 lds
    buffer_load_dwordx4 v22, s[32:35], s64 offen offset:3072 lds
    s_mov_b32 m0, 123648
    s_add_u32 s64, s63, 393216
    buffer_load_dwordx4 v19, s[32:35], s64 offen offset:0 lds
    buffer_load_dwordx4 v20, s[32:35], s64 offen offset:1024 lds
    buffer_load_dwordx4 v21, s[32:35], s64 offen offset:2048 lds
    buffer_load_dwordx4 v22, s[32:35], s64 offen offset:3072 lds
    s_waitcnt vmcnt(24)
    v_mov_b32 v9, 5
    ds_write_b32 v6, v9
    v_accvgpr_write_b32 a29, 0
    v_accvgpr_write_b32 a30, 0
    v_accvgpr_write_b32 a31, 0
    v_accvgpr_write_b32 a32, 0
    v_accvgpr_write_b32 a33, 0
    v_accvgpr_write_b32 a34, 0
    v_accvgpr_write_b32 a35, 0
    v_accvgpr_write_b32 a36, 0
    v_accvgpr_write_b32 a37, 0
    v_accvgpr_write_b32 a38, 0
    v_accvgpr_write_b32 a39, 0
    v_accvgpr_write_b32 a40, 0
    v_accvgpr_write_b32 a41, 0
    v_accvgpr_write_b32 a42, 0
    v_accvgpr_write_b32 a43, 0
    v_accvgpr_write_b32 a44, 0
    v_accvgpr_write_b32 a45, 0
    v_accvgpr_write_b32 a46, 0
    v_accvgpr_write_b32 a47, 0
    v_accvgpr_write_b32 a48, 0
    v_accvgpr_write_b32 a49, 0
    v_accvgpr_write_b32 a50, 0
    v_accvgpr_write_b32 a51, 0
    v_accvgpr_write_b32 a52, 0
    v_accvgpr_write_b32 a53, 0
    v_accvgpr_write_b32 a54, 0
    v_accvgpr_write_b32 a55, 0
    v_accvgpr_write_b32 a56, 0
    v_accvgpr_write_b32 a57, 0
    ds_read_b32 v8, v7
    s_waitcnt lgkmcnt(0)
    v_cmp_gt_u32 vcc, 3, v8
    s_cbranch_vccnz L_pc86
L_pc86r:
    s_add_u32 s63, s63, 524288
    s_cmp_eq_u32 s63, 4194304
    s_cselect_b32 s63, 524288, s63
    s_mov_b32 m0, 146176
    s_add_u32 s64, s63, 0
    buffer_load_dwordx4 v19, s[32:35], s64 offen offset:0 lds
    buffer_load_dwordx4 v20, s[32:35], s64 offen offset:1024 lds
    buffer_load_dwordx4 v21, s[32:35], s64 offen offset:2048 lds
    buffer_load_dwordx4 v22, s[32:35], s64 offen offset:3072 lds
    s_mov_b32 m0, 150272
    s_add_u32 s64, s63, 131072
    buffer_load_dwordx4 v19, s[32:35], s64 offen offset:0 lds
    buffer_load_dwordx4 v20, s[32:35], s64 offen offset:1024 lds
    buffer_load_dwordx4 v21, s[32:35], s64 offen offset:2048 lds
    buffer_load_dwordx4 v22, s[32:35], s64 offen offset:3072 lds
    s_waitcnt vmcnt(24)
    v_mov_b32 v9, 6
    ds_write_b32 v6, v9
    v_accvgpr_write_b32 a58, 0
    v_accvgpr_write_b32 a59, 0
    v_accvgpr_write_b32 a60, 0
    v_accvgpr_write_b32 a61, 0
    v_accvgpr_write_b32 a62, 0
    v_accvgpr_write_b32 a63, 0
    v_accvgpr_write_b32 a64, 0
    v_accvgpr_write_b32 a65, 0
    v_accvgpr_write_b32 a66, 0
    v_accvgpr_write_b32 a67, 0
    v_accvgpr_write_b32 a68, 0
    v_accvgpr_write_b32 a69, 0
    v_accvgpr_write_b32 a70, 0
    v_accvgpr_write_b32 a71, 0
    v_mov_b32 v32, 0
    v_mov_b32 v33, 0
    v_mov_b32 v34, 0
    v_mov_b32 v35, 0
    v_mov_b32 v36, 0
    v_mov_b32 v37, 0
    v_mov_b32 v38, 0
    v_mov_b32 v39, 0
    v_mov_b32 v40, 0
    v_mov_b32 v41, 0
    v_mov_b32 v42, 0
    v_mov_b32 v43, 0
    v_mov_b32 v44, 0
    v_mov_b32 v45, 0
    v_mov_b32 v46, 0
    ds_read_b32 v8, v7
    s_waitcnt lgkmcnt(0)
    v_cmp_gt_u32 vcc, 4, v8
    s_cbranch_vccnz L_pc87
L_pc87r:
    s_mov_b32 m0, 154368
    s_add_u32 s64, s63, 262144
    buffer_load_dwordx4 v19, s[32:35], s64 offen offset:0 lds
    buffer_load_dwordx4 v20, s[32:35], s64 offen offset:1024 lds
    buffer_load_dwordx4 v21, s[32:35], s64 offen offset:2048 lds
    buffer_load_dwordx4 v22, s[32:35], s64 offen offset:3072 lds
    s_mov_b32 m0, 158464
    s_add_u32 s64, s63, 393216
    buffer_load_dwordx4 v19, s[32:35], s64 offen offset:0 lds
    buffer_load_dwordx4 v20, s[32:35], s64 offen offset:1024 lds
    buffer_load_dwordx4 v21, s[32:35], s64 offen offset:2048 lds
    buffer_load_dwordx4 v22, s[32:35], s64 offen offset:3072 lds
    s_waitcnt vmcnt(24)
    v_mov_b32 v9, 7
    ds_write_b32 v6, v9
    v_mov_b32 v47, 0
    v_mov_b32 v48, 0
    v_mov_b32 v49, 0
    v_mov_b32 v50, 0
    v_mov_b32 v51, 0
    v_mov_b32 v52, 0
    v_mov_b32 v53, 0
    v_mov_b32 v54, 0
    v_mov_b32 v55, 0
    v_mov_b32 v56, 0
    v_mov_b32 v57, 0
    v_mov_b32 v58, 0
    v_mov_b32 v59, 0
    v_mov_b32 v60, 0
    v_mov_b32 v61, 0
    v_mov_b32 v62, 0
    v_mov_b32 v63, 0
    v_mov_b32 v64, 0
    v_mov_b32 v65, 0
    v_mov_b32 v66, 0
    v_mov_b32 v67, 0
    v_mov_b32 v68, 0
    v_mov_b32 v69, 0
    v_mov_b32 v70, 0
    v_mov_b32 v71, 0
    v_mov_b32 v72, 0
    v_mov_b32 v73, 0
    v_mov_b32 v74, 0
    v_mov_b32 v75, 0
    ds_read_b32 v8, v7
    s_waitcnt lgkmcnt(0)
    v_cmp_gt_u32 vcc, 5, v8
    s_cbranch_vccnz L_pc88
L_pc88r:
    s_add_u32 s63, s63, 524288
    s_cmp_eq_u32 s63, 4194304
    s_cselect_b32 s63, 524288, s63
    s_mov_b32 m0, 76544
    s_add_u32 s64, s63, 0
    buffer_load_dwordx4 v19, s[32:35], s64 offen offset:0 lds
    buffer_load_dwordx4 v20, s[32:35], s64 offen offset:1024 lds
    buffer_load_dwordx4 v21, s[32:35], s64 offen offset:2048 lds
    buffer_load_dwordx4 v22, s[32:35], s64 offen offset:3072 lds
    s_mov_b32 m0, 80640
    s_add_u32 s64, s63, 131072
    buffer_load_dwordx4 v19, s[32:35], s64 offen offset:0 lds
    buffer_load_dwordx4 v20, s[32:35], s64 offen offset:1024 lds
    buffer_load_dwordx4 v21, s[32:35], s64 offen offset:2048 lds
    buffer_load_dwordx4 v22, s[32:35], s64 offen offset:3072 lds
    s_waitcnt vmcnt(24)
    v_mov_b32 v9, 8
    ds_write_b32 v6, v9
    v_mov_b32 v76, 0
    v_mov_b32 v77, 0
    v_mov_b32 v78, 0
    v_mov_b32 v79, 0
    v_mov_b32 v80, 0
    v_mov_b32 v81, 0
    v_mov_b32 v82, 0
    v_mov_b32 v83, 0
    v_mov_b32 v84, 0
    v_mov_b32 v85, 0
    v_mov_b32 v86, 0
    v_mov_b32 v87, 0
    v_mov_b32 v88, 0
    v_mov_b32 v89, 0
    v_mov_b32 v90, 0
    v_mov_b32 v91, 0
    v_mov_b32 v92, 0
    v_mov_b32 v93, 0
    v_mov_b32 v94, 0
    v_mov_b32 v95, 0
    v_mov_b32 v96, 0
    v_mov_b32 v97, 0
    v_mov_b32 v98, 0
    v_mov_b32 v99, 0
    v_mov_b32 v100, 0
    v_mov_b32 v101, 0
    v_mov_b32 v102, 0
    v_mov_b32 v103, 0
    v_mov_b32 v104, 0
    ds_read_b32 v8, v7
    s_waitcnt lgkmcnt(0)
    v_cmp_gt_u32 vcc, 6, v8
    s_cbranch_vccnz L_pc89
L_pc89r:
    s_mov_b32 m0, 84736
    s_add_u32 s64, s63, 262144
    buffer_load_dwordx4 v19, s[32:35], s64 offen offset:0 lds
    buffer_load_dwordx4 v20, s[32:35], s64 offen offset:1024 lds
    buffer_load_dwordx4 v21, s[32:35], s64 offen offset:2048 lds
    buffer_load_dwordx4 v22, s[32:35], s64 offen offset:3072 lds
    s_mov_b32 m0, 88832
    s_add_u32 s64, s63, 393216
    buffer_load_dwordx4 v19, s[32:35], s64 offen offset:0 lds
    buffer_load_dwordx4 v20, s[32:35], s64 offen offset:1024 lds
    buffer_load_dwordx4 v21, s[32:35], s64 offen offset:2048 lds
    buffer_load_dwordx4 v22, s[32:35], s64 offen offset:3072 lds
    s_waitcnt vmcnt(24)
    v_mov_b32 v9, 9
    ds_write_b32 v6, v9
    v_mov_b32 v105, 0
    v_mov_b32 v106, 0
    v_mov_b32 v107, 0
    v_mov_b32 v108, 0
    v_mov_b32 v109, 0
    v_mov_b32 v110, 0
    v_mov_b32 v111, 0
    v_mov_b32 v112, 0
    v_mov_b32 v113, 0
    v_mov_b32 v114, 0
    v_mov_b32 v115, 0
    v_mov_b32 v116, 0
    v_mov_b32 v117, 0
    v_mov_b32 v118, 0
    v_mov_b32 v119, 0
    v_mov_b32 v120, 0
    v_mov_b32 v121, 0
    v_mov_b32 v122, 0
    v_mov_b32 v123, 0
    v_mov_b32 v124, 0
    v_mov_b32 v125, 0
    v_mov_b32 v126, 0
    v_mov_b32 v127, 0
    v_mov_b32 v128, 0
    v_mov_b32 v129, 0
    v_mov_b32 v130, 0
    v_mov_b32 v131, 0
    v_mov_b32 v132, 0
    v_mov_b32 v133, 0
    ds_read_b32 v8, v7
    s_waitcnt lgkmcnt(0)
    v_cmp_gt_u32 vcc, 7, v8
    s_cbranch_vccnz L_pc90
L_pc90r:
    s_add_u32 s63, s63, 524288
    s_cmp_eq_u32 s63, 4194304
    s_cselect_b32 s63, 524288, s63
    s_mov_b32 m0, 111360
    s_add_u32 s64, s63, 0
    buffer_load_dwordx4 v19, s[32:35], s64 offen offset:0 lds
    buffer_load_dwordx4 v20, s[32:35], s64 offen offset:1024 lds
    buffer_load_dwordx4 v21, s[32:35], s64 offen offset:2048 lds
    buffer_load_dwordx4 v22, s[32:35], s64 offen offset:3072 lds
    s_mov_b32 m0, 115456
    s_add_u32 s64, s63, 131072
    buffer_load_dwordx4 v19, s[32:35], s64 offen offset:0 lds
    buffer_load_dwordx4 v20, s[32:35], s64 offen offset:1024 lds
    buffer_load_dwordx4 v21, s[32:35], s64 offen offset:2048 lds
    buffer_load_dwordx4 v22, s[32:35], s64 offen offset:3072 lds
    s_waitcnt vmcnt(24)
    v_mov_b32 v9, 10
    ds_write_b32 v6, v9
    v_mov_b32 v134, 0
    v_mov_b32 v135, 0
    v_mov_b32 v136, 0
    v_mov_b32 v137, 0
    v_mov_b32 v138, 0
    v_mov_b32 v139, 0
    v_mov_b32 v140, 0
    v_mov_b32 v141, 0
    v_mov_b32 v142, 0
    v_mov_b32 v143, 0
    v_mov_b32 v144, 0
    v_mov_b32 v145, 0
    v_mov_b32 v146, 0
    v_mov_b32 v147, 0
    v_mov_b32 v148, 0
    v_mov_b32 v149, 0
    v_mov_b32 v150, 0
    v_mov_b32 v151, 0
    v_mov_b32 v152, 0
    v_mov_b32 v153, 0
    v_mov_b32 v154, 0
    v_mov_b32 v155, 0
    v_mov_b32 v156, 0
    v_mov_b32 v157, 0
    v_mov_b32 v158, 0
    v_mov_b32 v159, 0
    v_mov_b32 v160, 0
    v_mov_b32 v161, 0
    v_mov_b32 v162, 0
    ds_read_b32 v8, v7
    s_waitcnt lgkmcnt(0)
    v_cmp_gt_u32 vcc, 8, v8
    s_cbranch_vccnz L_pc91
L_pc91r:
    s_mov_b32 m0, 119552
    s_add_u32 s64, s63, 262144
    buffer_load_dwordx4 v19, s[32:35], s64 offen offset:0 lds
    buffer_load_dwordx4 v20, s[32:35], s64 offen offset:1024 lds
    buffer_load_dwordx4 v21, s[32:35], s64 offen offset:2048 lds
    buffer_load_dwordx4 v22, s[32:35], s64 offen offset:3072 lds
    s_mov_b32 m0, 123648
    s_add_u32 s64, s63, 393216
    buffer_load_dwordx4 v19, s[32:35], s64 offen offset:0 lds
    buffer_load_dwordx4 v20, s[32:35], s64 offen offset:1024 lds
    buffer_load_dwordx4 v21, s[32:35], s64 offen offset:2048 lds
    buffer_load_dwordx4 v22, s[32:35], s64 offen offset:3072 lds
    s_waitcnt vmcnt(24)
    v_mov_b32 v9, 11
    ds_write_b32 v6, v9
    v_mov_b32 v163, 0
    v_mov_b32 v164, 0
    v_mov_b32 v165, 0
    v_mov_b32 v166, 0
    v_mov_b32 v167, 0
    v_mov_b32 v168, 0
    v_mov_b32 v169, 0
    v_mov_b32 v170, 0
    v_mov_b32 v171, 0
    v_mov_b32 v172, 0
    v_mov_b32 v173, 0
    v_mov_b32 v174, 0
    v_mov_b32 v175, 0
    v_mov_b32 v176, 0
    v_mov_b32 v177, 0
    v_mov_b32 v178, 0
    v_mov_b32 v179, 0
    v_mov_b32 v180, 0
    v_mov_b32 v181, 0
    v_mov_b32 v182, 0
    v_mov_b32 v183, 0
    v_mov_b32 v184, 0
    v_mov_b32 v185, 0
    v_mov_b32 v186, 0
    v_mov_b32 v187, 0
    v_mov_b32 v188, 0
    v_mov_b32 v189, 0
    v_mov_b32 v190, 0
    v_mov_b32 v191, 0
    ds_read_b32 v8, v7
    s_waitcnt lgkmcnt(0)
    v_cmp_gt_u32 vcc, 9, v8
    s_cbranch_vccnz L_pc92
L_pc92r:
    s_add_u32 s63, s63, 524288
    s_cmp_eq_u32 s63, 4194304
    s_cselect_b32 s63, 524288, s63
    s_mov_b32 m0, 146176
    s_add_u32 s64, s63, 0
    buffer_load_dwordx4 v19, s[32:35], s64 offen offset:0 lds
    buffer_load_dwordx4 v20, s[32:35], s64 offen offset:1024 lds
    buffer_load_dwordx4 v21, s[32:35], s64 offen offset:2048 lds
    buffer_load_dwordx4 v22, s[32:35], s64 offen offset:3072 lds
    s_mov_b32 m0, 150272
    s_add_u32 s64, s63, 131072
    buffer_load_dwordx4 v19, s[32:35], s64 offen offset:0 lds
    buffer_load_dwordx4 v20, s[32:35], s64 offen offset:1024 lds
    buffer_load_dwordx4 v21, s[32:35], s64 offen offset:2048 lds
    buffer_load_dwordx4 v22, s[32:35], s64 offen offset:3072 lds
    s_waitcnt vmcnt(24)
    v_mov_b32 v9, 12
    ds_write_b32 v6, v9
    v_mov_b32 v192, 0
    v_mov_b32 v193, 0
    v_mov_b32 v194, 0
    v_mov_b32 v195, 0
    v_mov_b32 v196, 0
    v_mov_b32 v197, 0
    v_mov_b32 v198, 0
    v_mov_b32 v199, 0
    v_mov_b32 v200, 0
    v_mov_b32 v201, 0
    v_mov_b32 v202, 0
    v_mov_b32 v203, 0
    v_mov_b32 v204, 0
    v_mov_b32 v205, 0
    v_mov_b32 v206, 0
    v_mov_b32 v207, 0
    v_mov_b32 v208, 0
    v_mov_b32 v209, 0
    v_mov_b32 v210, 0
    v_mov_b32 v211, 0
    v_mov_b32 v212, 0
    v_mov_b32 v213, 0
    v_mov_b32 v214, 0
    v_mov_b32 v215, 0
    v_mov_b32 v216, 0
    v_mov_b32 v217, 0
    v_mov_b32 v218, 0
    v_mov_b32 v219, 0
    v_mov_b32 v220, 0
    ds_read_b32 v8, v7
    s_waitcnt lgkmcnt(0)
    v_cmp_gt_u32 vcc, 10, v8
    s_cbranch_vccnz L_pc93
L_pc93r:
    s_mov_b32 m0, 154368
    s_add_u32 s64, s63, 262144
    buffer_load_dwordx4 v19, s[32:35], s64 offen offset:0 lds
    buffer_load_dwordx4 v20, s[32:35], s64 offen offset:1024 lds
    buffer_load_dwordx4 v21, s[32:35], s64 offen offset:2048 lds
    buffer_load_dwordx4 v22, s[32:35], s64 offen offset:3072 lds
    s_mov_b32 m0, 158464
    s_add_u32 s64, s63, 393216
    buffer_load_dwordx4 v19, s[32:35], s64 offen offset:0 lds
    buffer_load_dwordx4 v20, s[32:35], s64 offen offset:1024 lds
    buffer_load_dwordx4 v21, s[32:35], s64 offen offset:2048 lds
    buffer_load_dwordx4 v22, s[32:35], s64 offen offset:3072 lds
    s_waitcnt vmcnt(24)
    v_mov_b32 v9, 13
    ds_write_b32 v6, v9
    v_mov_b32 v221, 0
    v_mov_b32 v222, 0
    v_mov_b32 v223, 0
    v_mov_b32 v224, 0
    v_mov_b32 v225, 0
    v_mov_b32 v226, 0
    v_mov_b32 v227, 0
    v_mov_b32 v228, 0
    v_mov_b32 v229, 0
    v_mov_b32 v230, 0
    v_mov_b32 v231, 0
    v_mov_b32 v232, 0
    v_mov_b32 v233, 0
    v_mov_b32 v234, 0
    v_mov_b32 v235, 0
    v_mov_b32 v236, 0
    v_mov_b32 v237, 0
    v_mov_b32 v238, 0
    v_mov_b32 v239, 0
    v_mov_b32 v240, 0
    v_mov_b32 v241, 0
    v_mov_b32 v242, 0
    v_mov_b32 v243, 0
    v_mov_b32 v244, 0
    v_mov_b32 v245, 0
    v_mov_b32 v246, 0
    v_mov_b32 v247, 0
    s_waitcnt vmcnt(16)
    v_mov_b32 v9, 14
    ds_write_b32 v6, v9
    s_add_u32 m0, s66, 0
    s_nop 0
    buffer_load_dwordx4 v2, s[24:27], s60 offen offset:0 nt lds
    buffer_load_dwordx4 v3, s[24:27], s60 offen offset:1024 nt lds
    buffer_load_dwordx4 v2, s[24:27], s60 offen offset:2048 nt lds
    buffer_load_dwordx4 v3, s[24:27], s60 offen offset:3072 nt lds
    s_add_u32 s60, s65, 4096
    s_add_u32 m0, s66, 4096
    s_nop 0
    s_waitcnt vmcnt(12)
    v_mov_b32 v9, 15
    ds_write_b32 v6, v9
    buffer_load_dwordx4 v2, s[24:27], s60 offen offset:0 nt lds
    buffer_load_dwordx4 v3, s[24:27], s60 offen offset:1024 nt lds
    buffer_load_dwordx4 v2, s[24:27], s60 offen offset:2048 nt lds
    buffer_load_dwordx4 v3, s[24:27], s60 offen offset:3072 nt lds
    s_sub_u32 s60, s65, 8192
    s_add_u32 m0, s66, 8192
    s_nop 0
    s_waitcnt vmcnt(8)
    v_mov_b32 v9, 16
    ds_write_b32 v6, v9
    buffer_load_dwordx4 v2, s[28:31], s60 offen offset:0 nt lds
    buffer_load_dwordx4 v3, s[28:31], s60 offen offset:1024 nt lds
    buffer_load_dwordx4 v2, s[28:31], s60 offen offset:2048 nt lds
    buffer_load_dwordx4 v3, s[28:31], s60 offen offset:3072 nt lds
    s_sub_u32 s60, s65, 4096
    s_add_u32 m0, s66, 12288
    s_nop 0
    buffer_load_dwordx4 v2, s[28:31], s60 offen offset:0 nt lds
    s_add_u32 s65, s65, 8192
    buffer_load_dwordx4 v3, s[28:31], s60 offen offset:1024 nt lds
    s_add_u32 s67, s67, 1
    buffer_load_dwordx4 v2, s[28:31], s60 offen offset:2048 nt lds
    s_add_u32 s66, s66, 16384
    buffer_load_dwordx4 v3, s[28:31], s60 offen offset:3072 nt lds
    s_cmp_eq_u32 s66, 114688
    s_cselect_b32 s66, 0, s66
    s_add_u32 s60, s65, 0
    s_add_u32 m0, s66, 0
    s_nop 0
    buffer_load_dwordx4 v2, s[24:27], s60 offen offset:0 nt lds
    buffer_load_dwordx4 v3, s[24:27], s60 offen offset:1024 nt lds
    buffer_load_dwordx4 v2, s[24:27], s60 offen offset:2048 nt lds
    buffer_load_dwordx4 v3, s[24:27], s60 offen offset:3072 nt lds
    s_add_u32 s60, s65, 4096
    s_add_u32 m0, s66, 4096
    s_waitcnt vmcnt(16)
    buffer_load_dwordx4 v2, s[24:27], s60 offen offset:0 nt lds
    buffer_load_dwordx4 v3, s[24:27], s60 offen offset:1024 nt lds
    buffer_load_dwordx4 v2, s[24:27], s60 offen offset:2048 nt lds
    buffer_load_dwordx4 v3, s[24:27], s60 offen offset:3072 nt lds
    s_sub_u32 s60, s65, 8192
    s_add_u32 m0, s66, 8192
    s_waitcnt vmcnt(16)
    buffer_load_dwordx4 v2, s[28:31], s60 offen offset:0 nt lds
    buffer_load_dwordx4 v3, s[28:31], s60 offen offset:1024 nt lds
    buffer_load_dwordx4 v2, s[28:31], s60 offen offset:2048 nt lds
    buffer_load_dwordx4 v3, s[28:31], s60 offen offset:3072 nt lds
    s_sub_u32 s60, s65, 4096
    s_add_u32 m0, s66, 12288
    s_waitcnt vmcnt(16)
    buffer_load_dwordx4 v2, s[28:31], s60 offen offset:0 nt lds
    s_add_u32 s65, s65, 8192
    buffer_load_dwordx4 v3, s[28:31], s60 offen offset:1024 nt lds
    s_add_u32 s67, s67, 1
    buffer_load_dwordx4 v2, s[28:31], s60 offen offset:2048 nt lds
    s_add_u32 s66, s66, 16384
    buffer_load_dwordx4 v3, s[28:31], s60 offen offset:3072 nt lds
    s_cmp_eq_u32 s66, 114688
    s_cselect_b32 s66, 0, s66
    s_add_u32 s60, s65, 0
    s_add_u32 m0, s66, 0
    s_waitcnt vmcnt(16)
    v_mov_b32 v9, 17
    ds_write_b32 v6, v9
    buffer_load_dwordx4 v2, s[24:27], s60 offen offset:0 nt lds
    buffer_load_dwordx4 v3, s[24:27], s60 offen offset:1024 nt lds
    buffer_load_dwordx4 v2, s[24:27], s60 offen offset:2048 nt lds
    buffer_load_dwordx4 v3, s[24:27], s60 offen offset:3072 nt lds
    s_add_u32 s60, s65, 4096
    s_add_u32 m0, s66, 4096
    s_waitcnt vmcnt(16)
    buffer_load_dwordx4 v2, s[24:27], s60 offen offset:0 nt lds
    buffer_load_dwordx4 v3, s[24:27], s60 offen offset:1024 nt lds
    buffer_load_dwordx4 v2, s[24:27], s60 offen offset:2048 nt lds
    buffer_load_dwordx4 v3, s[24:27], s60 offen offset:3072 nt lds
    s_sub_u32 s60, s65, 8192
    s_add_u32 m0, s66, 8192
    s_waitcnt vmcnt(16)
    buffer_load_dwordx4 v2, s[28:31], s60 offen offset:0 nt lds
    buffer_load_dwordx4 v3, s[28:31], s60 offen offset:1024 nt lds
    buffer_load_dwordx4 v2, s[28:31], s60 offen offset:2048 nt lds
    buffer_load_dwordx4 v3, s[28:31], s60 offen offset:3072 nt lds
    s_sub_u32 s60, s65, 4096
    s_add_u32 m0, s66, 12288
    s_waitcnt vmcnt(16)
    buffer_load_dwordx4 v2, s[28:31], s60 offen offset:0 nt lds
    s_add_u32 s65, s65, 8192
    buffer_load_dwordx4 v3, s[28:31], s60 offen offset:1024 nt lds
    s_add_u32 s67, s67, 1
    buffer_load_dwordx4 v2, s[28:31], s60 offen offset:2048 nt lds
    s_add_u32 s66, s66, 16384
    buffer_load_dwordx4 v3, s[28:31], s60 offen offset:3072 nt lds
    s_cmp_eq_u32 s66, 114688
    s_cselect_b32 s66, 0, s66
    s_add_u32 s60, s65, 0
    ds_read_b32 v8, v7
    s_add_u32 m0, s66, 0
    s_waitcnt vmcnt(16)
    v_mov_b32 v9, 18
    ds_write_b32 v6, v9
    s_waitcnt lgkmcnt(0)
    v_cmp_gt_u32 vcc, 12, v8
    s_cbranch_vccnz L_pc94
L_pc94r:
    buffer_load_dwordx4 v2, s[24:27], s60 offen offset:0 nt lds
    buffer_load_dwordx4 v3, s[24:27], s60 offen offset:1024 nt lds
    buffer_load_dwordx4 v2, s[24:27], s60 offen offset:2048 nt lds
    buffer_load_dwordx4 v3, s[24:27], s60 offen offset:3072 nt lds
    s_add_u32 s60, s65, 4096
    s_add_u32 m0, s66, 4096
    s_waitcnt vmcnt(16)
    buffer_load_dwordx4 v2, s[24:27], s60 offen offset:0 nt lds
    buffer_load_dwordx4 v3, s[24:27], s60 offen offset:1024 nt lds
    buffer_load_dwordx4 v2, s[24:27], s60 offen offset:2048 nt lds
    buffer_load_dwordx4 v3, s[24:27], s60 offen offset:3072 nt lds
    s_sub_u32 s60, s65, 8192
    s_add_u32 m0, s66, 8192
    s_waitcnt vmcnt(16)
    buffer_load_dwordx4 v2, s[28:31], s60 offen offset:0 nt lds
    buffer_load_dwordx4 v3, s[28:31], s60 offen offset:1024 nt lds
    buffer_load_dwordx4 v2, s[28:31], s60 offen offset:2048 nt lds
    buffer_load_dwordx4 v3, s[28:31], s60 offen offset:3072 nt lds
    s_sub_u32 s60, s65, 4096
    s_add_u32 m0, s66, 12288
    s_waitcnt vmcnt(16)
    buffer_load_dwordx4 v2, s[28:31], s60 offen offset:0 nt lds
    s_add_u32 s65, s65, 8192
    buffer_load_dwordx4 v3, s[28:31], s60 offen offset:1024 nt lds
    s_add_u32 s67, s67, 1
    buffer_load_dwordx4 v2, s[28:31], s60 offen offset:2048 nt lds
    s_add_u32 s66, s66, 16384
    buffer_load_dwordx4 v3, s[28:31], s60 offen offset:3072 nt lds
    s_cmp_eq_u32 s66, 114688
    s_cselect_b32 s66, 0, s66
    s_add_u32 s60, s65, 0
    s_add_u32 m0, s66, 0
    s_waitcnt vmcnt(16)
    v_mov_b32 v9, 19
    ds_write_b32 v6, v9
    buffer_load_dwordx4 v2, s[24:27], s60 offen offset:0 nt lds
    buffer_load_dwordx4 v3, s[24:27], s60 offen offset:1024 nt lds
    buffer_load_dwordx4 v2, s[24:27], s60 offen offset:2048 nt lds
    buffer_load_dwordx4 v3, s[24:27], s60 offen offset:3072 nt lds
    s_add_u32 s60, s65, 4096
    s_add_u32 m0, s66, 4096
    s_waitcnt vmcnt(16)
    buffer_load_dwordx4 v2, s[24:27], s60 offen offset:0 nt lds
    buffer_load_dwordx4 v3, s[24:27], s60 offen offset:1024 nt lds
    buffer_load_dwordx4 v2, s[24:27], s60 offen offset:2048 nt lds
    buffer_load_dwordx4 v3, s[24:27], s60 offen offset:3072 nt lds
    s_sub_u32 s60, s65, 8192
    s_add_u32 m0, s66, 8192
    s_waitcnt vmcnt(16)
    buffer_load_dwordx4 v2, s[28:31], s60 offen offset:0 nt lds
    buffer_load_dwordx4 v3, s[28:31], s60 offen offset:1024 nt lds
    buffer_load_dwordx4 v2, s[28:31], s60 offen offset:2048 nt lds
    buffer_load_dwordx4 v3, s[28:31], s60 offen offset:3072 nt lds
    s_sub_u32 s60, s65, 4096
    s_add_u32 m0, s66, 12288
    s_waitcnt vmcnt(16)
    buffer_load_dwordx4 v2, s[28:31], s60 offen offset:0 nt lds
    s_add_u32 s65, s65, 8192
    buffer_load_dwordx4 v3, s[28:31], s60 offen offset:1024 nt lds
    s_add_u32 s67, s67, 1
    buffer_load_dwordx4 v2, s[28:31], s60 offen offset:2048 nt lds
    s_add_u32 s66, s66, 16384
    buffer_load_dwordx4 v3, s[28:31], s60 offen offset:3072 nt lds
    s_cmp_eq_u32 s66, 114688
    s_cselect_b32 s66, 0, s66
    s_add_u32 s60, s65, 0
    s_add_u32 m0, s66, 0
    s_waitcnt vmcnt(16)
    v_mov_b32 v9, 20
    ds_write_b32 v6, v9
    ds_read_b32 v8, v7
    s_mov_b32 s7, 20
    s_mov_b32 s6, 4096
    s_mov_b32 s8, 16
    s_waitcnt lgkmcnt(0)
    v_cmp_gt_u32 vcc, 16, v8
    s_cbranch_vccnz L_pc95
L_pc95r:
    s_mov_b32 s73, 0
    s_add_u32 s64, s71, s73
    s_bfe_u32 s63, s64, 0x20002
    s_and_b32 s64, s64, 3
    s_mul_i32 s56, s63, s80
    s_mul_i32 s61, s64, s81
    s_add_u32 s56, s56, s61
    s_mul_i32 s58, s63, s82
    s_mul_i32 s61, s64, s83
    s_add_u32 s58, s58, s61
    s_add_u32 s58, s58, s100
    s_add_u32 s73, s73, 1
    s_mov_b32 m0, 127744
    s_add_u32 s57, s56, s36
    buffer_load_dwordx4 v10, s[20:23], s57 offen offset:0 lds
    buffer_load_dwordx4 v11, s[20:23], s57 offen offset:1024 lds
    buffer_load_dwordx4 v12, s[20:23], s57 offen offset:2048 lds
    buffer_load_dwordx4 v13, s[20:23], s57 offen offset:3072 lds
    s_mov_b32 m0, 131840
    s_add_u32 s57, s56, s37
    buffer_load_dwordx4 v10, s[20:23], s57 offen offset:0 lds
    buffer_load_dwordx4 v11, s[20:23], s57 offen offset:1024 lds
    buffer_load_dwordx4 v12, s[20:23], s57 offen offset:2048 lds
    buffer_load_dwordx4 v13, s[20:23], s57 offen offset:3072 lds
    s_add_u32 m0, s66, 0
    s_waitcnt lgkmcnt(0)
    s_add_u32 s57, s56, s38
    buffer_load_dwordx4 v2, s[24:27], s60 offen offset:0 nt lds
    buffer_load_dwordx4 v3, s[24:27], s60 offen offset:1024 nt lds
    s_add_u32 s64, s71, s73
    buffer_load_dwordx4 v2, s[24:27], s60 offen offset:2048 nt lds
    s_bfe_u32 s63, s64, 0x20002
    buffer_load_dwordx4 v3, s[24:27], s60 offen offset:3072 nt lds
    s_mov_b32 m0, 135936
    s_nop 0
    buffer_load_dwordx4 v10, s[20:23], s57 offen offset:0 lds
    s_and_b32 s64, s64, 3
    buffer_load_dwordx4 v11, s[20:23], s57 offen offset:1024 lds
    s_mul_i32 s59, s63, s82
    buffer_load_dwordx4 v12, s[20:23], s57 offen offset:2048 lds
    s_add_u32 s60, s65, 4096
    buffer_load_dwordx4 v13, s[20:23], s57 offen offset:3072 lds
    s_mul_i32 s61, s64, s83
    s_add_u32 m0, s66, 4096
    s_add_u32 s59, s59, s61
    s_waitcnt vmcnt(28)
    s_add_u32 s59, s59, s100
    s_add_u32 s73, s73, 1
    s_add_u32 s57, s56, s39
    buffer_load_dwordx4 v2, s[24:27], s60 offen offset:0 nt lds
    buffer_load_dwordx4 v3, s[24:27], s60 offen offset:1024 nt lds
    buffer_load_dwordx4 v2, s[24:27], s60 offen offset:2048 nt lds
    buffer_load_dwordx4 v3, s[24:27], s60 offen offset:3072 nt lds
    s_mov_b32 m0, 140032
    s_nop 0
    buffer_load_dwordx4 v10, s[20:23], s57 offen offset:0 lds
    buffer_load_dwordx4 v11, s[20:23], s57 offen offset:1024 lds
    buffer_load_dwordx4 v12, s[20:23], s57 offen offset:2048 lds
    s_sub_u32 s60, s65, 8192
    buffer_load_dwordx4 v13, s[20:23], s57 offen offset:3072 lds
    s_add_u32 m0, s66, 8192
    s_waitcnt vmcnt(32)
    buffer_load_dwordx4 v2, s[28:31], s60 offen offset:0 nt lds
    buffer_load_dwordx4 v3, s[28:31], s60 offen offset:1024 nt lds
    buffer_load_dwordx4 v2, s[28:31], s60 offen offset:2048 nt lds
    buffer_load_dwordx4 v3, s[28:31], s60 offen offset:3072 nt lds
    s_mov_b32 m0, 146176
    s_nop 0
    buffer_load_dwordx4 v19, s[32:35], s58 offen offset:0 lds
    buffer_load_dwordx4 v20, s[32:35], s58 offen offset:1024 lds
    buffer_load_dwordx4 v21, s[32:35], s58 offen offset:2048 lds
    s_sub_u32 s60, s65, 4096
    buffer_load_dwordx4 v22, s[32:35], s58 offen offset:3072 lds
    s_add_u32 m0, s66, 12288
    s_waitcnt vmcnt(36)
    s_add_u32 s57, s56, s74
    buffer_load_dwordx4 v2, s[28:31], s60 offen offset:0 nt lds
    s_add_u32 s65, s65, 8192
    v_readfirstlane_b32 s9, v8
    buffer_load_dwordx4 v3, s[28:31], s60 offen offset:1024 nt lds
    s_add_u32 s67, s67, 1
    s_add_u32 s7, s7, 1
    buffer_load_dwordx4 v2, s[28:31], s60 offen offset:2048 nt lds
    s_add_u32 s66, s66, 16384
    s_lshl4_add_u32 s9, s9, 32
    buffer_load_dwordx4 v3, s[28:31], s60 offen offset:3072 nt lds
    s_mov_b32 m0, 144128
    s_nop 0
    buffer_load_dwordx4 v10, s[20:23], s57 offen offset:0 lds
    s_min_u32 s6, s6, s9
    buffer_load_dwordx4 v11, s[20:23], s57 offen offset:1024 lds
    s_cmp_eq_u32 s66, 114688
    s_cselect_b32 s66, 0, s66
    s_add_u32 s6, s6, s8
    s_add_u32 s60, s65, 0
    s_lshr_b32 s9, s6, 4
    s_min_u32 s9, s9, s7
    ds_read_b32 v8, v7
    s_add_u32 m0, s66, 0
    s_waitcnt vmcnt(38)
    v_mov_b32 v9, s9
    ds_write_b32 v6, v9
    s_waitcnt lgkmcnt(0)
    v_cmp_gt_u32 vcc, s67, v8
    s_cbranch_vccnz L_pc96
L_pc96r:
    s_add_u32 s64, s58, s101
    buffer_load_dwordx4 v2, s[24:27], s60 offen offset:0 nt lds
    buffer_load_dwordx4 v3, s[24:27], s60 offen offset:1024 nt lds
    buffer_load_dwordx4 v2, s[24:27], s60 offen offset:2048 nt lds
    buffer_load_dwordx4 v3, s[24:27], s60 offen offset:3072 nt lds
    s_mov_b32 m0, 150272
    s_nop 0
    buffer_load_dwordx4 v19, s[32:35], s64 offen offset:0 lds
    buffer_load_dwordx4 v20, s[32:35], s64 offen offset:1024 lds
    buffer_load_dwordx4 v21, s[32:35], s64 offen offset:2048 lds
    s_add_u32 s60, s65, 4096
    buffer_load_dwordx4 v22, s[32:35], s64 offen offset:3072 lds
    s_add_u32 m0, s66, 4096
    s_waitcnt vmcnt(34)
    buffer_load_dwordx4 v2, s[24:27], s60 offen offset:0 nt lds
    buffer_load_dwordx4 v3, s[24:27], s60 offen offset:1024 nt lds
    buffer_load_dwordx4 v2, s[24:27], s60 offen offset:2048 nt lds
    buffer_load_dwordx4 v3, s[24:27], s60 offen offset:3072 nt lds
    s_sub_u32 s60, s65, 8192
    s_add_u32 m0, s66, 8192
    s_waitcnt vmcnt(30)
    s_waitcnt lgkmcnt(0)
    buffer_load_dwordx4 v2, s[28:31], s60 offen offset:0 nt lds
    s_add_u32 s64, s71, s73
    buffer_load_dwordx4 v3, s[28:31], s60 offen offset:1024 nt lds
    s_bfe_u32 s63, s64, 0x20002
    buffer_load_dwordx4 v2, s[28:31], s60 offen offset:2048 nt lds
    s_and_b32 s64, s64, 3
    buffer_load_dwordx4 v3, s[28:31], s60 offen offset:3072 nt lds
    s_mov_b32 m0, 154368
    s_nop 0
    buffer_load_dwordx4 v19, s[32:35], s59 offen offset:0 lds
    s_mul_i32 s56, s63, s80
    buffer_load_dwordx4 v20, s[32:35], s59 offen offset:1024 lds
    s_mul_i32 s61, s64, s81
    buffer_load_dwordx4 v21, s[32:35], s59 offen offset:2048 lds
    s_sub_u32 s60, s65, 4096
    buffer_load_dwordx4 v22, s[32:35], s59 offen offset:3072 lds
    s_add_u32 s56, s56, s61
    s_add_u32 m0, s66, 12288
    s_mul_i32 s58, s63, s82
    s_waitcnt vmcnt(30)
    s_mul_i32 s61, s64, s83
    s_add_u32 s58, s58, s61
    s_add_u32 s58, s58, s100
    s_add_u32 s73, s73, 1
    buffer_load_dwordx4 v2, s[28:31], s60 offen offset:0 nt lds
    s_add_u32 s65, s65, 8192
    v_readfirstlane_b32 s9, v8
    buffer_load_dwordx4 v3, s[28:31], s60 offen offset:1024 nt lds
    s_add_u32 s67, s67, 1
    s_add_u32 s7, s7, 1
    buffer_load_dwordx4 v2, s[28:31], s60 offen offset:2048 nt lds
    s_add_u32 s66, s66, 16384
    s_lshl4_add_u32 s9, s9, 32
    buffer_load_dwordx4 v3, s[28:31], s60 offen offset:3072 nt lds
    s_min_u32 s6, s6, s9
    s_cmp_eq_u32 s66, 114688
    s_cselect_b32 s66, 0, s66
    s_add_u32 s6, s6, s8
    s_add_u32 s60, s65, 0
    s_lshr_b32 s9, s6, 4
    s_min_u32 s9, s9, s7
    ds_read_b32 v8, v7
    s_add_u32 m0, s66, 0
    s_waitcnt vmcnt(26)
    v_mov_b32 v9, s9
    ds_write_b32 v6, v9
    s_waitcnt lgkmcnt(0)
    v_cmp_gt_u32 vcc, s67, v8
    s_cbranch_vccnz L_pc97
L_pc97r:
    s_add_u32 s64, s59, s101
    s_waitcnt vmcnt(46)
    buffer_load_dwordx4 v2, s[24:27], s60 offen offset:0 nt lds
    buffer_load_dwordx4 v3, s[24:27], s60 offen offset:1024 nt lds
    ds_read_b128 a[104:107], v25 offset:0
    buffer_load_dwordx4 v2, s[24:27], s60 offen offset:2048 nt lds
    ds_read_b128 a[208:211], v14 offset:0
    buffer_load_dwordx4 v3, s[24:27], s60 offen offset:3072 nt lds
    s_mov_b32 m0, 158464
    s_nop 0
    buffer_load_dwordx4 v19, s[32:35], s64 offen offset:0 lds
    ds_read_b128 a[108:111], v25 offset:2048
    buffer_load_dwordx4 v20, s[32:35], s64 offen offset:1024 lds
    ds_read_b128 a[212:215], v14 offset:2048
    buffer_load_dwordx4 v21, s[32:35], s64 offen offset:2048 lds
    s_add_u32 s60, s65, 4096
    buffer_load_dwordx4 v22, s[32:35], s64 offen offset:3072 lds
    ds_read_b128 a[112:115], v25 offset:4096
    ds_read_b128 a[216:219], v14 offset:4096
    s_add_u32 m0, s66, 4096
    s_waitcnt vmcnt(28)
    ds_read_b128 a[116:119], v25 offset:6144
    ds_read_b128 a[220:223], v14 offset:6144
    ds_read_b128 a[120:123], v25 offset:8192
    ds_read_b128 a[224:227], v14 offset:8192
    ds_read_b128 a[124:127], v25 offset:10240
    s_waitcnt vmcnt(32)
    buffer_load_dwordx4 v2, s[24:27], s60 offen offset:0 nt lds
    buffer_load_dwordx4 v3, s[24:27], s60 offen offset:1024 nt lds
    ds_read_b128 a[228:231], v14 offset:10240
    buffer_load_dwordx4 v2, s[24:27], s60 offen offset:2048 nt lds
    ds_read_b128 a[128:131], v25 offset:12288
    buffer_load_dwordx4 v3, s[24:27], s60 offen offset:3072 nt lds
    ds_read_b128 a[232:235], v14 offset:12288
    ds_read_b128 a[132:135], v25 offset:14336
    ds_read_b128 a[236:239], v14 offset:14336
    ds_read_b128 a[136:139], v25 offset:16384
    ds_read_b128 a[240:243], v14 offset:16384
    s_sub_u32 s60, s65, 8192
    s_add_u32 m0, s66, 8192
    s_waitcnt vmcnt(24)
    s_waitcnt lgkmcnt(0)
    s_add_u32 s57, s56, s36
    s_waitcnt vmcnt(28)
    buffer_load_dwordx4 v2, s[28:31], s60 offen offset:0 nt lds
    buffer_load_dwordx4 v3, s[28:31], s60 offen offset:1024 nt lds
    ds_read_b64_tr_b16 a[72:73], v23 offset:0
    buffer_load_dwordx4 v2, s[28:31], s60 offen offset:2048 nt lds
    ds_read_b64_tr_b16 a[74:75], v24 offset:0
    buffer_load_dwordx4 v3, s[28:31], s60 offen offset:3072 nt lds
    s_mov_b32 m0, 127744
    s_nop 0
    buffer_load_dwordx4 v10, s[20:23], s57 offen offset:0 lds
    ds_read_b64_tr_b16 a[76:77], v23 offset:8
    buffer_load_dwordx4 v11, s[20:23], s57 offen offset:1024 lds
    ds_read_b64_tr_b16 a[78:79], v24 offset:8
    buffer_load_dwordx4 v12, s[20:23], s57 offen offset:2048 lds
    s_sub_u32 s60, s65, 4096
    buffer_load_dwordx4 v13, s[20:23], s57 offen offset:3072 lds
    ds_read_b64_tr_b16 a[80:81], v23 offset:256
    ds_read_b64_tr_b16 a[82:83], v24 offset:256
    s_add_u32 m0, s66, 12288
    s_waitcnt vmcnt(28)
    ds_read_b64_tr_b16 a[84:85], v23 offset:264
    ds_read_b64_tr_b16 a[86:87], v24 offset:264
    ds_read_b64_tr_b16 a[88:89], v23 offset:512
    ds_read_b64_tr_b16 a[90:91], v24 offset:512
    ds_read_b64_tr_b16 a[92:93], v23 offset:520
    s_add_u32 s57, s56, s37
    buffer_load_dwordx4 v2, s[28:31], s60 offen offset:0 nt lds
    s_add_u32 s65, s65, 8192
    v_readfirstlane_b32 s9, v8
    buffer_load_dwordx4 v3, s[28:31], s60 offen offset:1024 nt lds
    s_add_u32 s67, s67, 1
    s_add_u32 s7, s7, 1
    buffer_load_dwordx4 v2, s[28:31], s60 offen offset:2048 nt lds
    s_add_u32 s66, s66, 16384
    s_lshl4_add_u32 s9, s9, 32
    buffer_load_dwordx4 v3, s[28:31], s60 offen offset:3072 nt lds
    s_mov_b32 m0, 131840
    s_nop 0
    buffer_load_dwordx4 v10, s[20:23], s57 offen offset:0 lds
    ds_read_b64_tr_b16 a[94:95], v24 offset:520
    s_min_u32 s6, s6, s9
    buffer_load_dwordx4 v11, s[20:23], s57 offen offset:1024 lds
    s_cmp_eq_u32 s66, 114688
    s_cselect_b32 s66, 0, s66
    s_add_u32 s6, s6, s8
    buffer_load_dwordx4 v12, s[20:23], s57 offen offset:2048 lds
    s_add_u32 s60, s65, 0
    s_lshr_b32 s9, s6, 4
    buffer_load_dwordx4 v13, s[20:23], s57 offen offset:3072 lds
    ds_read_b64_tr_b16 a[96:97], v23 offset:768
    s_min_u32 s9, s9, s7
    ds_read_b32 v8, v7
    s_add_u32 m0, s66, 0
    s_waitcnt vmcnt(28)
    v_mov_b32 v9, s9
    ds_write_b32 v6, v9
    ds_read_b64_tr_b16 a[98:99], v24 offset:768
    ds_read_b64_tr_b16 a[100:101], v23 offset:776
    ds_read_b64_tr_b16 a[102:103], v24 offset:776
    s_waitcnt lgkmcnt(0)
    v_cmp_gt_u32 vcc, s67, v8
    s_cbranch_vccnz L_pc98
L_pc98r:
    s_mov_b32 s69, 0
.p2align 3
L_eloop:
    s_waitcnt lgkmcnt(0)
    v_mfma_f32_16x16x32_bf16 a[0:3], a[72:75], a[104:107], a[0:3]
    s_add_u32 s57, s56, s38
    buffer_load_dwordx4 v2, s[24:27], s60 offen offset:0 nt lds
    v_mfma_f32_16x16x32_bf16 a[4:7], a[72:75], a[108:111], a[4:7]
    buffer_load_dwordx4 v3, s[24:27], s60 offen offset:1024 nt lds
    s_add_u32 s64, s71, s73
    v_mfma_f32_16x16x32_bf16 a[8:11], a[72:75], a[112:115], a[8:11]
    buffer_load_dwordx4 v2, s[24:27], s60 offen offset:2048 nt lds
    s_bfe_u32 s63, s64, 0x20002
    v_mfma_f32_16x16x32_bf16 a[12:15], a[72:75], a[116:119], a[12:15]
    buffer_load_dwordx4 v3, s[24:27], s60 offen offset:3072 nt lds
    s_mov_b32 m0, 135936
    v_mfma_f32_16x16x32_bf16 a[16:19], a[72:75], a[120:123], a[16:19]
    buffer_load_dwordx4 v10, s[20:23], s57 offen offset:0 lds
    s_and_b32 s64, s64, 3
    v_mfma_f32_16x16x32_bf16 a[20:23], a[72:75], a[124:127], a[20:23]
    buffer_load_dwordx4 v11, s[20:23], s57 offen offset:1024 lds
    s_mul_i32 s59, s63, s82
    v_mfma_f32_16x16x32_bf16 a[24:27], a[72:75], a[128:131], a[24:27]
    buffer_load_dwordx4 v12, s[20:23], s57 offen offset:2048 lds
    s_add_u32 s60, s65, 4096
    v_mfma_f32_16x16x32_bf16 a[28:31], a[72:75], a[132:135], a[28:31]
    buffer_load_dwordx4 v13, s[20:23], s57 offen offset:3072 lds
    s_mul_i32 s61, s64, s83
    v_mfma_f32_16x16x32_bf16 a[32:35], a[72:75], a[136:139], a[32:35]
    s_add_u32 m0, s66, 4096
    s_add_u32 s59, s59, s61
    v_mfma_f32_16x16x32_bf16 a[36:39], a[76:79], a[104:107], a[36:39]
    s_waitcnt vmcnt(32)
    s_add_u32 s59, s59, s100
    v_mfma_f32_16x16x32_bf16 a[40:43], a[76:79], a[108:111], a[40:43]
    s_add_u32 s73, s73, 1
    v_accvgpr_mov_b32 a172, a208
    v_mfma_f32_16x16x32_bf16 a[44:47], a[76:79], a[112:115], a[44:47]
    v_accvgpr_mov_b32 a173, a209
    v_accvgpr_mov_b32 a174, a210
    v_mfma_f32_16x16x32_bf16 a[48:51], a[76:79], a[116:119], a[48:51]
    s_add_u32 s57, s56, s39
    buffer_load_dwordx4 v2, s[24:27], s60 offen offset:0 nt lds
    v_mfma_f32_16x16x32_bf16 a[52:55], a[76:79], a[120:123], a[52:55]
    buffer_load_dwordx4 v3, s[24:27], s60 offen offset:1024 nt lds
    v_accvgpr_mov_b32 a175, a211
    v_mfma_f32_16x16x32_bf16 a[56:59], a[76:79], a[124:127], a[56:59]
    buffer_load_dwordx4 v2, s[24:27], s60 offen offset:2048 nt lds
    v_accvgpr_mov_b32 a176, a212
    v_mfma_f32_16x16x32_bf16 a[60:63], a[76:79], a[128:131], a[60:63]
    buffer_load_dwordx4 v3, s[24:27], s60 offen offset:3072 nt lds
    s_mov_b32 m0, 140032
    v_mfma_f32_16x16x32_bf16 a[64:67], a[76:79], a[132:135], a[64:67]
    buffer_load_dwordx4 v10, s[20:23], s57 offen offset:0 lds
    v_accvgpr_mov_b32 a177, a213
    v_mfma_f32_16x16x32_bf16 a[68:71], a[76:79], a[136:139], a[68:71]
    buffer_load_dwordx4 v11, s[20:23], s57 offen offset:1024 lds
    v_accvgpr_mov_b32 a178, a214
    v_mfma_f32_16x16x32_bf16 v[32:35], a[80:83], a[104:107], v[32:35]
    buffer_load_dwordx4 v12, s[20:23], s57 offen offset:2048 lds
    s_sub_u32 s60, s65, 8192
    v_mfma_f32_16x16x32_bf16 v[36:39], a[80:83], a[108:111], v[36:39]
    buffer_load_dwordx4 v13, s[20:23], s57 offen offset:3072 lds
    v_accvgpr_mov_b32 a179, a215
    v_mfma_f32_16x16x32_bf16 v[40:43], a[80:83], a[112:115], v[40:43]
    s_add_u32 m0, s66, 8192
    v_accvgpr_mov_b32 a180, a216
    v_mfma_f32_16x16x32_bf16 v[44:47], a[80:83], a[116:119], v[44:47]
    s_waitcnt vmcnt(32)
    v_accvgpr_mov_b32 a181, a217
    v_mfma_f32_16x16x32_bf16 v[48:51], a[80:83], a[120:123], v[48:51]
    v_accvgpr_mov_b32 a182, a218
    v_accvgpr_mov_b32 a183, a219
    v_mfma_f32_16x16x32_bf16 v[52:55], a[80:83], a[124:127], v[52:55]
    v_accvgpr_mov_b32 a184, a220
    v_accvgpr_mov_b32 a185, a221
    v_mfma_f32_16x16x32_bf16 v[56:59], a[80:83], a[128:131], v[56:59]
    buffer_load_dwordx4 v2, s[28:31], s60 offen offset:0 nt lds
    v_accvgpr_mov_b32 a186, a222
    v_mfma_f32_16x16x32_bf16 v[60:63], a[80:83], a[132:135], v[60:63]
    buffer_load_dwordx4 v3, s[28:31], s60 offen offset:1024 nt lds
    v_accvgpr_mov_b32 a187, a223
    v_mfma_f32_16x16x32_bf16 v[64:67], a[80:83], a[136:139], v[64:67]
    buffer_load_dwordx4 v2, s[28:31], s60 offen offset:2048 nt lds
    v_accvgpr_mov_b32 a188, a224
    v_mfma_f32_16x16x32_bf16 v[68:71], a[84:87], a[104:107], v[68:71]
    buffer_load_dwordx4 v3, s[28:31], s60 offen offset:3072 nt lds
    s_mov_b32 m0, 146176
    v_mfma_f32_16x16x32_bf16 v[72:75], a[84:87], a[108:111], v[72:75]
    buffer_load_dwordx4 v19, s[32:35], s58 offen offset:0 lds
    v_accvgpr_mov_b32 a189, a225
    v_mfma_f32_16x16x32_bf16 v[76:79], a[84:87], a[112:115], v[76:79]
    buffer_load_dwordx4 v20, s[32:35], s58 offen offset:1024 lds
    v_accvgpr_mov_b32 a190, a226
    v_mfma_f32_16x16x32_bf16 v[80:83], a[84:87], a[116:119], v[80:83]
    buffer_load_dwordx4 v21, s[32:35], s58 offen offset:2048 lds
    s_sub_u32 s60, s65, 4096
    v_mfma_f32_16x16x32_bf16 v[84:87], a[84:87], a[120:123], v[84:87]
    buffer_load_dwordx4 v22, s[32:35], s58 offen offset:3072 lds
    v_accvgpr_mov_b32 a191, a227
    v_mfma_f32_16x16x32_bf16 v[88:91], a[84:87], a[124:127], v[88:91]
    s_add_u32 m0, s66, 12288
    v_accvgpr_mov_b32 a192, a228
    v_mfma_f32_16x16x32_bf16 v[92:95], a[84:87], a[128:131], v[92:95]
    s_waitcnt vmcnt(36)
    v_accvgpr_mov_b32 a193, a229
    v_mfma_f32_16x16x32_bf16 v[96:99], a[84:87], a[132:135], v[96:99]
    v_accvgpr_mov_b32 a194, a230
    v_accvgpr_mov_b32 a195, a231
    v_mfma_f32_16x16x32_bf16 v[100:103], a[84:87], a[136:139], v[100:103]
    v_accvgpr_mov_b32 a196, a232
    v_accvgpr_mov_b32 a197, a233
    v_mfma_f32_16x16x32_bf16 v[104:107], a[88:91], a[104:107], v[104:107]
    s_add_u32 s57, s56, s74
    buffer_load_dwordx4 v2, s[28:31], s60 offen offset:0 nt lds
    s_add_u32 s65, s65, 8192
    v_readfirstlane_b32 s9, v8
    v_mfma_f32_16x16x32_bf16 v[108:111], a[88:91], a[108:111], v[108:111]
    buffer_load_dwordx4 v3, s[28:31], s60 offen offset:1024 nt lds
    s_add_u32 s67, s67, 1
    s_add_u32 s7, s7, 1
    v_mfma_f32_16x16x32_bf16 v[112:115], a[88:91], a[112:115], v[112:115]
    buffer_load_dwordx4 v2, s[28:31], s60 offen offset:2048 nt lds
    s_add_u32 s66, s66, 16384
    s_lshl4_add_u32 s9, s9, 32
    v_mfma_f32_16x16x32_bf16 v[116:119], a[88:91], a[116:119], v[116:119]
    buffer_load_dwordx4 v3, s[28:31], s60 offen offset:3072 nt lds
    s_mov_b32 m0, 144128
    v_mfma_f32_16x16x32_bf16 v[120:123], a[88:91], a[120:123], v[120:123]
    buffer_load_dwordx4 v10, s[20:23], s57 offen offset:0 lds
    v_accvgpr_mov_b32 a198, a234
    s_min_u32 s6, s6, s9
    v_mfma_f32_16x16x32_bf16 v[124:127], a[88:91], a[124:127], v[124:127]
    buffer_load_dwordx4 v11, s[20:23], s57 offen offset:1024 lds
    s_cmp_eq_u32 s66, 114688
    s_cselect_b32 s66, 0, s66
    s_add_u32 s6, s6, s8
    v_mfma_f32_16x16x32_bf16 v[128:131], a[88:91], a[128:131], v[128:131]
    s_add_u32 s60, s65, 0
    v_accvgpr_mov_b32 a199, a235
    s_lshr_b32 s9, s6, 4
    v_mfma_f32_16x16x32_bf16 v[132:135], a[88:91], a[132:135], v[132:135]
    v_accvgpr_mov_b32 a200, a236
    v_accvgpr_mov_b32 a201, a237
    s_min_u32 s9, s9, s7
    v_mfma_f32_16x16x32_bf16 v[136:139], a[88:91], a[136:139], v[136:139]
    ds_read_b32 v8, v7
    s_add_u32 m0, s66, 0
    v_mfma_f32_16x16x32_bf16 v[140:143], a[92:95], a[104:107], v[140:143]
    s_waitcnt vmcnt(34)
    v_mov_b32 v9, s9
    v_mfma_f32_16x16x32_bf16 v[144:147], a[92:95], a[108:111], v[144:147]
    ds_write_b32 v6, v9
    v_accvgpr_mov_b32 a202, a238
    v_mfma_f32_16x16x32_bf16 v[148:151], a[92:95], a[112:115], v[148:151]
    s_waitcnt lgkmcnt(0)
    v_cmp_gt_u32 vcc, s67, v8
    s_cbranch_vccnz L_pc99
L_pc99r:
    v_mfma_f32_16x16x32_bf16 v[152:155], a[92:95], a[116:119], v[152:155]
    s_add_u32 s64, s58, s101
    s_waitcnt vmcnt(50)
    buffer_load_dwordx4 v2, s[24:27], s60 offen offset:0 nt lds
    v_mfma_f32_16x16x32_bf16 v[156:159], a[92:95], a[120:123], v[156:159]
    buffer_load_dwordx4 v3, s[24:27], s60 offen offset:1024 nt lds
    ds_read_b64_tr_b16 a[140:141], v23 offset:8192
    v_mfma_f32_16x16x32_bf16 v[160:163], a[92:95], a[124:127], v[160:163]
    buffer_load_dwordx4 v2, s[24:27], s60 offen offset:2048 nt lds
    ds_read_b64_tr_b16 a[142:143], v24 offset:8192
    v_mfma_f32_16x16x32_bf16 v[164:167], a[92:95], a[128:131], v[164:167]
    buffer_load_dwordx4 v3, s[24:27], s60 offen offset:3072 nt lds
    s_mov_b32 m0, 150272
    v_mfma_f32_16x16x32_bf16 v[168:171], a[92:95], a[132:135], v[168:171]
    buffer_load_dwordx4 v19, s[32:35], s64 offen offset:0 lds
    ds_read_b64_tr_b16 a[144:145], v23 offset:8200
    v_mfma_f32_16x16x32_bf16 v[172:175], a[92:95], a[136:139], v[172:175]
    buffer_load_dwordx4 v20, s[32:35], s64 offen offset:1024 lds
    ds_read_b64_tr_b16 a[146:147], v24 offset:8200
    v_mfma_f32_16x16x32_bf16 v[176:179], a[96:99], a[104:107], v[176:179]
    buffer_load_dwordx4 v21, s[32:35], s64 offen offset:2048 lds
    s_add_u32 s60, s65, 4096
    v_mfma_f32_16x16x32_bf16 v[180:183], a[96:99], a[108:111], v[180:183]
    buffer_load_dwordx4 v22, s[32:35], s64 offen offset:3072 lds
    ds_read_b64_tr_b16 a[148:149], v23 offset:8448
    v_mfma_f32_16x16x32_bf16 v[184:187], a[96:99], a[112:115], v[184:187]
    ds_read_b64_tr_b16 a[150:151], v24 offset:8448
    s_add_u32 m0, s66, 4096
    v_mfma_f32_16x16x32_bf16 v[188:191], a[96:99], a[116:119], v[188:191]
    s_waitcnt vmcnt(34)
    ds_read_b64_tr_b16 a[152:153], v23 offset:8456
    v_mfma_f32_16x16x32_bf16 v[192:195], a[96:99], a[120:123], v[192:195]
    ds_read_b64_tr_b16 a[154:155], v24 offset:8456
    ds_read_b64_tr_b16 a[156:157], v23 offset:8704
    v_mfma_f32_16x16x32_bf16 v[196:199], a[96:99], a[124:127], v[196:199]
    ds_read_b64_tr_b16 a[158:159], v24 offset:8704
    ds_read_b64_tr_b16 a[160:161], v23 offset:8712
    v_mfma_f32_16x16x32_bf16 v[200:203], a[96:99], a[128:131], v[200:203]
    buffer_load_dwordx4 v2, s[24:27], s60 offen offset:0 nt lds
    ds_read_b64_tr_b16 a[162:163], v24 offset:8712
    v_mfma_f32_16x16x32_bf16 v[204:207], a[96:99], a[132:135], v[204:207]
    buffer_load_dwordx4 v3, s[24:27], s60 offen offset:1024 nt lds
    ds_read_b64_tr_b16 a[164:165], v23 offset:8960
    v_mfma_f32_16x16x32_bf16 v[208:211], a[96:99], a[136:139], v[208:211]
    buffer_load_dwordx4 v2, s[24:27], s60 offen offset:2048 nt lds
    ds_read_b64_tr_b16 a[166:167], v24 offset:8960
    v_mfma_f32_16x16x32_bf16 v[212:215], a[100:103], a[104:107], v[212:215]
    buffer_load_dwordx4 v3, s[24:27], s60 offen offset:3072 nt lds
    ds_read_b64_tr_b16 a[168:169], v23 offset:8968
    v_mfma_f32_16x16x32_bf16 v[216:219], a[100:103], a[108:111], v[216:219]
    ds_read_b64_tr_b16 a[170:171], v24 offset:8968
    v_accvgpr_mov_b32 a203, a239
    v_mfma_f32_16x16x32_bf16 v[220:223], a[100:103], a[112:115], v[220:223]
    v_accvgpr_mov_b32 a204, a240
    v_accvgpr_mov_b32 a205, a241
    v_mfma_f32_16x16x32_bf16 v[224:227], a[100:103], a[116:119], v[224:227]
    s_sub_u32 s60, s65, 8192
    v_accvgpr_mov_b32 a206, a242
    v_mfma_f32_16x16x32_bf16 v[228:231], a[100:103], a[120:123], v[228:231]
    v_accvgpr_mov_b32 a207, a243
    v_mfma_f32_16x16x32_bf16 v[232:235], a[100:103], a[124:127], v[232:235]
    s_add_u32 m0, s66, 8192
    v_mfma_f32_16x16x32_bf16 v[236:239], a[100:103], a[128:131], v[236:239]
    s_waitcnt vmcnt(30)
    v_mfma_f32_16x16x32_bf16 v[240:243], a[100:103], a[132:135], v[240:243]
    v_mfma_f32_16x16x32_bf16 v[244:247], a[100:103], a[136:139], v[244:247]
    s_waitcnt lgkmcnt(0)
    v_mfma_f32_16x16x32_bf16 a[0:3], a[140:143], a[172:175], a[0:3]
    buffer_load_dwordx4 v2, s[28:31], s60 offen offset:0 nt lds
    s_add_u32 s64, s71, s73
    v_mfma_f32_16x16x32_bf16 a[4:7], a[140:143], a[176:179], a[4:7]
    buffer_load_dwordx4 v3, s[28:31], s60 offen offset:1024 nt lds
    s_bfe_u32 s63, s64, 0x20002
    v_mfma_f32_16x16x32_bf16 a[8:11], a[140:143], a[180:183], a[8:11]
    buffer_load_dwordx4 v2, s[28:31], s60 offen offset:2048 nt lds
    s_and_b32 s64, s64, 3
    v_mfma_f32_16x16x32_bf16 a[12:15], a[140:143], a[184:187], a[12:15]
    buffer_load_dwordx4 v3, s[28:31], s60 offen offset:3072 nt lds
    s_mov_b32 m0, 154368
    v_mfma_f32_16x16x32_bf16 a[16:19], a[140:143], a[188:191], a[16:19]
    buffer_load_dwordx4 v19, s[32:35], s59 offen offset:0 lds
    s_mul_i32 s56, s63, s80
    v_mfma_f32_16x16x32_bf16 a[20:23], a[140:143], a[192:195], a[20:23]
    buffer_load_dwordx4 v20, s[32:35], s59 offen offset:1024 lds
    s_mul_i32 s61, s64, s81
    v_mfma_f32_16x16x32_bf16 a[24:27], a[140:143], a[196:199], a[24:27]
    buffer_load_dwordx4 v21, s[32:35], s59 offen offset:2048 lds
    s_sub_u32 s60, s65, 4096
    v_mfma_f32_16x16x32_bf16 a[28:31], a[140:143], a[200:203], a[28:31]
    buffer_load_dwordx4 v22, s[32:35], s59 offen offset:3072 lds
    s_add_u32 s56, s56, s61
    v_mfma_f32_16x16x32_bf16 a[32:35], a[140:143], a[204:207], a[32:35]
    s_add_u32 m0, s66, 12288
    s_mul_i32 s58, s63, s82
    v_mfma_f32_16x16x32_bf16 a[36:39], a[144:147], a[172:175], a[36:39]
    s_waitcnt vmcnt(30)
    s_mul_i32 s61, s64, s83
    v_mfma_f32_16x16x32_bf16 a[40:43], a[144:147], a[176:179], a[40:43]
    s_add_u32 s58, s58, s61
    s_add_u32 s58, s58, s100
    v_mfma_f32_16x16x32_bf16 a[44:47], a[144:147], a[180:183], a[44:47]
    s_add_u32 s73, s73, 1
    v_mfma_f32_16x16x32_bf16 a[48:51], a[144:147], a[184:187], a[48:51]
    buffer_load_dwordx4 v2, s[28:31], s60 offen offset:0 nt lds
    s_add_u32 s65, s65, 8192
    v_readfirstlane_b32 s9, v8
    v_mfma_f32_16x16x32_bf16 a[52:55], a[144:147], a[188:191], a[52:55]
    buffer_load_dwordx4 v3, s[28:31], s60 offen offset:1024 nt lds
    s_add_u32 s67, s67, 1
    s_add_u32 s7, s7, 1
    v_mfma_f32_16x16x32_bf16 a[56:59], a[144:147], a[192:195], a[56:59]
    buffer_load_dwordx4 v2, s[28:31], s60 offen offset:2048 nt lds
    s_add_u32 s66, s66, 16384
    s_lshl4_add_u32 s9, s9, 32
    v_mfma_f32_16x16x32_bf16 a[60:63], a[144:147], a[196:199], a[60:63]
    buffer_load_dwordx4 v3, s[28:31], s60 offen offset:3072 nt lds
    v_mfma_f32_16x16x32_bf16 a[64:67], a[144:147], a[200:203], a[64:67]
    s_min_u32 s6, s6, s9
    v_mfma_f32_16x16x32_bf16 a[68:71], a[144:147], a[204:207], a[68:71]
    s_cmp_eq_u32 s66, 114688
    s_cselect_b32 s66, 0, s66
    s_add_u32 s6, s6, s8
    v_mfma_f32_16x16x32_bf16 v[32:35], a[148:151], a[172:175], v[32:35]
    s_add_u32 s60, s65, 0
    s_lshr_b32 s9, s6, 4
    v_mfma_f32_16x16x32_bf16 v[36:39], a[148:151], a[176:179], v[36:39]
    s_min_u32 s9, s9, s7
    v_mfma_f32_16x16x32_bf16 v[40:43], a[148:151], a[180:183], v[40:43]
    ds_read_b32 v8, v7
    s_add_u32 m0, s66, 0
    v_mfma_f32_16x16x32_bf16 v[44:47], a[148:151], a[184:187], v[44:47]
    s_waitcnt vmcnt(26)
    v_mov_b32 v9, s9
    v_mfma_f32_16x16x32_bf16 v[48:51], a[148:151], a[188:191], v[48:51]
    ds_write_b32 v6, v9
    v_mfma_f32_16x16x32_bf16 v[52:55], a[148:151], a[192:195], v[52:55]
    s_waitcnt lgkmcnt(0)
    v_cmp_gt_u32 vcc, s67, v8
    s_cbranch_vccnz L_pc100
L_pc100r:
    v_mfma_f32_16x16x32_bf16 v[56:59], a[148:151], a[196:199], v[56:59]
    s_add_u32 s64, s59, s101
    s_waitcnt vmcnt(46)
    buffer_load_dwordx4 v2, s[24:27], s60 offen offset:0 nt lds
    v_mfma_f32_16x16x32_bf16 v[60:63], a[148:151], a[200:203], v[60:63]
    buffer_load_dwordx4 v3, s[24:27], s60 offen offset:1024 nt lds
    ds_read_b128 a[104:107], v25 offset:0
    v_mfma_f32_16x16x32_bf16 v[64:67], a[148:151], a[204:207], v[64:67]
    buffer_load_dwordx4 v2, s[24:27], s60 offen offset:2048 nt lds
    ds_read_b128 a[208:211], v14 offset:0
    v_mfma_f32_16x16x32_bf16 v[68:71], a[152:155], a[172:175], v[68:71]
    buffer_load_dwordx4 v3, s[24:27], s60 offen offset:3072 nt lds
    s_mov_b32 m0, 158464
    v_mfma_f32_16x16x32_bf16 v[72:75], a[152:155], a[176:179], v[72:75]
    buffer_load_dwordx4 v19, s[32:35], s64 offen offset:0 lds
    ds_read_b128 a[108:111], v25 offset:2048
    v_mfma_f32_16x16x32_bf16 v[76:79], a[152:155], a[180:183], v[76:79]
    buffer_load_dwordx4 v20, s[32:35], s64 offen offset:1024 lds
    ds_read_b128 a[212:215], v14 offset:2048
    v_mfma_f32_16x16x32_bf16 v[80:83], a[152:155], a[184:187], v[80:83]
    buffer_load_dwordx4 v21, s[32:35], s64 offen offset:2048 lds
    s_add_u32 s60, s65, 4096
    v_mfma_f32_16x16x32_bf16 v[84:87], a[152:155], a[188:191], v[84:87]
    buffer_load_dwordx4 v22, s[32:35], s64 offen offset:3072 lds
    ds_read_b128 a[112:115], v25 offset:4096
    v_mfma_f32_16x16x32_bf16 v[88:91], a[152:155], a[192:195], v[88:91]
    ds_read_b128 a[216:219], v14 offset:4096
    s_add_u32 m0, s66, 4096
    v_mfma_f32_16x16x32_bf16 v[92:95], a[152:155], a[196:199], v[92:95]
    s_waitcnt vmcnt(28)
    ds_read_b128 a[116:119], v25 offset:6144
    v_mfma_f32_16x16x32_bf16 v[96:99], a[152:155], a[200:203], v[96:99]
    ds_read_b128 a[220:223], v14 offset:6144
    ds_read_b128 a[120:123], v25 offset:8192
    v_mfma_f32_16x16x32_bf16 v[100:103], a[152:155], a[204:207], v[100:103]
    ds_read_b128 a[224:227], v14 offset:8192
    ds_read_b128 a[124:127], v25 offset:10240
    v_mfma_f32_16x16x32_bf16 v[104:107], a[156:159], a[172:175], v[104:107]
    s_waitcnt vmcnt(32)
    buffer_load_dwordx4 v2, s[24:27], s60 offen offset:0 nt lds
    v_mfma_f32_16x16x32_bf16 v[108:111], a[156:159], a[176:179], v[108:111]
    buffer_load_dwordx4 v3, s[24:27], s60 offen offset:1024 nt lds
    ds_read_b128 a[228:231], v14 offset:10240
    v_mfma_f32_16x16x32_bf16 v[112:115], a[156:159], a[180:183], v[112:115]
    buffer_load_dwordx4 v2, s[24:27], s60 offen offset:2048 nt lds
    ds_read_b128 a[128:131], v25 offset:12288
    v_mfma_f32_16x16x32_bf16 v[116:119], a[156:159], a[184:187], v[116:119]
    buffer_load_dwordx4 v3, s[24:27], s60 offen offset:3072 nt lds
    ds_read_b128 a[232:235], v14 offset:12288
    v_mfma_f32_16x16x32_bf16 v[120:123], a[156:159], a[188:191], v[120:123]
    ds_read_b128 a[132:135], v25 offset:14336
    ds_read_b128 a[236:239], v14 offset:14336
    v_mfma_f32_16x16x32_bf16 v[124:127], a[156:159], a[192:195], v[124:127]
    ds_read_b128 a[136:139], v25 offset:16384
    ds_read_b128 a[240:243], v14 offset:16384
    v_mfma_f32_16x16x32_bf16 v[128:131], a[156:159], a[196:199], v[128:131]
    s_sub_u32 s60, s65, 8192
    v_mfma_f32_16x16x32_bf16 v[132:135], a[156:159], a[200:203], v[132:135]
    v_mfma_f32_16x16x32_bf16 v[136:139], a[156:159], a[204:207], v[136:139]
    s_add_u32 m0, s66, 8192
    v_mfma_f32_16x16x32_bf16 v[140:143], a[160:163], a[172:175], v[140:143]
    s_waitcnt vmcnt(24)
    v_mfma_f32_16x16x32_bf16 v[144:147], a[160:163], a[176:179], v[144:147]
    v_mfma_f32_16x16x32_bf16 v[148:151], a[160:163], a[180:183], v[148:151]
    s_waitcnt lgkmcnt(0)
    v_mfma_f32_16x16x32_bf16 v[152:155], a[160:163], a[184:187], v[152:155]
    s_add_u32 s57, s56, s36
    s_waitcnt vmcnt(28)
    buffer_load_dwordx4 v2, s[28:31], s60 offen offset:0 nt lds
    v_mfma_f32_16x16x32_bf16 v[156:159], a[160:163], a[188:191], v[156:159]
    buffer_load_dwordx4 v3, s[28:31], s60 offen offset:1024 nt lds
    ds_read_b64_tr_b16 a[72:73], v23 offset:0
    v_mfma_f32_16x16x32_bf16 v[160:163], a[160:163], a[192:195], v[160:163]
    buffer_load_dwordx4 v2, s[28:31], s60 offen offset:2048 nt lds
    ds_read_b64_tr_b16 a[74:75], v24 offset:0
    v_mfma_f32_16x16x32_bf16 v[164:167], a[160:163], a[196:199], v[164:167]
    buffer_load_dwordx4 v3, s[28:31], s60 offen offset:3072 nt lds
    s_mov_b32 m0, 127744
    v_mfma_f32_16x16x32_bf16 v[168:171], a[160:163], a[200:203], v[168:171]
    buffer_load_dwordx4 v10, s[20:23], s57 offen offset:0 lds
    ds_read_b64_tr_b16 a[76:77], v23 offset:8
    v_mfma_f32_16x16x32_bf16 v[172:175], a[160:163], a[204:207], v[172:175]
    buffer_load_dwordx4 v11, s[20:23], s57 offen offset:1024 lds
    ds_read_b64_tr_b16 a[78:79], v24 offset:8
    v_mfma_f32_16x16x32_bf16 v[176:179], a[164:167], a[172:175], v[176:179]
    buffer_load_dwordx4 v12, s[20:23], s57 offen offset:2048 lds
    s_sub_u32 s60, s65, 4096
    v_mfma_f32_16x16x32_bf16 v[180:183], a[164:167], a[176:179], v[180:183]
    buffer_load_dwordx4 v13, s[20:23], s57 offen offset:3072 lds
    ds_read_b64_tr_b16 a[80:81], v23 offset:256
    v_mfma_f32_16x16x32_bf16 v[184:187], a[164:167], a[180:183], v[184:187]
    ds_read_b64_tr_b16 a[82:83], v24 offset:256
    s_add_u32 m0, s66, 12288
    v_mfma_f32_16x16x32_bf16 v[188:191], a[164:167], a[184:187], v[188:191]
    s_waitcnt vmcnt(28)
    ds_read_b64_tr_b16 a[84:85], v23 offset:264
    v_mfma_f32_16x16x32_bf16 v[192:195], a[164:167], a[188:191], v[192:195]
    ds_read_b64_tr_b16 a[86:87], v24 offset:264
    ds_read_b64_tr_b16 a[88:89], v23 offset:512
    v_mfma_f32_16x16x32_bf16 v[196:199], a[164:167], a[192:195], v[196:199]
    ds_read_b64_tr_b16 a[90:91], v24 offset:512
    ds_read_b64_tr_b16 a[92:93], v23 offset:520
    v_mfma_f32_16x16x32_bf16 v[200:203], a[164:167], a[196:199], v[200:203]
    s_add_u32 s57, s56, s37
    buffer_load_dwordx4 v2, s[28:31], s60 offen offset:0 nt lds
    s_add_u32 s65, s65, 8192
    v_readfirstlane_b32 s9, v8
    v_mfma_f32_16x16x32_bf16 v[204:207], a[164:167], a[200:203], v[204:207]
    buffer_load_dwordx4 v3, s[28:31], s60 offen offset:1024 nt lds
    s_add_u32 s67, s67, 1
    s_add_u32 s7, s7, 1
    v_mfma_f32_16x16x32_bf16 v[208:211], a[164:167], a[204:207], v[208:211]
    buffer_load_dwordx4 v2, s[28:31], s60 offen offset:2048 nt lds
    s_add_u32 s66, s66, 16384
    s_lshl4_add_u32 s9, s9, 32
    v_mfma_f32_16x16x32_bf16 v[212:215], a[168:171], a[172:175], v[212:215]
    buffer_load_dwordx4 v3, s[28:31], s60 offen offset:3072 nt lds
    s_mov_b32 m0, 131840
    v_mfma_f32_16x16x32_bf16 v[216:219], a[168:171], a[176:179], v[216:219]
    buffer_load_dwordx4 v10, s[20:23], s57 offen offset:0 lds
    ds_read_b64_tr_b16 a[94:95], v24 offset:520
    s_min_u32 s6, s6, s9
    v_mfma_f32_16x16x32_bf16 v[220:223], a[168:171], a[180:183], v[220:223]
    buffer_load_dwordx4 v11, s[20:23], s57 offen offset:1024 lds
    s_cmp_eq_u32 s66, 114688
    s_cselect_b32 s66, 0, s66
    s_add_u32 s6, s6, s8
    v_mfma_f32_16x16x32_bf16 v[224:227], a[168:171], a[184:187], v[224:227]
    buffer_load_dwordx4 v12, s[20:23], s57 offen offset:2048 lds
    s_add_u32 s60, s65, 0
    s_lshr_b32 s9, s6, 4
    v_mfma_f32_16x16x32_bf16 v[228:231], a[168:171], a[188:191], v[228:231]
    buffer_load_dwordx4 v13, s[20:23], s57 offen offset:3072 lds
    ds_read_b64_tr_b16 a[96:97], v23 offset:768
    s_min_u32 s9, s9, s7
    v_mfma_f32_16x16x32_bf16 v[232:235], a[168:171], a[192:195], v[232:235]
    ds_read_b32 v8, v7
    s_add_u32 m0, s66, 0
    v_mfma_f32_16x16x32_bf16 v[236:239], a[168:171], a[196:199], v[236:239]
    s_waitcnt vmcnt(28)
    v_mov_b32 v9, s9
    v_mfma_f32_16x16x32_bf16 v[240:243], a[168:171], a[200:203], v[240:243]
    ds_write_b32 v6, v9
    ds_read_b64_tr_b16 a[98:99], v24 offset:768
    ds_read_b64_tr_b16 a[100:101], v23 offset:776
    ds_read_b64_tr_b16 a[102:103], v24 offset:776
    v_mfma_f32_16x16x32_bf16 v[244:247], a[168:171], a[204:207], v[244:247]
    s_waitcnt lgkmcnt(0)
    v_cmp_gt_u32 vcc, s67, v8
    s_cbranch_vccnz L_pc101
L_pc101r:
    s_add_u32 s69, s69, 1
    s_cmp_lt_u32 s69, 7
    s_cbranch_scc1 L_eloop
    s_waitcnt lgkmcnt(0)
    v_mfma_f32_16x16x32_bf16 a[0:3], a[72:75], a[104:107], a[0:3]
    buffer_load_dwordx4 v2, s[24:27], s60 offen offset:0 nt lds
    v_accvgpr_mov_b32 a172, a208
    v_mfma_f32_16x16x32_bf16 a[4:7], a[72:75], a[108:111], a[4:7]
    buffer_load_dwordx4 v3, s[24:27], s60 offen offset:1024 nt lds
    v_accvgpr_mov_b32 a173, a209
    v_mfma_f32_16x16x32_bf16 a[8:11], a[72:75], a[112:115], a[8:11]
    buffer_load_dwordx4 v2, s[24:27], s60 offen offset:2048 nt lds
    v_accvgpr_mov_b32 a174, a210
    v_mfma_f32_16x16x32_bf16 a[12:15], a[72:75], a[116:119], a[12:15]
    buffer_load_dwordx4 v3, s[24:27], s60 offen offset:3072 nt lds
    v_accvgpr_mov_b32 a175, a211
    v_mfma_f32_16x16x32_bf16 a[16:19], a[72:75], a[120:123], a[16:19]
    v_accvgpr_mov_b32 a176, a212
    v_accvgpr_mov_b32 a177, a213
    v_mfma_f32_16x16x32_bf16 a[20:23], a[72:75], a[124:127], a[20:23]
    v_accvgpr_mov_b32 a178, a214
    v_accvgpr_mov_b32 a179, a215
    v_mfma_f32_16x16x32_bf16 a[24:27], a[72:75], a[128:131], a[24:27]
    s_add_u32 s60, s65, 4096
    v_accvgpr_mov_b32 a180, a216
    v_mfma_f32_16x16x32_bf16 a[28:31], a[72:75], a[132:135], a[28:31]
    v_accvgpr_mov_b32 a181, a217
    v_accvgpr_mov_b32 a182, a218
    v_mfma_f32_16x16x32_bf16 a[32:35], a[72:75], a[136:139], a[32:35]
    s_add_u32 m0, s66, 4096
    v_accvgpr_mov_b32 a183, a219
    v_mfma_f32_16x16x32_bf16 a[36:39], a[76:79], a[104:107], a[36:39]
    s_waitcnt vmcnt(28)
    v_accvgpr_mov_b32 a184, a220
    v_mfma_f32_16x16x32_bf16 a[40:43], a[76:79], a[108:111], a[40:43]
    v_accvgpr_mov_b32 a185, a221
    v_accvgpr_mov_b32 a186, a222
    v_mfma_f32_16x16x32_bf16 a[44:47], a[76:79], a[112:115], a[44:47]
    v_accvgpr_mov_b32 a187, a223
    v_accvgpr_mov_b32 a188, a224
    v_mfma_f32_16x16x32_bf16 a[48:51], a[76:79], a[116:119], a[48:51]
    buffer_load_dwordx4 v2, s[24:27], s60 offen offset:0 nt lds
    v_accvgpr_mov_b32 a189, a225
    v_mfma_f32_16x16x32_bf16 a[52:55], a[76:79], a[120:123], a[52:55]
    buffer_load_dwordx4 v3, s[24:27], s60 offen offset:1024 nt lds
    v_accvgpr_mov_b32 a190, a226
    v_mfma_f32_16x16x32_bf16 a[56:59], a[76:79], a[124:127], a[56:59]
    buffer_load_dwordx4 v2, s[24:27], s60 offen offset:2048 nt lds
    v_accvgpr_mov_b32 a191, a227
    v_mfma_f32_16x16x32_bf16 a[60:63], a[76:79], a[128:131], a[60:63]
    buffer_load_dwordx4 v3, s[24:27], s60 offen offset:3072 nt lds
    v_accvgpr_mov_b32 a192, a228
    v_mfma_f32_16x16x32_bf16 a[64:67], a[76:79], a[132:135], a[64:67]
    v_accvgpr_mov_b32 a193, a229
    v_accvgpr_mov_b32 a194, a230
    v_mfma_f32_16x16x32_bf16 a[68:71], a[76:79], a[136:139], a[68:71]
    v_accvgpr_mov_b32 a195, a231
    v_accvgpr_mov_b32 a196, a232
    v_mfma_f32_16x16x32_bf16 v[32:35], a[80:83], a[104:107], v[32:35]
    s_sub_u32 s60, s65, 8192
    v_accvgpr_mov_b32 a197, a233
    v_mfma_f32_16x16x32_bf16 v[36:39], a[80:83], a[108:111], v[36:39]
    v_accvgpr_mov_b32 a198, a234
    v_accvgpr_mov_b32 a199, a235
    v_mfma_f32_16x16x32_bf16 v[40:43], a[80:83], a[112:115], v[40:43]
    s_add_u32 m0, s66, 8192
    v_accvgpr_mov_b32 a200, a236
    v_mfma_f32_16x16x32_bf16 v[44:47], a[80:83], a[116:119], v[44:47]
    s_waitcnt vmcnt(24)
    v_accvgpr_mov_b32 a201, a237
    v_mfma_f32_16x16x32_bf16 v[48:51], a[80:83], a[120:123], v[48:51]
    v_accvgpr_mov_b32 a202, a238
    v_accvgpr_mov_b32 a203, a239
    v_mfma_f32_16x16x32_bf16 v[52:55], a[80:83], a[124:127], v[52:55]
    v_accvgpr_mov_b32 a204, a240
    v_accvgpr_mov_b32 a205, a241
    v_mfma_f32_16x16x32_bf16 v[56:59], a[80:83], a[128:131], v[56:59]
    buffer_load_dwordx4 v2, s[28:31], s60 offen offset:0 nt lds
    v_accvgpr_mov_b32 a206, a242
    v_mfma_f32_16x16x32_bf16 v[60:63], a[80:83], a[132:135], v[60:63]
    buffer_load_dwordx4 v3, s[28:31], s60 offen offset:1024 nt lds
    v_accvgpr_mov_b32 a207, a243
    v_mfma_f32_16x16x32_bf16 v[64:67], a[80:83], a[136:139], v[64:67]
    buffer_load_dwordx4 v2, s[28:31], s60 offen offset:2048 nt lds
    v_mfma_f32_16x16x32_bf16 v[68:71], a[84:87], a[104:107], v[68:71]
    buffer_load_dwordx4 v3, s[28:31], s60 offen offset:3072 nt lds
    v_mfma_f32_16x16x32_bf16 v[72:75], a[84:87], a[108:111], v[72:75]
    v_mfma_f32_16x16x32_bf16 v[76:79], a[84:87], a[112:115], v[76:79]
    v_mfma_f32_16x16x32_bf16 v[80:83], a[84:87], a[116:119], v[80:83]
    s_sub_u32 s60, s65, 4096
    v_mfma_f32_16x16x32_bf16 v[84:87], a[84:87], a[120:123], v[84:87]
    v_mfma_f32_16x16x32_bf16 v[88:91], a[84:87], a[124:127], v[88:91]
    s_add_u32 m0, s66, 12288
    v_mfma_f32_16x16x32_bf16 v[92:95], a[84:87], a[128:131], v[92:95]
    s_waitcnt vmcnt(24)
    v_mfma_f32_16x16x32_bf16 v[96:99], a[84:87], a[132:135], v[96:99]
    v_mfma_f32_16x16x32_bf16 v[100:103], a[84:87], a[136:139], v[100:103]
    v_mfma_f32_16x16x32_bf16 v[104:107], a[88:91], a[104:107], v[104:107]
    buffer_load_dwordx4 v2, s[28:31], s60 offen offset:0 nt lds
    s_add_u32 s65, s65, 8192
    v_readfirstlane_b32 s9, v8
    v_mfma_f32_16x16x32_bf16 v[108:111], a[88:91], a[108:111], v[108:111]
    buffer_load_dwordx4 v3, s[28:31], s60 offen offset:1024 nt lds
    s_add_u32 s67, s67, 1
    s_add_u32 s7, s7, 1
    v_mfma_f32_16x16x32_bf16 v[112:115], a[88:91], a[112:115], v[112:115]
    buffer_load_dwordx4 v2, s[28:31], s60 offen offset:2048 nt lds
    s_add_u32 s66, s66, 16384
    s_lshl4_add_u32 s9, s9, 32
    v_mfma_f32_16x16x32_bf16 v[116:119], a[88:91], a[116:119], v[116:119]
    buffer_load_dwordx4 v3, s[28:31], s60 offen offset:3072 nt lds
    v_mfma_f32_16x16x32_bf16 v[120:123], a[88:91], a[120:123], v[120:123]
    s_min_u32 s6, s6, s9
    v_mfma_f32_16x16x32_bf16 v[124:127], a[88:91], a[124:127], v[124:127]
    s_cmp_eq_u32 s66, 114688
    s_cselect_b32 s66, 0, s66
    s_add_u32 s6, s6, s8
    v_mfma_f32_16x16x32_bf16 v[128:131], a[88:91], a[128:131], v[128:131]
    s_add_u32 s60, s65, 0
    s_lshr_b32 s9, s6, 4
    v_mfma_f32_16x16x32_bf16 v[132:135], a[88:91], a[132:135], v[132:135]
    s_min_u32 s9, s9, s7
    v_mfma_f32_16x16x32_bf16 v[136:139], a[88:91], a[136:139], v[136:139]
    ds_read_b32 v8, v7
    s_add_u32 m0, s66, 0
    v_mfma_f32_16x16x32_bf16 v[140:143], a[92:95], a[104:107], v[140:143]
    s_waitcnt vmcnt(20)
    v_mov_b32 v9, s9
    v_mfma_f32_16x16x32_bf16 v[144:147], a[92:95], a[108:111], v[144:147]
    ds_write_b32 v6, v9
    v_mfma_f32_16x16x32_bf16 v[148:151], a[92:95], a[112:115], v[148:151]
    s_waitcnt lgkmcnt(0)
    v_cmp_gt_u32 vcc, s67, v8
    s_cbranch_vccnz L_pc102
L_pc102r:
    v_mfma_f32_16x16x32_bf16 v[152:155], a[92:95], a[116:119], v[152:155]
    s_waitcnt vmcnt(36)
    buffer_load_dwordx4 v2, s[24:27], s60 offen offset:0 nt lds
    v_mfma_f32_16x16x32_bf16 v[156:159], a[92:95], a[120:123], v[156:159]
    buffer_load_dwordx4 v3, s[24:27], s60 offen offset:1024 nt lds
    ds_read_b64_tr_b16 a[140:141], v23 offset:8192
    v_mfma_f32_16x16x32_bf16 v[160:163], a[92:95], a[124:127], v[160:163]
    buffer_load_dwordx4 v2, s[24:27], s60 offen offset:2048 nt lds
    ds_read_b64_tr_b16 a[142:143], v24 offset:8192
    v_mfma_f32_16x16x32_bf16 v[164:167], a[92:95], a[128:131], v[164:167]
    buffer_load_dwordx4 v3, s[24:27], s60 offen offset:3072 nt lds
    ds_read_b64_tr_b16 a[144:145], v23 offset:8200
    v_mfma_f32_16x16x32_bf16 v[168:171], a[92:95], a[132:135], v[168:171]
    ds_read_b64_tr_b16 a[146:147], v24 offset:8200
    ds_read_b64_tr_b16 a[148:149], v23 offset:8448
    v_mfma_f32_16x16x32_bf16 v[172:175], a[92:95], a[136:139], v[172:175]
    ds_read_b64_tr_b16 a[150:151], v24 offset:8448
    ds_read_b64_tr_b16 a[152:153], v23 offset:8456
    v_mfma_f32_16x16x32_bf16 v[176:179], a[96:99], a[104:107], v[176:179]
    ds_read_b64_tr_b16 a[154:155], v24 offset:8456
    s_add_u32 s60, s65, 4096
    v_mfma_f32_16x16x32_bf16 v[180:183], a[96:99], a[108:111], v[180:183]
    ds_read_b64_tr_b16 a[156:157], v23 offset:8704
    ds_read_b64_tr_b16 a[158:159], v24 offset:8704
    v_mfma_f32_16x16x32_bf16 v[184:187], a[96:99], a[112:115], v[184:187]
    ds_read_b64_tr_b16 a[160:161], v23 offset:8712
    s_add_u32 m0, s66, 4096
    v_mfma_f32_16x16x32_bf16 v[188:191], a[96:99], a[116:119], v[188:191]
    s_waitcnt vmcnt(16)
    ds_read_b64_tr_b16 a[162:163], v24 offset:8712
    v_mfma_f32_16x16x32_bf16 v[192:195], a[96:99], a[120:123], v[192:195]
    ds_read_b64_tr_b16 a[164:165], v23 offset:8960
    ds_read_b64_tr_b16 a[166:167], v24 offset:8960
    v_mfma_f32_16x16x32_bf16 v[196:199], a[96:99], a[124:127], v[196:199]
    ds_read_b64_tr_b16 a[168:169], v23 offset:8968
    ds_read_b64_tr_b16 a[170:171], v24 offset:8968
    v_mfma_f32_16x16x32_bf16 v[200:203], a[96:99], a[128:131], v[200:203]
    buffer_load_dwordx4 v2, s[24:27], s60 offen offset:0 nt lds
    v_mfma_f32_16x16x32_bf16 v[204:207], a[96:99], a[132:135], v[204:207]
    buffer_load_dwordx4 v3, s[24:27], s60 offen offset:1024 nt lds
    v_mfma_f32_16x16x32_bf16 v[208:211], a[96:99], a[136:139], v[208:211]
    buffer_load_dwordx4 v2, s[24:27], s60 offen offset:2048 nt lds
    v_mfma_f32_16x16x32_bf16 v[212:215], a[100:103], a[104:107], v[212:215]
    buffer_load_dwordx4 v3, s[24:27], s60 offen offset:3072 nt lds
    v_mfma_f32_16x16x32_bf16 v[216:219], a[100:103], a[108:111], v[216:219]
    v_mfma_f32_16x16x32_bf16 v[220:223], a[100:103], a[112:115], v[220:223]
    v_mfma_f32_16x16x32_bf16 v[224:227], a[100:103], a[116:119], v[224:227]
    s_sub_u32 s60, s65, 8192
    v_mfma_f32_16x16x32_bf16 v[228:231], a[100:103], a[120:123], v[228:231]
    v_mfma_f32_16x16x32_bf16 v[232:235], a[100:103], a[124:127], v[232:235]
    s_add_u32 m0, s66, 8192
    v_mfma_f32_16x16x32_bf16 v[236:239], a[100:103], a[128:131], v[236:239]
    s_waitcnt vmcnt(16)
    v_mfma_f32_16x16x32_bf16 v[240:243], a[100:103], a[132:135], v[240:243]
    v_mfma_f32_16x16x32_bf16 v[244:247], a[100:103], a[136:139], v[244:247]
    s_waitcnt lgkmcnt(0)
    v_mfma_f32_16x16x32_bf16 a[0:3], a[140:143], a[172:175], a[0:3]
    buffer_load_dwordx4 v2, s[28:31], s60 offen offset:0 nt lds
    v_mfma_f32_16x16x32_bf16 a[4:7], a[140:143], a[176:179], a[4:7]
    buffer_load_dwordx4 v3, s[28:31], s60 offen offset:1024 nt lds
    v_mfma_f32_16x16x32_bf16 a[8:11], a[140:143], a[180:183], a[8:11]
    buffer_load_dwordx4 v2, s[28:31], s60 offen offset:2048 nt lds
    v_mfma_f32_16x16x32_bf16 a[12:15], a[140:143], a[184:187], a[12:15]
    buffer_load_dwordx4 v3, s[28:31], s60 offen offset:3072 nt lds
    v_mfma_f32_16x16x32_bf16 a[16:19], a[140:143], a[188:191], a[16:19]
    v_mfma_f32_16x16x32_bf16 a[20:23], a[140:143], a[192:195], a[20:23]
    v_mfma_f32_16x16x32_bf16 a[24:27], a[140:143], a[196:199], a[24:27]
    s_sub_u32 s60, s65, 4096
    v_mfma_f32_16x16x32_bf16 a[28:31], a[140:143], a[200:203], a[28:31]
    v_mfma_f32_16x16x32_bf16 a[32:35], a[140:143], a[204:207], a[32:35]
    s_add_u32 m0, s66, 12288
    v_mfma_f32_16x16x32_bf16 a[36:39], a[144:147], a[172:175], a[36:39]
    s_waitcnt vmcnt(16)
    v_mfma_f32_16x16x32_bf16 a[40:43], a[144:147], a[176:179], a[40:43]
    v_mfma_f32_16x16x32_bf16 a[44:47], a[144:147], a[180:183], a[44:47]
    v_mfma_f32_16x16x32_bf16 a[48:51], a[144:147], a[184:187], a[48:51]
    buffer_load_dwordx4 v2, s[28:31], s60 offen offset:0 nt lds
    s_add_u32 s65, s65, 8192
    v_readfirstlane_b32 s9, v8
    v_mfma_f32_16x16x32_bf16 a[52:55], a[144:147], a[188:191], a[52:55]
    buffer_load_dwordx4 v3, s[28:31], s60 offen offset:1024 nt lds
    s_add_u32 s67, s67, 1
    s_add_u32 s7, s7, 1
    v_mfma_f32_16x16x32_bf16 a[56:59], a[144:147], a[192:195], a[56:59]
    buffer_load_dwordx4 v2, s[28:31], s60 offen offset:2048 nt lds
    s_add_u32 s66, s66, 16384
    s_lshl4_add_u32 s9, s9, 32
    v_mfma_f32_16x16x32_bf16 a[60:63], a[144:147], a[196:199], a[60:63]
    buffer_load_dwordx4 v3, s[28:31], s60 offen offset:3072 nt lds
    v_mfma_f32_16x16x32_bf16 a[64:67], a[144:147], a[200:203], a[64:67]
    s_min_u32 s6, s6, s9
    v_mfma_f32_16x16x32_bf16 a[68:71], a[144:147], a[204:207], a[68:71]
    s_cmp_eq_u32 s66, 114688
    s_cselect_b32 s66, 0, s66
    s_add_u32 s6, s6, s8
    v_mfma_f32_16x16x32_bf16 v[32:35], a[148:151], a[172:175], v[32:35]
    s_add_u32 s60, s65, 0
    s_lshr_b32 s9, s6, 4
    v_mfma_f32_16x16x32_bf16 v[36:39], a[148:151], a[176:179], v[36:39]
    s_min_u32 s9, s9, s7
    v_mfma_f32_16x16x32_bf16 v[40:43], a[148:151], a[180:183], v[40:43]
    ds_read_b32 v8, v7
    s_add_u32 m0, s66, 0
    v_mfma_f32_16x16x32_bf16 v[44:47], a[148:151], a[184:187], v[44:47]
    s_waitcnt vmcnt(16)
    v_mov_b32 v9, s9
    v_mfma_f32_16x16x32_bf16 v[48:51], a[148:151], a[188:191], v[48:51]
    ds_write_b32 v6, v9
    v_mfma_f32_16x16x32_bf16 v[52:55], a[148:151], a[192:195], v[52:55]
    s_waitcnt lgkmcnt(0)
    v_cmp_gt_u32 vcc, s67, v8
    s_cbranch_vccnz L_pc103
L_pc103r:
    v_mfma_f32_16x16x32_bf16 v[56:59], a[148:151], a[196:199], v[56:59]
    buffer_load_dwordx4 v2, s[24:27], s60 offen offset:0 nt lds
    v_mfma_f32_16x16x32_bf16 v[60:63], a[148:151], a[200:203], v[60:63]
    buffer_load_dwordx4 v3, s[24:27], s60 offen offset:1024 nt lds
    v_mfma_f32_16x16x32_bf16 v[64:67], a[148:151], a[204:207], v[64:67]
    buffer_load_dwordx4 v2, s[24:27], s60 offen offset:2048 nt lds
    v_mfma_f32_16x16x32_bf16 v[68:71], a[152:155], a[172:175], v[68:71]
    buffer_load_dwordx4 v3, s[24:27], s60 offen offset:3072 nt lds
    v_mfma_f32_16x16x32_bf16 v[72:75], a[152:155], a[176:179], v[72:75]
    v_mfma_f32_16x16x32_bf16 v[76:79], a[152:155], a[180:183], v[76:79]
    v_mfma_f32_16x16x32_bf16 v[80:83], a[152:155], a[184:187], v[80:83]
    s_add_u32 s60, s65, 4096
    v_mfma_f32_16x16x32_bf16 v[84:87], a[152:155], a[188:191], v[84:87]
    v_mfma_f32_16x16x32_bf16 v[88:91], a[152:155], a[192:195], v[88:91]
    s_add_u32 m0, s66, 4096
    v_mfma_f32_16x16x32_bf16 v[92:95], a[152:155], a[196:199], v[92:95]
    s_waitcnt vmcnt(16)
    v_mfma_f32_16x16x32_bf16 v[96:99], a[152:155], a[200:203], v[96:99]
    v_mfma_f32_16x16x32_bf16 v[100:103], a[152:155], a[204:207], v[100:103]
    v_mfma_f32_16x16x32_bf16 v[104:107], a[156:159], a[172:175], v[104:107]
    buffer_load_dwordx4 v2, s[24:27], s60 offen offset:0 nt lds
    v_mfma_f32_16x16x32_bf16 v[108:111], a[156:159], a[176:179], v[108:111]
    buffer_load_dwordx4 v3, s[24:27], s60 offen offset:1024 nt lds
    v_mfma_f32_16x16x32_bf16 v[112:115], a[156:159], a[180:183], v[112:115]
    buffer_load_dwordx4 v2, s[24:27], s60 offen offset:2048 nt lds
    v_mfma_f32_16x16x32_bf16 v[116:119], a[156:159], a[184:187], v[116:119]
    buffer_load_dwordx4 v3, s[24:27], s60 offen offset:3072 nt lds
    v_mfma_f32_16x16x32_bf16 v[120:123], a[156:159], a[188:191], v[120:123]
    v_mfma_f32_16x16x32_bf16 v[124:127], a[156:159], a[192:195], v[124:127]
    v_mfma_f32_16x16x32_bf16 v[128:131], a[156:159], a[196:199], v[128:131]
    s_sub_u32 s60, s65, 8192
    v_mfma_f32_16x16x32_bf16 v[132:135], a[156:159], a[200:203], v[132:135]
    v_mfma_f32_16x16x32_bf16 v[136:139], a[156:159], a[204:207], v[136:139]
    s_add_u32 m0, s66, 8192
    v_mfma_f32_16x16x32_bf16 v[140:143], a[160:163], a[172:175], v[140:143]
    s_waitcnt vmcnt(16)
    v_mfma_f32_16x16x32_bf16 v[144:147], a[160:163], a[176:179], v[144:147]
    v_mfma_f32_16x16x32_bf16 v[148:151], a[160:163], a[180:183], v[148:151]
    v_mfma_f32_16x16x32_bf16 v[152:155], a[160:163], a[184:187], v[152:155]
    buffer_load_dwordx4 v2, s[28:31], s60 offen offset:0 nt lds
    v_mfma_f32_16x16x32_bf16 v[156:159], a[160:163], a[188:191], v[156:159]
    buffer_load_dwordx4 v3, s[28:31], s60 offen offset:1024 nt lds
    v_mfma_f32_16x16x32_bf16 v[160:163], a[160:163], a[192:195], v[160:163]
    buffer_load_dwordx4 v2, s[28:31], s60 offen offset:2048 nt lds
    v_mfma_f32_16x16x32_bf16 v[164:167], a[160:163], a[196:199], v[164:167]
    buffer_load_dwordx4 v3, s[28:31], s60 offen offset:3072 nt lds
    v_mfma_f32_16x16x32_bf16 v[168:171], a[160:163], a[200:203], v[168:171]
    v_mfma_f32_16x16x32_bf16 v[172:175], a[160:163], a[204:207], v[172:175]
    v_mfma_f32_16x16x32_bf16 v[176:179], a[164:167], a[172:175], v[176:179]
    s_sub_u32 s60, s65, 4096
    v_mfma_f32_16x16x32_bf16 v[180:183], a[164:167], a[176:179], v[180:183]
    v_mfma_f32_16x16x32_bf16 v[184:187], a[164:167], a[180:183], v[184:187]
    s_add_u32 m0, s66, 12288
    v_mfma_f32_16x16x32_bf16 v[188:191], a[164:167], a[184:187], v[188:191]
    s_waitcnt vmcnt(16)
    v_mfma_f32_16x16x32_bf16 v[192:195], a[164:167], a[188:191], v[192:195]
    v_mfma_f32_16x16x32_bf16 v[196:199], a[164:167], a[192:195], v[196:199]
    v_mfma_f32_16x16x32_bf16 v[200:203], a[164:167], a[196:199], v[200:203]
    buffer_load_dwordx4 v2, s[28:31], s60 offen offset:0 nt lds
    s_add_u32 s65, s65, 8192
    v_readfirstlane_b32 s9, v8
    v_mfma_f32_16x16x32_bf16 v[204:207], a[164:167], a[200:203], v[204:207]
    buffer_load_dwordx4 v3, s[28:31], s60 offen offset:1024 nt lds
    s_add_u32 s67, s67, 1
    s_add_u32 s7, s7, 1
    v_mfma_f32_16x16x32_bf16 v[208:211], a[164:167], a[204:207], v[208:211]
    buffer_load_dwordx4 v2, s[28:31], s60 offen offset:2048 nt lds
    s_add_u32 s66, s66, 16384
    s_lshl4_add_u32 s9, s9, 32
    v_mfma_f32_16x16x32_bf16 v[212:215], a[168:171], a[172:175], v[212:215]
    buffer_load_dwordx4 v3, s[28:31], s60 offen offset:3072 nt lds
    v_mfma_f32_16x16x32_bf16 v[216:219], a[168:171], a[176:179], v[216:219]
    s_min_u32 s6, s6, s9
    v_mfma_f32_16x16x32_bf16 v[220:223], a[168:171], a[180:183], v[220:223]
    s_cmp_eq_u32 s66, 114688
    s_cselect_b32 s66, 0, s66
    s_add_u32 s6, s6, s8
    v_mfma_f32_16x16x32_bf16 v[224:227], a[168:171], a[184:187], v[224:227]
    s_add_u32 s60, s65, 0
    s_lshr_b32 s9, s6, 4
    v_mfma_f32_16x16x32_bf16 v[228:231], a[168:171], a[188:191], v[228:231]
    s_min_u32 s9, s9, s7
    v_mfma_f32_16x16x32_bf16 v[232:235], a[168:171], a[192:195], v[232:235]
    ds_read_b32 v8, v7
    s_add_u32 m0, s66, 0
    v_mfma_f32_16x16x32_bf16 v[236:239], a[168:171], a[196:199], v[236:239]
    s_waitcnt vmcnt(16)
    v_mov_b32 v9, s9
    v_mfma_f32_16x16x32_bf16 v[240:243], a[168:171], a[200:203], v[240:243]
    ds_write_b32 v6, v9
    v_mfma_f32_16x16x32_bf16 v[244:247], a[168:171], a[204:207], v[244:247]
    s_waitcnt lgkmcnt(0)
    v_cmp_gt_u32 vcc, s67, v8
    s_cbranch_vccnz L_pc104
L_pc104r:
    buffer_load_dwordx4 v2, s[24:27], s60 offen offset:0 nt lds
    buffer_load_dwordx4 v3, s[24:27], s60 offen offset:1024 nt lds
    buffer_load_dwordx4 v2, s[24:27], s60 offen offset:2048 nt lds
    buffer_load_dwordx4 v3, s[24:27], s60 offen offset:3072 nt lds
    s_add_u32 s60, s65, 4096
    s_add_u32 m0, s66, 4096
    v_add_u32 v30, 122880, v5
    s_nop 3
    v_pk_mul_f32 v[32:33], v[32:33], v[26:27]
    v_pk_mul_f32 v[34:35], v[34:35], v[26:27]
    v_pk_mul_f32 v[68:69], v[68:69], v[26:27]
    v_pk_mul_f32 v[70:71], v[70:71], v[26:27]
    v_cvt_pk_bf16_f32 v248, v32, v33
    v_cvt_pk_bf16_f32 v249, v34, v35
    v_cvt_pk_bf16_f32 v250, v68, v69
    v_cvt_pk_bf16_f32 v251, v70, v71
    ds_write_b128 v30, v[248:251] offset:1024
    v_pk_mul_f32 v[36:37], v[36:37], v[26:27]
    v_pk_mul_f32 v[38:39], v[38:39], v[26:27]
    v_pk_mul_f32 v[72:73], v[72:73], v[26:27]
    v_pk_mul_f32 v[74:75], v[74:75], v[26:27]
    v_cvt_pk_bf16_f32 v252, v36, v37
    v_cvt_pk_bf16_f32 v253, v38, v39
    v_cvt_pk_bf16_f32 v254, v72, v73
    v_cvt_pk_bf16_f32 v255, v74, v75
    ds_write_b128 v30, v[252:255] offset:5120
    v_pk_mul_f32 v[40:41], v[40:41], v[26:27]
    v_pk_mul_f32 v[42:43], v[42:43], v[26:27]
    v_pk_mul_f32 v[76:77], v[76:77], v[26:27]
    v_pk_mul_f32 v[78:79], v[78:79], v[26:27]
    v_cvt_pk_bf16_f32 v248, v40, v41
    v_cvt_pk_bf16_f32 v249, v42, v43
    v_cvt_pk_bf16_f32 v250, v76, v77
    v_cvt_pk_bf16_f32 v251, v78, v79
    ds_write_b128 v30, v[248:251] offset:9216
    v_pk_mul_f32 v[44:45], v[44:45], v[26:27]
    v_pk_mul_f32 v[46:47], v[46:47], v[26:27]
    v_pk_mul_f32 v[80:81], v[80:81], v[26:27]
    v_pk_mul_f32 v[82:83], v[82:83], v[26:27]
    s_waitcnt vmcnt(16)
    buffer_load_dwordx4 v2, s[24:27], s60 offen offset:0 nt lds
    buffer_load_dwordx4 v3, s[24:27], s60 offen offset:1024 nt lds
    buffer_load_dwordx4 v2, s[24:27], s60 offen offset:2048 nt lds
    buffer_load_dwordx4 v3, s[24:27], s60 offen offset:3072 nt lds
    s_sub_u32 s60, s65, 8192
    s_add_u32 m0, s66, 8192
    v_cvt_pk_bf16_f32 v252, v44, v45
    v_cvt_pk_bf16_f32 v253, v46, v47
    v_cvt_pk_bf16_f32 v254, v80, v81
    v_cvt_pk_bf16_f32 v255, v82, v83
    ds_write_b128 v30, v[252:255] offset:13312
    v_pk_mul_f32 v[48:49], v[48:49], v[26:27]
    v_pk_mul_f32 v[50:51], v[50:51], v[26:27]
    v_pk_mul_f32 v[84:85], v[84:85], v[26:27]
    v_pk_mul_f32 v[86:87], v[86:87], v[26:27]
    v_cvt_pk_bf16_f32 v248, v48, v49
    v_cvt_pk_bf16_f32 v249, v50, v51
    v_cvt_pk_bf16_f32 v250, v84, v85
    v_cvt_pk_bf16_f32 v251, v86, v87
    ds_write_b128 v30, v[248:251] offset:17408
    v_pk_mul_f32 v[52:53], v[52:53], v[26:27]
    v_pk_mul_f32 v[54:55], v[54:55], v[26:27]
    v_pk_mul_f32 v[88:89], v[88:89], v[26:27]
    v_pk_mul_f32 v[90:91], v[90:91], v[26:27]
    v_cvt_pk_bf16_f32 v252, v52, v53
    v_cvt_pk_bf16_f32 v253, v54, v55
    v_cvt_pk_bf16_f32 v254, v88, v89
    v_cvt_pk_bf16_f32 v255, v90, v91
    ds_write_b128 v30, v[252:255] offset:21504
    v_pk_mul_f32 v[56:57], v[56:57], v[26:27]
    v_pk_mul_f32 v[58:59], v[58:59], v[26:27]
    v_pk_mul_f32 v[92:93], v[92:93], v[26:27]
    v_pk_mul_f32 v[94:95], v[94:95], v[26:27]
    v_cvt_pk_bf16_f32 v248, v56, v57
    v_cvt_pk_bf16_f32 v249, v58, v59
    v_cvt_pk_bf16_f32 v250, v92, v93
    v_cvt_pk_bf16_f32 v251, v94, v95
    ds_write_b128 v30, v[248:251] offset:25600
    v_pk_mul_f32 v[60:61], v[60:61], v[26:27]
    s_waitcnt vmcnt(16)
    buffer_load_dwordx4 v2, s[28:31], s60 offen offset:0 nt lds
    buffer_load_dwordx4 v3, s[28:31], s60 offen offset:1024 nt lds
    buffer_load_dwordx4 v2, s[28:31], s60 offen offset:2048 nt lds
    buffer_load_dwordx4 v3, s[28:31], s60 offen offset:3072 nt lds
    s_sub_u32 s60, s65, 4096
    s_add_u32 m0, s66, 12288
    v_pk_mul_f32 v[62:63], v[62:63], v[26:27]
    v_pk_mul_f32 v[96:97], v[96:97], v[26:27]
    v_pk_mul_f32 v[98:99], v[98:99], v[26:27]
    v_cvt_pk_bf16_f32 v252, v60, v61
    v_cvt_pk_bf16_f32 v253, v62, v63
    v_cvt_pk_bf16_f32 v254, v96, v97
    v_cvt_pk_bf16_f32 v255, v98, v99
    ds_write_b128 v30, v[252:255] offset:29696
    v_pk_mul_f32 v[64:65], v[64:65], v[26:27]
    v_pk_mul_f32 v[66:67], v[66:67], v[26:27]
    v_pk_mul_f32 v[100:101], v[100:101], v[26:27]
    v_pk_mul_f32 v[102:103], v[102:103], v[26:27]
    v_cvt_pk_bf16_f32 v248, v64, v65
    v_cvt_pk_bf16_f32 v249, v66, v67
    v_cvt_pk_bf16_f32 v250, v100, v101
    v_cvt_pk_bf16_f32 v251, v102, v103
    ds_write_b128 v30, v[248:251] offset:33792
    v_pk_mul_f32 v[104:105], v[104:105], v[26:27]
    v_pk_mul_f32 v[106:107], v[106:107], v[26:27]
    v_pk_mul_f32 v[140:141], v[140:141], v[26:27]
    v_pk_mul_f32 v[142:143], v[142:143], v[26:27]
    v_cvt_pk_bf16_f32 v252, v104, v105
    v_cvt_pk_bf16_f32 v253, v106, v107
    v_cvt_pk_bf16_f32 v254, v140, v141
    v_cvt_pk_bf16_f32 v255, v142, v143
    ds_write_b128 v30, v[252:255] offset:2048
    v_pk_mul_f32 v[108:109], v[108:109], v[26:27]
    v_pk_mul_f32 v[110:111], v[110:111], v[26:27]
    v_pk_mul_f32 v[144:145], v[144:145], v[26:27]
    v_pk_mul_f32 v[146:147], v[146:147], v[26:27]
    v_cvt_pk_bf16_f32 v248, v108, v109
    v_cvt_pk_bf16_f32 v249, v110, v111
    v_cvt_pk_bf16_f32 v250, v144, v145
    s_waitcnt vmcnt(16)
    buffer_load_dwordx4 v2, s[28:31], s60 offen offset:0 nt lds
    s_add_u32 s65, s65, 8192
    v_readfirstlane_b32 s9, v8
    buffer_load_dwordx4 v3, s[28:31], s60 offen offset:1024 nt lds
    s_add_u32 s67, s67, 1
    s_add_u32 s7, s7, 1
    buffer_load_dwordx4 v2, s[28:31], s60 offen offset:2048 nt lds
    s_add_u32 s66, s66, 16384
    s_lshl4_add_u32 s9, s9, 32
    buffer_load_dwordx4 v3, s[28:31], s60 offen offset:3072 nt lds
    s_min_u32 s6, s6, s9
    s_cmp_eq_u32 s66, 114688
    s_cselect_b32 s66, 0, s66
    s_add_u32 s6, s6, s8
    s_add_u32 s60, s65, 0
    s_lshr_b32 s9, s6, 4
    s_min_u32 s9, s9, s7
    ds_read_b32 v8, v7
    s_add_u32 m0, s66, 0
    v_cvt_pk_bf16_f32 v251, v146, v147
    ds_write_b128 v30, v[248:251] offset:6144
    v_pk_mul_f32 v[112:113], v[112:113], v[26:27]
    v_pk_mul_f32 v[114:115], v[114:115], v[26:27]
    v_pk_mul_f32 v[148:149], v[148:149], v[26:27]
    v_pk_mul_f32 v[150:151], v[150:151], v[26:27]
    v_cvt_pk_bf16_f32 v252, v112, v113
    v_cvt_pk_bf16_f32 v253, v114, v115
    v_cvt_pk_bf16_f32 v254, v148, v149
    v_cvt_pk_bf16_f32 v255, v150, v151
    ds_write_b128 v30, v[252:255] offset:10240
    v_pk_mul_f32 v[116:117], v[116:117], v[26:27]
    v_pk_mul_f32 v[118:119], v[118:119], v[26:27]
    v_pk_mul_f32 v[152:153], v[152:153], v[26:27]
    v_pk_mul_f32 v[154:155], v[154:155], v[26:27]
    v_cvt_pk_bf16_f32 v248, v116, v117
    v_cvt_pk_bf16_f32 v249, v118, v119
    v_cvt_pk_bf16_f32 v250, v152, v153
    v_cvt_pk_bf16_f32 v251, v154, v155
    ds_write_b128 v30, v[248:251] offset:14336
    v_pk_mul_f32 v[120:121], v[120:121], v[26:27]
    v_pk_mul_f32 v[122:123], v[122:123], v[26:27]
    v_pk_mul_f32 v[156:157], v[156:157], v[26:27]
    v_pk_mul_f32 v[158:159], v[158:159], v[26:27]
    v_cvt_pk_bf16_f32 v252, v120, v121
    v_cvt_pk_bf16_f32 v253, v122, v123
    v_cvt_pk_bf16_f32 v254, v156, v157
    v_cvt_pk_bf16_f32 v255, v158, v159
    ds_write_b128 v30, v[252:255] offset:18432
    v_pk_mul_f32 v[124:125], v[124:125], v[26:27]
    v_pk_mul_f32 v[126:127], v[126:127], v[26:27]
    v_pk_mul_f32 v[160:161], v[160:161], v[26:27]
    v_pk_mul_f32 v[162:163], v[162:163], v[26:27]
    s_waitcnt vmcnt(16)
    v_mov_b32 v9, s9
    ds_write_b32 v6, v9
    s_waitcnt lgkmcnt(0)
    v_cmp_gt_u32 vcc, s67, v8
    s_cbranch_vccnz L_pc105
L_pc105r:
    buffer_load_dwordx4 v2, s[24:27], s60 offen offset:0 nt lds
    buffer_load_dwordx4 v3, s[24:27], s60 offen offset:1024 nt lds
    buffer_load_dwordx4 v2, s[24:27], s60 offen offset:2048 nt lds
    buffer_load_dwordx4 v3, s[24:27], s60 offen offset:3072 nt lds
    s_add_u32 s60, s65, 4096
    s_add_u32 m0, s66, 4096
    v_cvt_pk_bf16_f32 v248, v124, v125
    v_cvt_pk_bf16_f32 v249, v126, v127
    v_cvt_pk_bf16_f32 v250, v160, v161
    v_cvt_pk_bf16_f32 v251, v162, v163
    ds_write_b128 v30, v[248:251] offset:22528
    v_pk_mul_f32 v[128:129], v[128:129], v[26:27]
    v_pk_mul_f32 v[130:131], v[130:131], v[26:27]
    v_pk_mul_f32 v[164:165], v[164:165], v[26:27]
    v_pk_mul_f32 v[166:167], v[166:167], v[26:27]
    v_cvt_pk_bf16_f32 v252, v128, v129
    v_cvt_pk_bf16_f32 v253, v130, v131
    v_cvt_pk_bf16_f32 v254, v164, v165
    v_cvt_pk_bf16_f32 v255, v166, v167
    ds_write_b128 v30, v[252:255] offset:26624
    v_pk_mul_f32 v[132:133], v[132:133], v[26:27]
    v_pk_mul_f32 v[134:135], v[134:135], v[26:27]
    v_pk_mul_f32 v[168:169], v[168:169], v[26:27]
    v_pk_mul_f32 v[170:171], v[170:171], v[26:27]
    v_cvt_pk_bf16_f32 v248, v132, v133
    v_cvt_pk_bf16_f32 v249, v134, v135
    v_cvt_pk_bf16_f32 v250, v168, v169
    v_cvt_pk_bf16_f32 v251, v170, v171
    ds_write_b128 v30, v[248:251] offset:30720
    v_pk_mul_f32 v[136:137], v[136:137], v[26:27]
    v_pk_mul_f32 v[138:139], v[138:139], v[26:27]
    v_pk_mul_f32 v[172:173], v[172:173], v[26:27]
    v_pk_mul_f32 v[174:175], v[174:175], v[26:27]
    v_cvt_pk_bf16_f32 v252, v136, v137
    v_cvt_pk_bf16_f32 v253, v138, v139
    v_cvt_pk_bf16_f32 v254, v172, v173
    v_cvt_pk_bf16_f32 v255, v174, v175
    ds_write_b128 v30, v[252:255] offset:34816
    v_pk_mul_f32 v[176:177], v[176:177], v[26:27]
    s_waitcnt vmcnt(16)
    buffer_load_dwordx4 v2, s[24:27], s60 offen offset:0 nt lds
    buffer_load_dwordx4 v3, s[24:27], s60 offen offset:1024 nt lds
    buffer_load_dwordx4 v2, s[24:27], s60 offen offset:2048 nt lds
    buffer_load_dwordx4 v3, s[24:27], s60 offen offset:3072 nt lds
    s_sub_u32 s60, s65, 8192
    s_add_u32 m0, s66, 8192
    v_pk_mul_f32 v[178:179], v[178:179], v[26:27]
    v_pk_mul_f32 v[212:213], v[212:213], v[26:27]
    v_pk_mul_f32 v[214:215], v[214:215], v[26:27]
    v_cvt_pk_bf16_f32 v248, v176, v177
    v_cvt_pk_bf16_f32 v249, v178, v179
    v_cvt_pk_bf16_f32 v250, v212, v213
    v_cvt_pk_bf16_f32 v251, v214, v215
    ds_write_b128 v30, v[248:251] offset:3072
    v_pk_mul_f32 v[180:181], v[180:181], v[26:27]
    v_pk_mul_f32 v[182:183], v[182:183], v[26:27]
    v_pk_mul_f32 v[216:217], v[216:217], v[26:27]
    v_pk_mul_f32 v[218:219], v[218:219], v[26:27]
    v_cvt_pk_bf16_f32 v252, v180, v181
    v_cvt_pk_bf16_f32 v253, v182, v183
    v_cvt_pk_bf16_f32 v254, v216, v217
    v_cvt_pk_bf16_f32 v255, v218, v219
    ds_write_b128 v30, v[252:255] offset:7168
    v_pk_mul_f32 v[184:185], v[184:185], v[26:27]
    v_pk_mul_f32 v[186:187], v[186:187], v[26:27]
    v_pk_mul_f32 v[220:221], v[220:221], v[26:27]
    v_pk_mul_f32 v[222:223], v[222:223], v[26:27]
    v_cvt_pk_bf16_f32 v248, v184, v185
    v_cvt_pk_bf16_f32 v249, v186, v187
    v_cvt_pk_bf16_f32 v250, v220, v221
    v_cvt_pk_bf16_f32 v251, v222, v223
    ds_write_b128 v30, v[248:251] offset:11264
    v_pk_mul_f32 v[188:189], v[188:189], v[26:27]
    v_pk_mul_f32 v[190:191], v[190:191], v[26:27]
    v_pk_mul_f32 v[224:225], v[224:225], v[26:27]
    v_pk_mul_f32 v[226:227], v[226:227], v[26:27]
    v_cvt_pk_bf16_f32 v252, v188, v189
    v_cvt_pk_bf16_f32 v253, v190, v191
    v_cvt_pk_bf16_f32 v254, v224, v225
    s_waitcnt vmcnt(16)
    buffer_load_dwordx4 v2, s[28:31], s60 offen offset:0 nt lds
    buffer_load_dwordx4 v3, s[28:31], s60 offen offset:1024 nt lds
    buffer_load_dwordx4 v2, s[28:31], s60 offen offset:2048 nt lds
    buffer_load_dwordx4 v3, s[28:31], s60 offen offset:3072 nt lds
    s_sub_u32 s60, s65, 4096
    s_add_u32 m0, s66, 12288
    v_cvt_pk_bf16_f32 v255, v226, v227
    ds_write_b128 v30, v[252:255] offset:15360
    v_pk_mul_f32 v[192:193], v[192:193], v[26:27]
    v_pk_mul_f32 v[194:195], v[194:195], v[26:27]
    v_pk_mul_f32 v[228:229], v[228:229], v[26:27]
    v_pk_mul_f32 v[230:231], v[230:231], v[26:27]
    v_cvt_pk_bf16_f32 v248, v192, v193
    v_cvt_pk_bf16_f32 v249, v194, v195
    v_cvt_pk_bf16_f32 v250, v228, v229
    v_cvt_pk_bf16_f32 v251, v230, v231
    ds_write_b128 v30, v[248:251] offset:19456
    v_pk_mul_f32 v[196:197], v[196:197], v[26:27]
    v_pk_mul_f32 v[198:199], v[198:199], v[26:27]
    v_pk_mul_f32 v[232:233], v[232:233], v[26:27]
    v_pk_mul_f32 v[234:235], v[234:235], v[26:27]
    v_cvt_pk_bf16_f32 v252, v196, v197
    v_cvt_pk_bf16_f32 v253, v198, v199
    v_cvt_pk_bf16_f32 v254, v232, v233
    v_cvt_pk_bf16_f32 v255, v234, v235
    ds_write_b128 v30, v[252:255] offset:23552
    v_pk_mul_f32 v[200:201], v[200:201], v[26:27]
    v_pk_mul_f32 v[202:203], v[202:203], v[26:27]
    v_pk_mul_f32 v[236:237], v[236:237], v[26:27]
    v_pk_mul_f32 v[238:239], v[238:239], v[26:27]
    v_cvt_pk_bf16_f32 v248, v200, v201
    v_cvt_pk_bf16_f32 v249, v202, v203
    v_cvt_pk_bf16_f32 v250, v236, v237
    v_cvt_pk_bf16_f32 v251, v238, v239
    ds_write_b128 v30, v[248:251] offset:27648
    v_pk_mul_f32 v[204:205], v[204:205], v[26:27]
    v_pk_mul_f32 v[206:207], v[206:207], v[26:27]
    v_pk_mul_f32 v[240:241], v[240:241], v[26:27]
    v_pk_mul_f32 v[242:243], v[242:243], v[26:27]
    s_waitcnt vmcnt(16)
    buffer_load_dwordx4 v2, s[28:31], s60 offen offset:0 nt lds
    s_add_u32 s65, s65, 8192
    v_readfirstlane_b32 s9, v8
    buffer_load_dwordx4 v3, s[28:31], s60 offen offset:1024 nt lds
    s_add_u32 s67, s67, 1
    s_add_u32 s7, s7, 1
    buffer_load_dwordx4 v2, s[28:31], s60 offen offset:2048 nt lds
    s_add_u32 s66, s66, 16384
    s_lshl4_add_u32 s9, s9, 32
    buffer_load_dwordx4 v3, s[28:31], s60 offen offset:3072 nt lds
    s_min_u32 s6, s6, s9
    s_cmp_eq_u32 s66, 114688
    s_cselect_b32 s66, 0, s66
    s_add_u32 s6, s6, s8
    s_add_u32 s60, s65, 0
    s_lshr_b32 s9, s6, 4
    s_min_u32 s9, s9, s7
    ds_read_b32 v8, v7
    s_add_u32 m0, s66, 0
    v_cvt_pk_bf16_f32 v252, v204, v205
    v_cvt_pk_bf16_f32 v253, v206, v207
    v_cvt_pk_bf16_f32 v254, v240, v241
    v_cvt_pk_bf16_f32 v255, v242, v243
    ds_write_b128 v30, v[252:255] offset:31744
    v_pk_mul_f32 v[208:209], v[208:209], v[26:27]
    v_pk_mul_f32 v[210:211], v[210:211], v[26:27]
    v_pk_mul_f32 v[244:245], v[244:245], v[26:27]
    v_pk_mul_f32 v[246:247], v[246:247], v[26:27]
    v_cvt_pk_bf16_f32 v248, v208, v209
    v_cvt_pk_bf16_f32 v249, v210, v211
    v_cvt_pk_bf16_f32 v250, v244, v245
    v_cvt_pk_bf16_f32 v251, v246, v247
    ds_write_b128 v30, v[248:251] offset:35840
    v_accvgpr_read_b32 v32, a0
    v_accvgpr_read_b32 v36, a36
    v_accvgpr_read_b32 v33, a1
    v_accvgpr_read_b32 v37, a37
    v_accvgpr_read_b32 v34, a2
    v_accvgpr_read_b32 v38, a38
    v_accvgpr_read_b32 v35, a3
    v_accvgpr_read_b32 v39, a39
    v_pk_mul_f32 v[32:33], v[32:33], v[26:27]
    v_pk_mul_f32 v[34:35], v[34:35], v[26:27]
    v_pk_mul_f32 v[36:37], v[36:37], v[26:27]
    v_pk_mul_f32 v[38:39], v[38:39], v[26:27]
    v_cvt_pk_bf16_f32 v252, v32, v33
    v_cvt_pk_bf16_f32 v253, v34, v35
    v_cvt_pk_bf16_f32 v254, v36, v37
    v_cvt_pk_bf16_f32 v255, v38, v39
    ds_write_b128 v30, v[252:255] offset:0
    v_accvgpr_read_b32 v40, a4
    v_accvgpr_read_b32 v44, a40
    v_accvgpr_read_b32 v41, a5
    s_waitcnt vmcnt(16)
    v_mov_b32 v9, s9
    ds_write_b32 v6, v9
    s_waitcnt lgkmcnt(0)
    v_cmp_gt_u32 vcc, s67, v8
    s_cbranch_vccnz L_pc106
L_pc106r:
    buffer_load_dwordx4 v2, s[24:27], s60 offen offset:0 nt lds
    buffer_load_dwordx4 v3, s[24:27], s60 offen offset:1024 nt lds
    buffer_load_dwordx4 v2, s[24:27], s60 offen offset:2048 nt lds
    buffer_load_dwordx4 v3, s[24:27], s60 offen offset:3072 nt lds
    s_add_u32 s60, s65, 4096
    s_add_u32 m0, s66, 4096
    v_accvgpr_read_b32 v45, a41
    v_accvgpr_read_b32 v42, a6
    v_accvgpr_read_b32 v46, a42
    v_accvgpr_read_b32 v43, a7
    v_accvgpr_read_b32 v47, a43
    v_pk_mul_f32 v[40:41], v[40:41], v[26:27]
    v_pk_mul_f32 v[42:43], v[42:43], v[26:27]
    v_pk_mul_f32 v[44:45], v[44:45], v[26:27]
    v_pk_mul_f32 v[46:47], v[46:47], v[26:27]
    v_cvt_pk_bf16_f32 v248, v40, v41
    v_cvt_pk_bf16_f32 v249, v42, v43
    v_cvt_pk_bf16_f32 v250, v44, v45
    v_cvt_pk_bf16_f32 v251, v46, v47
    ds_write_b128 v30, v[248:251] offset:4096
    v_accvgpr_read_b32 v32, a8
    v_accvgpr_read_b32 v36, a44
    v_accvgpr_read_b32 v33, a9
    v_accvgpr_read_b32 v37, a45
    v_accvgpr_read_b32 v34, a10
    v_accvgpr_read_b32 v38, a46
    v_accvgpr_read_b32 v35, a11
    v_accvgpr_read_b32 v39, a47
    v_pk_mul_f32 v[32:33], v[32:33], v[26:27]
    v_pk_mul_f32 v[34:35], v[34:35], v[26:27]
    v_pk_mul_f32 v[36:37], v[36:37], v[26:27]
    v_pk_mul_f32 v[38:39], v[38:39], v[26:27]
    v_cvt_pk_bf16_f32 v252, v32, v33
    v_cvt_pk_bf16_f32 v253, v34, v35
    v_cvt_pk_bf16_f32 v254, v36, v37
    v_cvt_pk_bf16_f32 v255, v38, v39
    ds_write_b128 v30, v[252:255] offset:8192
    v_accvgpr_read_b32 v40, a12
    v_accvgpr_read_b32 v44, a48
    s_waitcnt vmcnt(16)
    buffer_load_dwordx4 v2, s[24:27], s60 offen offset:0 nt lds
    buffer_load_dwordx4 v3, s[24:27], s60 offen offset:1024 nt lds
    buffer_load_dwordx4 v2, s[24:27], s60 offen offset:2048 nt lds
    buffer_load_dwordx4 v3, s[24:27], s60 offen offset:3072 nt lds
    s_sub_u32 s60, s65, 8192
    s_add_u32 m0, s66, 8192
    v_accvgpr_read_b32 v41, a13
    v_accvgpr_read_b32 v45, a49
    v_accvgpr_read_b32 v42, a14
    v_accvgpr_read_b32 v46, a50
    v_accvgpr_read_b32 v43, a15
    v_accvgpr_read_b32 v47, a51
    v_pk_mul_f32 v[40:41], v[40:41], v[26:27]
    v_pk_mul_f32 v[42:43], v[42:43], v[26:27]
    v_pk_mul_f32 v[44:45], v[44:45], v[26:27]
    v_pk_mul_f32 v[46:47], v[46:47], v[26:27]
    v_cvt_pk_bf16_f32 v248, v40, v41
    v_cvt_pk_bf16_f32 v249, v42, v43
    v_cvt_pk_bf16_f32 v250, v44, v45
    v_cvt_pk_bf16_f32 v251, v46, v47
    ds_write_b128 v30, v[248:251] offset:12288
    v_accvgpr_read_b32 v32, a16
    v_accvgpr_read_b32 v36, a52
    v_accvgpr_read_b32 v33, a17
    v_accvgpr_read_b32 v37, a53
    v_accvgpr_read_b32 v34, a18
    v_accvgpr_read_b32 v38, a54
    v_accvgpr_read_b32 v35, a19
    v_accvgpr_read_b32 v39, a55
    v_pk_mul_f32 v[32:33], v[32:33], v[26:27]
    v_pk_mul_f32 v[34:35], v[34:35], v[26:27]
    v_pk_mul_f32 v[36:37], v[36:37], v[26:27]
    v_pk_mul_f32 v[38:39], v[38:39], v[26:27]
    v_cvt_pk_bf16_f32 v252, v32, v33
    v_cvt_pk_bf16_f32 v253, v34, v35
    v_cvt_pk_bf16_f32 v254, v36, v37
    v_cvt_pk_bf16_f32 v255, v38, v39
    ds_write_b128 v30, v[252:255] offset:16384
    v_accvgpr_read_b32 v40, a20
    s_waitcnt vmcnt(16)
    buffer_load_dwordx4 v2, s[28:31], s60 offen offset:0 nt lds
    buffer_load_dwordx4 v3, s[28:31], s60 offen offset:1024 nt lds
    buffer_load_dwordx4 v2, s[28:31], s60 offen offset:2048 nt lds
    buffer_load_dwordx4 v3, s[28:31], s60 offen offset:3072 nt lds
    s_sub_u32 s60, s65, 4096
    s_add_u32 m0, s66, 12288
    v_accvgpr_read_b32 v44, a56
    v_accvgpr_read_b32 v41, a21
    v_accvgpr_read_b32 v45, a57
    v_accvgpr_read_b32 v42, a22
    v_accvgpr_read_b32 v46, a58
    v_accvgpr_read_b32 v43, a23
    v_accvgpr_read_b32 v47, a59
    v_pk_mul_f32 v[40:41], v[40:41], v[26:27]
    v_pk_mul_f32 v[42:43], v[42:43], v[26:27]
    v_pk_mul_f32 v[44:45], v[44:45], v[26:27]
    v_pk_mul_f32 v[46:47], v[46:47], v[26:27]
    v_cvt_pk_bf16_f32 v248, v40, v41
    v_cvt_pk_bf16_f32 v249, v42, v43
    v_cvt_pk_bf16_f32 v250, v44, v45
    v_cvt_pk_bf16_f32 v251, v46, v47
    ds_write_b128 v30, v[248:251] offset:20480
    v_accvgpr_read_b32 v32, a24
    v_accvgpr_read_b32 v36, a60
    v_accvgpr_read_b32 v33, a25
    v_accvgpr_read_b32 v37, a61
    v_accvgpr_read_b32 v34, a26
    v_accvgpr_read_b32 v38, a62
    v_accvgpr_read_b32 v35, a27
    v_accvgpr_read_b32 v39, a63
    v_pk_mul_f32 v[32:33], v[32:33], v[26:27]
    v_pk_mul_f32 v[34:35], v[34:35], v[26:27]
    v_pk_mul_f32 v[36:37], v[36:37], v[26:27]
    v_pk_mul_f32 v[38:39], v[38:39], v[26:27]
    v_cvt_pk_bf16_f32 v252, v32, v33
    v_cvt_pk_bf16_f32 v253, v34, v35
    v_cvt_pk_bf16_f32 v254, v36, v37
    v_cvt_pk_bf16_f32 v255, v38, v39
    ds_write_b128 v30, v[252:255] offset:24576
    s_waitcnt vmcnt(16)
    buffer_load_dwordx4 v2, s[28:31], s60 offen offset:0 nt lds
    s_add_u32 s65, s65, 8192
    v_readfirstlane_b32 s9, v8
    buffer_load_dwordx4 v3, s[28:31], s60 offen offset:1024 nt lds
    s_add_u32 s67, s67, 1
    s_add_u32 s7, s7, 1
    buffer_load_dwordx4 v2, s[28:31], s60 offen offset:2048 nt lds
    s_add_u32 s66, s66, 16384
    s_lshl4_add_u32 s9, s9, 32
    buffer_load_dwordx4 v3, s[28:31], s60 offen offset:3072 nt lds
    s_min_u32 s6, s6, s9
    s_cmp_eq_u32 s66, 114688
    s_cselect_b32 s66, 0, s66
    s_add_u32 s6, s6, s8
    s_add_u32 s60, s65, 0
    s_lshr_b32 s9, s6, 4
    s_min_u32 s9, s9, s7
    ds_read_b32 v8, v7
    s_add_u32 m0, s66, 0
    v_accvgpr_read_b32 v40, a28
    v_accvgpr_read_b32 v44, a64
    v_accvgpr_read_b32 v41, a29
    v_accvgpr_read_b32 v45, a65
    v_accvgpr_read_b32 v42, a30
    v_accvgpr_read_b32 v46, a66
    v_accvgpr_read_b32 v43, a31
    v_accvgpr_read_b32 v47, a67
    v_pk_mul_f32 v[40:41], v[40:41], v[26:27]
    v_pk_mul_f32 v[42:43], v[42:43], v[26:27]
    v_pk_mul_f32 v[44:45], v[44:45], v[26:27]
    v_pk_mul_f32 v[46:47], v[46:47], v[26:27]
    v_cvt_pk_bf16_f32 v248, v40, v41
    v_cvt_pk_bf16_f32 v249, v42, v43
    v_cvt_pk_bf16_f32 v250, v44, v45
    v_cvt_pk_bf16_f32 v251, v46, v47
    ds_write_b128 v30, v[248:251] offset:28672
    v_accvgpr_read_b32 v32, a32
    v_accvgpr_read_b32 v36, a68
    v_accvgpr_read_b32 v33, a33
    v_accvgpr_read_b32 v37, a69
    v_accvgpr_read_b32 v34, a34
    v_accvgpr_read_b32 v38, a70
    v_accvgpr_read_b32 v35, a35
    v_accvgpr_read_b32 v39, a71
    v_pk_mul_f32 v[32:33], v[32:33], v[26:27]
    v_pk_mul_f32 v[34:35], v[34:35], v[26:27]
    v_pk_mul_f32 v[36:37], v[36:37], v[26:27]
    v_pk_mul_f32 v[38:39], v[38:39], v[26:27]
    v_cvt_pk_bf16_f32 v252, v32, v33
    v_cvt_pk_bf16_f32 v253, v34, v35
    v_cvt_pk_bf16_f32 v254, v36, v37
    v_cvt_pk_bf16_f32 v255, v38, v39
    ds_write_b128 v30, v[252:255] offset:32768
    s_waitcnt vmcnt(16)
    v_mov_b32 v9, s9
    ds_write_b32 v6, v9
    s_waitcnt lgkmcnt(0)
    v_cmp_gt_u32 vcc, s67, v8
    s_cbranch_vccnz L_pc107
L_pc107r:
    buffer_load_dwordx4 v2, s[24:27], s60 offen offset:0 nt lds
    buffer_load_dwordx4 v3, s[24:27], s60 offen offset:1024 nt lds
    buffer_load_dwordx4 v2, s[24:27], s60 offen offset:2048 nt lds
    buffer_load_dwordx4 v3, s[24:27], s60 offen offset:3072 nt lds
    s_add_u32 s60, s65, 4096
    s_add_u32 m0, s66, 4096
    s_lshl_b32 s62, s76, 20
    s_lshl_b32 s63, s77, 8
    s_add_u32 s62, s62, s63
    s_add_u32 s32, s12, s62
    s_addc_u32 s33, s13, 0
    s_and_b32 s33, s33, 0xffff
    s_waitcnt vmcnt(16)
    buffer_load_dwordx4 v2, s[24:27], s60 offen offset:0 nt lds
    buffer_load_dwordx4 v3, s[24:27], s60 offen offset:1024 nt lds
    buffer_load_dwordx4 v2, s[24:27], s60 offen offset:2048 nt lds
    buffer_load_dwordx4 v3, s[24:27], s60 offen offset:3072 nt lds
    s_sub_u32 s60, s65, 8192
    s_add_u32 m0, s66, 8192
    s_mov_b32 s34, 1048576
    s_mov_b32 s35, 0x00020000
    s_sub_u32 s34, s34, s63
    s_add_u32 s56, s16, 0
    s_addc_u32 s57, s17, 0
    s_and_b32 s57, s57, 0xffff
    s_mov_b32 s58, 256
    s_waitcnt vmcnt(16)
    buffer_load_dwordx4 v2, s[28:31], s60 offen offset:0 nt lds
    buffer_load_dwordx4 v3, s[28:31], s60 offen offset:1024 nt lds
    buffer_load_dwordx4 v2, s[28:31], s60 offen offset:2048 nt lds
    buffer_load_dwordx4 v3, s[28:31], s60 offen offset:3072 nt lds
    s_sub_u32 s60, s65, 4096
    s_add_u32 m0, s66, 12288
    s_mov_b32 s59, 0x00020000
    v_bfe_u32 v30, v1, 2, 2
    v_lshlrev_b32 v30, 10, v30
    v_lshrrev_b32 v31, 4, v1
    v_lshl_add_u32 v30, v31, 6, v30
    v_and_b32 v31, 3, v1
    s_waitcnt vmcnt(16)
    buffer_load_dwordx4 v2, s[28:31], s60 offen offset:0 nt lds
    s_add_u32 s65, s65, 8192
    v_readfirstlane_b32 s9, v8
    buffer_load_dwordx4 v3, s[28:31], s60 offen offset:1024 nt lds
    s_add_u32 s67, s67, 1
    s_add_u32 s7, s7, 1
    buffer_load_dwordx4 v2, s[28:31], s60 offen offset:2048 nt lds
    s_add_u32 s66, s66, 16384
    s_lshl4_add_u32 s9, s9, 32
    buffer_load_dwordx4 v3, s[28:31], s60 offen offset:3072 nt lds
    s_min_u32 s6, s6, s9
    s_cmp_eq_u32 s66, 114688
    s_cselect_b32 s66, 0, s66
    s_add_u32 s6, s6, s8
    s_add_u32 s60, s65, 0
    s_lshr_b32 s9, s6, 4
    s_min_u32 s9, s9, s7
    ds_read_b32 v8, v7
    s_add_u32 m0, s66, 0
    v_lshl_add_u32 v48, v31, 4, v30
    v_xor_b32 v31, 2, v31
    v_lshl_add_u32 v49, v31, 4, v30
    v_add_u32 v50, 2048, v48
    v_add_u32 v51, 17408, v49
    v_add_u32 v49, 15360, v49
    s_mov_b32 s8, 19
    s_waitcnt vmcnt(16)
    v_mov_b32 v9, s9
    ds_write_b32 v6, v9
    s_waitcnt lgkmcnt(0)
    v_cmp_gt_u32 vcc, s67, v8
    s_cbranch_vccnz L_pc108
L_pc108r:
    buffer_load_dwordx4 v2, s[24:27], s60 offen offset:0 nt lds
    buffer_load_dwordx4 v3, s[24:27], s60 offen offset:1024 nt lds
    buffer_load_dwordx4 v2, s[24:27], s60 offen offset:2048 nt lds
    buffer_load_dwordx4 v3, s[24:27], s60 offen offset:3072 nt lds
    s_add_u32 s60, s65, 4096
    s_add_u32 m0, s66, 4096
    s_add_u32 s61, s77, 0
    s_and_b32 s61, s61, 3
    s_lshl_b32 s36, s61, 18
    s_add_u32 s61, s77, 1
    s_and_b32 s61, s61, 3
    s_lshl_b32 s37, s61, 18
    s_waitcnt vmcnt(16)
    buffer_load_dwordx4 v2, s[24:27], s60 offen offset:0 nt lds
    buffer_load_dwordx4 v3, s[24:27], s60 offen offset:1024 nt lds
    buffer_load_dwordx4 v2, s[24:27], s60 offen offset:2048 nt lds
    buffer_load_dwordx4 v3, s[24:27], s60 offen offset:3072 nt lds
    s_sub_u32 s60, s65, 8192
    s_add_u32 m0, s66, 8192
    s_add_u32 s61, s77, 2
    s_and_b32 s61, s61, 3
    s_lshl_b32 s38, s61, 18
    s_add_u32 s61, s77, 3
    s_and_b32 s61, s61, 3
    s_lshl_b32 s39, s61, 18
    v_bfe_u32 v30, v1, 2, 2
    s_waitcnt vmcnt(16)
    buffer_load_dwordx4 v2, s[28:31], s60 offen offset:0 nt lds
    buffer_load_dwordx4 v3, s[28:31], s60 offen offset:1024 nt lds
    buffer_load_dwordx4 v2, s[28:31], s60 offen offset:2048 nt lds
    buffer_load_dwordx4 v3, s[28:31], s60 offen offset:3072 nt lds
    s_sub_u32 s60, s65, 4096
    s_add_u32 m0, s66, 12288
    v_min_u32 v30, 2, v30
    v_add_u32 v30, s77, v30
    v_add_u32 v30, 1, v30
    v_and_b32 v30, 3, v30
    v_and_b32 v31, 3, v1
    v_min_u32 v31, 2, v31
    v_lshl_add_u32 v31, v30, 2, v31
    s_waitcnt vmcnt(16)
    buffer_load_dwordx4 v2, s[28:31], s60 offen offset:0 nt lds
    s_add_u32 s65, s65, 8192
    v_readfirstlane_b32 s9, v8
    buffer_load_dwordx4 v3, s[28:31], s60 offen offset:1024 nt lds
    s_add_u32 s67, s67, 1
    s_add_u32 s7, s7, 1
    buffer_load_dwordx4 v2, s[28:31], s60 offen offset:2048 nt lds
    s_add_u32 s66, s66, 16384
    s_lshl4_add_u32 s9, s9, 32
    buffer_load_dwordx4 v3, s[28:31], s60 offen offset:3072 nt lds
    s_min_u32 s6, s6, s9
    s_cmp_eq_u32 s66, 114688
    s_cselect_b32 s66, 0, s66
    s_add_u32 s6, s6, s8
    s_add_u32 s60, s65, 0
    s_lshr_b32 s9, s6, 4
    s_min_u32 s9, s9, s7
    ds_read_b32 v8, v7
    s_add_u32 m0, s66, 0
    v_lshlrev_b32 v232, 7, v31
    v_lshlrev_b32 v53, 9, v30
    v_add_u32 v53, 384, v53
    v_mov_b32 v54, 0
    v_mov_b32 v64, 163648
    s_mov_b32 s100, 128
    v_mov_b32 v65, s100
    s_waitcnt vmcnt(16)
    v_mov_b32 v9, s9
    ds_write_b32 v6, v9
    s_waitcnt lgkmcnt(0)
    v_cmp_gt_u32 vcc, s67, v8
    s_cbranch_vccnz L_pc109
L_pc109r:
    buffer_load_dwordx4 v2, s[24:27], s60 offen offset:0 nt lds
    buffer_load_dwordx4 v3, s[24:27], s60 offen offset:1024 nt lds
    buffer_load_dwordx4 v2, s[24:27], s60 offen offset:2048 nt lds
    buffer_load_dwordx4 v3, s[24:27], s60 offen offset:3072 nt lds
    s_add_u32 s60, s65, 4096
    s_add_u32 m0, s66, 4096
    ds_write_b32 v64, v65
    s_lshl_b32 s61, s3, 8
    v_lshrrev_b32 v250, 4, v1
    v_lshlrev_b32 v250, 11, v250
    v_bfe_u32 v251, v1, 2, 2
    v_lshl_add_u32 v250, v251, 6, v250
    s_waitcnt vmcnt(16)
    buffer_load_dwordx4 v2, s[24:27], s60 offen offset:0 nt lds
    buffer_load_dwordx4 v3, s[24:27], s60 offen offset:1024 nt lds
    buffer_load_dwordx4 v2, s[24:27], s60 offen offset:2048 nt lds
    buffer_load_dwordx4 v3, s[24:27], s60 offen offset:3072 nt lds
    s_sub_u32 s60, s65, 8192
    s_add_u32 m0, s66, 8192
    v_add_u32 v250, s61, v250
    v_and_b32 v251, 3, v1
    v_lshl_add_u32 v252, v251, 4, v250
    v_xor_b32 v251, 2, v251
    v_lshl_add_u32 v253, v251, 4, v250
    v_add_u32 v253, 1024, v253
    v_add_u32 v254, 65536, v252
    s_waitcnt vmcnt(16)
    buffer_load_dwordx4 v2, s[28:31], s60 offen offset:0 nt lds
    buffer_load_dwordx4 v3, s[28:31], s60 offen offset:1024 nt lds
    buffer_load_dwordx4 v2, s[28:31], s60 offen offset:2048 nt lds
    buffer_load_dwordx4 v3, s[28:31], s60 offen offset:3072 nt lds
    s_sub_u32 s60, s65, 4096
    s_add_u32 m0, s66, 12288
    v_add_u32 v255, 65536, v253
    s_mul_i32 s61, s3, 3
    s_add_u32 s61, s61, 4
    s_lshr_b32 s62, s61, 2
    s_add_u32 s62, s62, s77
    s_and_b32 s62, s62, 3
    s_mul_i32 s62, s62, 73728
    s_waitcnt vmcnt(16)
    buffer_load_dwordx4 v2, s[28:31], s60 offen offset:0 nt lds
    s_add_u32 s65, s65, 8192
    v_readfirstlane_b32 s9, v8
    buffer_load_dwordx4 v3, s[28:31], s60 offen offset:1024 nt lds
    s_add_u32 s67, s67, 1
    s_add_u32 s7, s7, 1
    buffer_load_dwordx4 v2, s[28:31], s60 offen offset:2048 nt lds
    s_add_u32 s66, s66, 16384
    s_lshl4_add_u32 s9, s9, 32
    buffer_load_dwordx4 v3, s[28:31], s60 offen offset:3072 nt lds
    s_min_u32 s6, s6, s9
    s_cmp_eq_u32 s66, 114688
    s_cselect_b32 s66, 0, s66
    s_add_u32 s6, s6, s8
    s_add_u32 s60, s65, 0
    s_lshr_b32 s9, s6, 4
    s_min_u32 s9, s9, s7
    ds_read_b32 v8, v7
    s_add_u32 m0, s66, 0
    s_and_b32 s61, s61, 3
    s_lshl_b32 s61, s61, 10
    s_add_u32 s61, s61, s62
    s_add_u32 s61, s61, 4096
    v_add_u32 v242, s61, v5
    s_mul_i32 s61, s3, 3
    s_add_u32 s61, s61, 5
    s_waitcnt vmcnt(16)
    v_mov_b32 v9, s9
    ds_write_b32 v6, v9
    s_waitcnt lgkmcnt(0)
    v_cmp_gt_u32 vcc, s67, v8
    s_cbranch_vccnz L_pc110
L_pc110r:
    buffer_load_dwordx4 v2, s[24:27], s60 offen offset:0 nt lds
    buffer_load_dwordx4 v3, s[24:27], s60 offen offset:1024 nt lds
    buffer_load_dwordx4 v2, s[24:27], s60 offen offset:2048 nt lds
    buffer_load_dwordx4 v3, s[24:27], s60 offen offset:3072 nt lds
    s_add_u32 s60, s65, 4096
    s_add_u32 m0, s66, 4096
    s_lshr_b32 s62, s61, 2
    s_add_u32 s62, s62, s77
    s_and_b32 s62, s62, 3
    s_mul_i32 s62, s62, 73728
    s_and_b32 s61, s61, 3
    s_lshl_b32 s61, s61, 10
    s_waitcnt vmcnt(16)
    buffer_load_dwordx4 v2, s[24:27], s60 offen offset:0 nt lds
    buffer_load_dwordx4 v3, s[24:27], s60 offen offset:1024 nt lds
    buffer_load_dwordx4 v2, s[24:27], s60 offen offset:2048 nt lds
    buffer_load_dwordx4 v3, s[24:27], s60 offen offset:3072 nt lds
    s_sub_u32 s60, s65, 8192
    s_add_u32 m0, s66, 8192
    s_add_u32 s61, s61, s62
    s_add_u32 s61, s61, 3072
    v_add_u32 v243, s61, v5
    s_mul_i32 s61, s3, 3
    s_add_u32 s61, s61, 6
    s_lshr_b32 s62, s61, 2
    s_add_u32 s62, s62, s77
    s_waitcnt vmcnt(16)
    buffer_load_dwordx4 v2, s[28:31], s60 offen offset:0 nt lds
    buffer_load_dwordx4 v3, s[28:31], s60 offen offset:1024 nt lds
    buffer_load_dwordx4 v2, s[28:31], s60 offen offset:2048 nt lds
    buffer_load_dwordx4 v3, s[28:31], s60 offen offset:3072 nt lds
    s_sub_u32 s60, s65, 4096
    s_add_u32 m0, s66, 12288
    s_and_b32 s62, s62, 3
    s_mul_i32 s62, s62, 73728
    s_and_b32 s61, s61, 3
    s_lshl_b32 s61, s61, 10
    s_add_u32 s61, s61, s62
    s_add_u32 s61, s61, 2048
    v_add_u32 v244, s61, v5
    s_waitcnt vmcnt(16)
    buffer_load_dwordx4 v2, s[28:31], s60 offen offset:0 nt lds
    s_add_u32 s65, s65, 8192
    v_readfirstlane_b32 s9, v8
    buffer_load_dwordx4 v3, s[28:31], s60 offen offset:1024 nt lds
    s_add_u32 s67, s67, 1
    s_add_u32 s7, s7, 1
    buffer_load_dwordx4 v2, s[28:31], s60 offen offset:2048 nt lds
    s_add_u32 s66, s66, 16384
    s_lshl4_add_u32 s9, s9, 32
    buffer_load_dwordx4 v3, s[28:31], s60 offen offset:3072 nt lds
    s_min_u32 s6, s6, s9
    s_cmp_eq_u32 s66, 114688
    s_cselect_b32 s66, 0, s66
    s_add_u32 s6, s6, s8
    s_add_u32 s60, s65, 0
    s_lshr_b32 s9, s6, 4
    s_min_u32 s9, s9, s7
    ds_read_b32 v8, v7
    s_add_u32 m0, s66, 0
    s_lshl_b32 s61, s3, 12
    s_add_u32 s61, s61, 131072
    v_bfe_u32 v236, v1, 2, 2
    v_lshlrev_b32 v236, 10, v236
    v_lshrrev_b32 v237, 4, v1
    v_lshl_add_u32 v236, v237, 6, v236
    v_add_u32 v236, s61, v236
    s_waitcnt vmcnt(16)
    v_mov_b32 v9, s9
    ds_write_b32 v6, v9
    s_waitcnt lgkmcnt(0)
    v_cmp_gt_u32 vcc, s67, v8
    s_cbranch_vccnz L_pc111
L_pc111r:
    buffer_load_dwordx4 v2, s[24:27], s60 offen offset:0 nt lds
    buffer_load_dwordx4 v3, s[24:27], s60 offen offset:1024 nt lds
    buffer_load_dwordx4 v2, s[24:27], s60 offen offset:2048 nt lds
    buffer_load_dwordx4 v3, s[24:27], s60 offen offset:3072 nt lds
    s_add_u32 s60, s65, 4096
    s_add_u32 m0, s66, 4096
    v_and_b32 v237, 3, v1
    v_lshl_add_u32 v248, v237, 4, v236
    v_xor_b32 v237, 2, v237
    v_lshl_add_u32 v236, v237, 4, v236
    v_add_u32 v249, 15360, v236
    v_add_u32 v236, 65536, v5
    s_waitcnt vmcnt(16)
    buffer_load_dwordx4 v2, s[24:27], s60 offen offset:0 nt lds
    buffer_load_dwordx4 v3, s[24:27], s60 offen offset:1024 nt lds
    buffer_load_dwordx4 v2, s[24:27], s60 offen offset:2048 nt lds
    buffer_load_dwordx4 v3, s[24:27], s60 offen offset:3072 nt lds
    s_sub_u32 s60, s65, 8192
    s_add_u32 m0, s66, 8192
    v_add_u32 v237, 131072, v5
    s_add_u32 s61, s76, 1
    s_and_b32 s61, s61, 3
    s_lshl_b32 s61, s61, 13
    s_add_u32 s61, s61, 122880
    v_add_u32 v238, s61, v5
    s_add_u32 s61, s76, 2
    s_waitcnt vmcnt(16)
    buffer_load_dwordx4 v2, s[28:31], s60 offen offset:0 nt lds
    buffer_load_dwordx4 v3, s[28:31], s60 offen offset:1024 nt lds
    buffer_load_dwordx4 v2, s[28:31], s60 offen offset:2048 nt lds
    buffer_load_dwordx4 v3, s[28:31], s60 offen offset:3072 nt lds
    s_sub_u32 s60, s65, 4096
    s_add_u32 m0, s66, 12288
    s_and_b32 s61, s61, 3
    s_lshl_b32 s61, s61, 13
    s_add_u32 s61, s61, 122880
    v_add_u32 v239, s61, v5
    s_add_u32 s61, s76, 3
    s_and_b32 s61, s61, 3
    s_lshl_b32 s61, s61, 13
    s_waitcnt vmcnt(16)
    buffer_load_dwordx4 v2, s[28:31], s60 offen offset:0 nt lds
    s_add_u32 s65, s65, 8192
    v_readfirstlane_b32 s9, v8
    buffer_load_dwordx4 v3, s[28:31], s60 offen offset:1024 nt lds
    s_add_u32 s67, s67, 1
    s_add_u32 s7, s7, 1
    buffer_load_dwordx4 v2, s[28:31], s60 offen offset:2048 nt lds
    s_add_u32 s66, s66, 16384
    s_lshl4_add_u32 s9, s9, 32
    buffer_load_dwordx4 v3, s[28:31], s60 offen offset:3072 nt lds
    s_min_u32 s6, s6, s9
    s_cmp_eq_u32 s66, 114688
    s_cselect_b32 s66, 0, s66
    s_add_u32 s6, s6, s8
    s_add_u32 s60, s65, 0
    s_lshr_b32 s9, s6, 4
    s_min_u32 s9, s9, s7
    ds_read_b32 v8, v7
    s_add_u32 m0, s66, 0
    s_add_u32 s61, s61, 122880
    v_add_u32 v240, s61, v5
    s_add_u32 s61, s76, 4
    s_and_b32 s61, s61, 3
    s_lshl_b32 s61, s61, 13
    s_add_u32 s61, s61, 122880
    v_add_u32 v241, s61, v5
    s_waitcnt vmcnt(16)
    v_mov_b32 v9, s9
    ds_write_b32 v6, v9
    s_waitcnt lgkmcnt(0)
    v_cmp_gt_u32 vcc, s67, v8
    s_cbranch_vccnz L_pc112
L_pc112r:
    buffer_load_dwordx4 v2, s[24:27], s60 offen offset:0 nt lds
    buffer_load_dwordx4 v3, s[24:27], s60 offen offset:1024 nt lds
    buffer_load_dwordx4 v2, s[24:27], s60 offen offset:2048 nt lds
    buffer_load_dwordx4 v3, s[24:27], s60 offen offset:3072 nt lds
    s_bfe_u32 s63, s2, 0x30003
    s_lshr_b32 s64, s63, 1
    s_and_b32 s63, s63, 1
    s_lshl_b32 s64, s64, 18
    s_lshl_b32 s63, s63, 16
    s_add_u32 s63, s63, s64
    s_add_u32 s63, s63, 0
    v_lshrrev_b32 v30, 1, v1
    v_and_b32 v31, 1, v1
    v_lshlrev_b32 v30, 10, v30
    v_lshl_add_u32 v30, v31, 7, v30
    s_add_u32 s64, s63, 32768
    buffer_load_dword v52, v30, s[32:35], s63 offen
    buffer_load_dword v52, v30, s[32:35], s64 offen
    s_add_u32 s60, s65, 4096
    s_add_u32 m0, s66, 4096
    s_waitcnt vmcnt(18)
    buffer_load_dwordx4 v2, s[24:27], s60 offen offset:0 nt lds
    buffer_load_dwordx4 v3, s[24:27], s60 offen offset:1024 nt lds
    buffer_load_dwordx4 v2, s[24:27], s60 offen offset:2048 nt lds
    buffer_load_dwordx4 v3, s[24:27], s60 offen offset:3072 nt lds
    s_sub_u32 s60, s65, 8192
    s_add_u32 m0, s66, 8192
    s_waitcnt vmcnt(18)
    buffer_load_dwordx4 v2, s[28:31], s60 offen offset:0 nt lds
    buffer_load_dwordx4 v3, s[28:31], s60 offen offset:1024 nt lds
    buffer_load_dwordx4 v2, s[28:31], s60 offen offset:2048 nt lds
    buffer_load_dwordx4 v3, s[28:31], s60 offen offset:3072 nt lds
    s_sub_u32 s60, s65, 4096
    s_add_u32 m0, s66, 12288
    s_waitcnt vmcnt(18)
    buffer_load_dwordx4 v2, s[28:31], s60 offen offset:0 nt lds
    s_add_u32 s65, s65, 8192
    v_readfirstlane_b32 s9, v8
    buffer_load_dwordx4 v3, s[28:31], s60 offen offset:1024 nt lds
    s_add_u32 s67, s67, 1
    s_add_u32 s7, s7, 1
    buffer_load_dwordx4 v2, s[28:31], s60 offen offset:2048 nt lds
    s_add_u32 s66, s66, 16384
    s_lshl4_add_u32 s9, s9, 32
    buffer_load_dwordx4 v3, s[28:31], s60 offen offset:3072 nt lds
    s_min_u32 s6, s6, s9
    s_cmp_eq_u32 s66, 114688
    s_cselect_b32 s66, 0, s66
    s_add_u32 s6, s6, s8
    s_add_u32 s60, s65, 0
    s_lshr_b32 s9, s6, 4
    s_min_u32 s9, s9, s7
    s_add_u32 m0, s66, 0
    s_waitcnt vmcnt(18)
    v_mov_b32 v9, s9
    ds_write_b32 v6, v9
L_s0:
    ds_read_b32 v8, v7
    s_mov_b32 s68, 1
    s_waitcnt lgkmcnt(0)
    v_cmp_gt_u32 vcc, s67, v8
    s_cbranch_vccnz L_pc113
L_pc113r:
    buffer_load_dwordx4 v2, s[24:27], s60 offen offset:0 nt lds
    buffer_load_dwordx4 v3, s[24:27], s60 offen offset:1024 nt lds
    buffer_load_dwordx4 v2, s[24:27], s60 offen offset:2048 nt lds
    buffer_load_dwordx4 v3, s[24:27], s60 offen offset:3072 nt lds
    ds_read_b32 v8, v7
    s_waitcnt lgkmcnt(0)
    v_cmp_gt_u32 vcc, 52, v8
    s_cbranch_vccnz L_pc114
L_pc114r:
    s_mov_b32 m0, 0
    s_add_u32 s61, s36, 0
    buffer_load_dwordx4 v48, s[32:35], s61 offen offset:0 lds
    buffer_load_dwordx4 v49, s[32:35], s61 offen offset:1024 lds
    buffer_load_dwordx2 v[56:57], v54, s[56:59], 0 offen sc1
    s_add_u32 s60, s65, 4096
    s_mov_b32 m0, 102400
    v_add_u32 v30, 122880, v5
    ds_read_b128 v[80:83], v30 offset:0
    ds_read_b128 v[84:87], v30 offset:1024
    ds_read_b128 v[88:91], v30 offset:2048
    ds_read_b128 v[92:95], v30 offset:3072
    ds_read_b128 v[96:99], v30 offset:4096
    ds_read_b128 v[100:103], v30 offset:5120
    ds_read_b128 v[104:107], v30 offset:6144
    ds_read_b128 v[108:111], v30 offset:7168
    s_waitcnt vmcnt(21)
    buffer_load_dwordx4 v2, s[24:27], s60 offen offset:0 nt lds
    buffer_load_dwordx4 v3, s[24:27], s60 offen offset:1024 nt lds
    buffer_load_dwordx4 v2, s[24:27], s60 offen offset:2048 nt lds
    buffer_load_dwordx4 v3, s[24:27], s60 offen offset:3072 nt lds
    s_mov_b32 m0, 0
    s_nop 0
    buffer_load_dwordx4 v50, s[32:35], s61 offen offset:2048 lds
    buffer_load_dwordx4 v51, s[32:35], s61 offen offset:3072 lds
    s_sub_u32 s60, s65, 8192
    s_mov_b32 m0, 106496
    ds_read_b128 v[112:115], v30 offset:8192
    ds_read_b128 v[116:119], v30 offset:9216
    ds_read_b128 v[120:123], v30 offset:10240
    ds_read_b128 v[124:127], v30 offset:11264
    ds_read_b128 v[128:131], v30 offset:12288
    ds_read_b128 v[132:135], v30 offset:13312
    ds_read_b128 v[136:139], v30 offset:14336
    ds_read_b128 v[140:143], v30 offset:15360
    ds_read_b128 v[144:147], v30 offset:16384
    s_waitcnt vmcnt(21)
    buffer_load_dwordx4 v2, s[28:31], s60 offen offset:0 nt lds
    buffer_load_dwordx4 v3, s[28:31], s60 offen offset:1024 nt lds
    buffer_load_dwordx4 v2, s[28:31], s60 offen offset:2048 nt lds
    buffer_load_dwordx4 v3, s[28:31], s60 offen offset:3072 nt lds
    s_mov_b32 m0, 4096
    s_add_u32 s61, s36, 8192
    buffer_load_dwordx4 v48, s[32:35], s61 offen offset:0 lds
    buffer_load_dwordx4 v49, s[32:35], s61 offen offset:1024 lds
    s_sub_u32 s60, s65, 4096
    s_mov_b32 m0, 110592
    ds_read_b128 v[148:151], v30 offset:17408
    ds_read_b128 v[152:155], v30 offset:18432
    ds_read_b128 v[156:159], v30 offset:19456
    ds_read_b128 v[160:163], v30 offset:20480
    ds_read_b128 v[164:167], v30 offset:21504
    ds_read_b128 v[168:171], v30 offset:22528
    ds_read_b128 v[172:175], v30 offset:23552
    ds_read_b128 v[176:179], v30 offset:24576
    ds_read_b128 v[180:183], v30 offset:25600
    s_waitcnt vmcnt(23)
    buffer_load_dwordx4 v2, s[28:31], s60 offen offset:0 nt lds
    s_add_u32 s65, s65, 8192
    v_readfirstlane_b32 s9, v8
    buffer_load_dwordx4 v3, s[28:31], s60 offen offset:1024 nt lds
    s_add_u32 s7, s7, 1
    buffer_load_dwordx4 v2, s[28:31], s60 offen offset:2048 nt lds
    s_lshl4_add_u32 s9, s9, 32
    buffer_load_dwordx4 v3, s[28:31], s60 offen offset:3072 nt lds
    s_mov_b32 m0, 4096
    s_nop 0
    buffer_load_dwordx4 v50, s[32:35], s61 offen offset:2048 lds
    s_min_u32 s6, s6, s9
    s_add_u32 s6, s6, s8
    s_add_u32 s60, s65, 0
    s_lshr_b32 s9, s6, 4
    s_min_u32 s9, s9, s7
    ds_read_b32 v8, v7
    s_mov_b32 m0, 114688
    ds_read_b128 v[184:187], v30 offset:26624
    ds_read_b128 v[188:191], v30 offset:27648
    ds_read_b128 v[192:195], v30 offset:28672
    ds_read_b128 v[196:199], v30 offset:29696
    ds_read_b128 v[200:203], v30 offset:30720
    ds_read_b128 v[204:207], v30 offset:31744
    ds_read_b128 v[208:211], v30 offset:32768
    ds_read_b128 v[212:215], v30 offset:33792
    ds_read_b128 v[216:219], v30 offset:34816
    ds_read_b128 v[220:223], v30 offset:35840
    s_waitcnt vmcnt(24)
    v_mov_b32 v9, s9
    ds_write_b32 v6, v9
    s_waitcnt lgkmcnt(0)
    buffer_load_dwordx4 v2, s[24:27], s60 offen offset:0 nt lds
    buffer_load_dwordx4 v3, s[24:27], s60 offen offset:1024 nt lds
    buffer_load_dwordx4 v2, s[24:27], s60 offen offset:2048 nt lds
    buffer_load_dwordx4 v3, s[24:27], s60 offen offset:3072 nt lds
    s_mov_b32 m0, 4096
    s_nop 0
    buffer_load_dwordx4 v51, s[32:35], s61 offen offset:3072 lds
    s_mov_b32 m0, 8192
    s_add_u32 s61, s36, 32768
    buffer_load_dwordx4 v48, s[32:35], s61 offen offset:0 lds
    s_add_u32 s60, s65, 4096
    s_mov_b32 m0, 118784
    s_waitcnt vmcnt(26)
    buffer_load_dwordx4 v2, s[24:27], s60 offen offset:0 nt lds
    buffer_load_dwordx4 v3, s[24:27], s60 offen offset:1024 nt lds
    buffer_load_dwordx4 v2, s[24:27], s60 offen offset:2048 nt lds
    buffer_load_dwordx4 v3, s[24:27], s60 offen offset:3072 nt lds
    s_mov_b32 m0, 8192
    s_nop 0
    buffer_load_dwordx4 v49, s[32:35], s61 offen offset:1024 lds
    buffer_load_dwordx4 v50, s[32:35], s61 offen offset:2048 lds
    s_sub_u32 s60, s65, 8192
    s_mov_b32 m0, 122880
    s_waitcnt vmcnt(25)
    buffer_load_dwordx4 v2, s[28:31], s60 offen offset:0 nt lds
    buffer_load_dwordx4 v3, s[28:31], s60 offen offset:1024 nt lds
    buffer_load_dwordx4 v2, s[28:31], s60 offen offset:2048 nt lds
    buffer_load_dwordx4 v3, s[28:31], s60 offen offset:3072 nt lds
    s_mov_b32 m0, 8192
    s_nop 0
    buffer_load_dwordx4 v51, s[32:35], s61 offen offset:3072 lds
    s_mov_b32 m0, 12288
    s_add_u32 s61, s36, 40960
    buffer_load_dwordx4 v48, s[32:35], s61 offen offset:0 lds
    s_sub_u32 s60, s65, 4096
    s_mov_b32 m0, 126976
    s_waitcnt vmcnt(25)
    buffer_load_dwordx4 v2, s[28:31], s60 offen offset:0 nt lds
    s_add_u32 s65, s65, 8192
    v_readfirstlane_b32 s9, v8
    buffer_load_dwordx4 v3, s[28:31], s60 offen offset:1024 nt lds
    s_add_u32 s7, s7, 1
    buffer_load_dwordx4 v2, s[28:31], s60 offen offset:2048 nt lds
    s_lshl4_add_u32 s9, s9, 32
    buffer_load_dwordx4 v3, s[28:31], s60 offen offset:3072 nt lds
    s_mov_b32 m0, 12288
    s_nop 0
    buffer_load_dwordx4 v49, s[32:35], s61 offen offset:1024 lds
    s_min_u32 s6, s6, s9
    s_add_u32 s6, s6, s8
    s_add_u32 s60, s65, 0
    s_lshr_b32 s9, s6, 4
    s_min_u32 s9, s9, s7
    ds_read_b32 v8, v7
    s_mov_b32 m0, 131072
    s_waitcnt vmcnt(24)
    v_mov_b32 v9, s9
    ds_write_b32 v6, v9
    s_waitcnt vmcnt(40)
L_tok:
    v_readfirstlane_b32 s5, v57
    v_readfirstlane_b32 s4, v56
    s_cmp_eq_u32 s5, 0
    s_cbranch_scc1 L_tok2
L_tokok:
    v_add_u32 v55, 4096, v5
    v_add_u32 v62, 122880, v5
    buffer_load_dwordx4 v2, s[24:27], s60 offen offset:0 nt lds
    buffer_load_dwordx4 v3, s[24:27], s60 offen offset:1024 nt lds
    buffer_load_dwordx4 v2, s[24:27], s60 offen offset:2048 nt lds
    buffer_load_dwordx4 v3, s[24:27], s60 offen offset:3072 nt lds
    s_mov_b32 m0, 12288
    s_nop 0
    buffer_load_dwordx4 v50, s[32:35], s61 offen offset:2048 lds
    buffer_load_dwordx4 v51, s[32:35], s61 offen offset:3072 lds
    s_add_u32 s60, s65, 4096
    s_mov_b32 m0, 135168
    s_waitcnt vmcnt(25)
    buffer_load_dwordx4 v2, s[24:27], s60 offen offset:0 nt lds
    buffer_load_dwordx4 v3, s[24:27], s60 offen offset:1024 nt lds
    buffer_load_dwordx4 v2, s[24:27], s60 offen offset:2048 nt lds
    buffer_load_dwordx4 v3, s[24:27], s60 offen offset:3072 nt lds
    ds_read_b32 v8, v7
    s_waitcnt lgkmcnt(0)
    v_cmp_gt_u32 vcc, 55, v8
    s_cbranch_vccnz L_pc115
L_pc115r:
    s_mov_b32 m0, 49152
    s_add_u32 s61, s36, 65536
    buffer_load_dwordx4 v48, s[32:35], s61 offen offset:0 lds
    buffer_load_dwordx4 v49, s[32:35], s61 offen offset:1024 lds
    s_sub_u32 s60, s65, 8192
    s_mov_b32 m0, 139264
    s_waitcnt vmcnt(25)
    buffer_load_dwordx4 v2, s[28:31], s60 offen offset:0 nt lds
    buffer_load_dwordx4 v3, s[28:31], s60 offen offset:1024 nt lds
    buffer_load_dwordx4 v2, s[28:31], s60 offen offset:2048 nt lds
    buffer_load_dwordx4 v3, s[28:31], s60 offen offset:3072 nt lds
    s_mov_b32 m0, 49152
    s_nop 0
    buffer_load_dwordx4 v50, s[32:35], s61 offen offset:2048 lds
    buffer_load_dwordx4 v51, s[32:35], s61 offen offset:3072 lds
    s_sub_u32 s60, s65, 4096
    s_mov_b32 m0, 143360
    s_waitcnt vmcnt(25)
    buffer_load_dwordx4 v2, s[28:31], s60 offen offset:0 nt lds
    s_add_u32 s65, s65, 8192
    v_readfirstlane_b32 s9, v8
    buffer_load_dwordx4 v3, s[28:31], s60 offen offset:1024 nt lds
    s_add_u32 s7, s7, 1
    buffer_load_dwordx4 v2, s[28:31], s60 offen offset:2048 nt lds
    s_lshl4_add_u32 s9, s9, 32
    buffer_load_dwordx4 v3, s[28:31], s60 offen offset:3072 nt lds
    s_mov_b32 m0, 53248
    s_add_u32 s61, s36, 73728
    buffer_load_dwordx4 v48, s[32:35], s61 offen offset:0 lds
    s_min_u32 s6, s6, s9
    s_add_u32 s6, s6, s8
    s_add_u32 s60, s65, 0
    s_lshr_b32 s9, s6, 4
    s_min_u32 s9, s9, s7
    ds_read_b32 v8, v7
    s_mov_b32 m0, 16384
    s_waitcnt vmcnt(24)
    v_mov_b32 v9, s9
    ds_write_b32 v6, v9
    s_waitcnt lgkmcnt(0)
    v_cmp_gt_u32 vcc, 53, v8
    s_cbranch_vccnz L_pc116
L_pc116r:
    buffer_load_dwordx4 v2, s[24:27], s60 offen offset:0 nt lds
    buffer_load_dwordx4 v3, s[24:27], s60 offen offset:1024 nt lds
    buffer_load_dwordx4 v2, s[24:27], s60 offen offset:2048 nt lds
    buffer_load_dwordx4 v3, s[24:27], s60 offen offset:3072 nt lds
    s_mov_b32 m0, 53248
    s_nop 0
    buffer_load_dwordx4 v49, s[32:35], s61 offen offset:1024 lds
    buffer_load_dwordx4 v50, s[32:35], s61 offen offset:2048 lds
    s_add_u32 s60, s65, 4096
    s_mov_b32 m0, 20480
    s_waitcnt vmcnt(25)
    buffer_load_dwordx4 v2, s[24:27], s60 offen offset:0 nt lds
    buffer_load_dwordx4 v3, s[24:27], s60 offen offset:1024 nt lds
    buffer_load_dwordx4 v2, s[24:27], s60 offen offset:2048 nt lds
    buffer_load_dwordx4 v3, s[24:27], s60 offen offset:3072 nt lds
    s_mov_b32 m0, 53248
    s_nop 0
    buffer_load_dwordx4 v51, s[32:35], s61 offen offset:3072 lds
    s_mov_b32 m0, 57344
    s_add_u32 s61, s36, 98304
    buffer_load_dwordx4 v48, s[32:35], s61 offen offset:0 lds
    s_sub_u32 s60, s65, 8192
    s_mov_b32 m0, 24576
    s_waitcnt vmcnt(31)
    s_cmp_ge_u32 s100, 192
    s_cbranch_scc1 L_fb117
    s_waitcnt vmcnt(25)
    s_cmp_ge_u32 s100, 64
    s_cbranch_scc1 L_fb117
    s_waitcnt vmcnt(19)
L_fb117:
    buffer_load_dwordx4 v2, s[28:31], s60 offen offset:0 nt lds
    buffer_load_dwordx4 v3, s[28:31], s60 offen offset:1024 nt lds
    buffer_load_dwordx4 v2, s[28:31], s60 offen offset:2048 nt lds
    buffer_load_dwordx4 v3, s[28:31], s60 offen offset:3072 nt lds
    s_mov_b32 m0, 57344
    s_nop 0
    buffer_load_dwordx4 v49, s[32:35], s61 offen offset:1024 lds
    buffer_load_dwordx4 v50, s[32:35], s61 offen offset:2048 lds
    s_sub_u32 s60, s65, 4096
    s_mov_b32 m0, 28672
    s_waitcnt vmcnt(31)
    s_cmp_ge_u32 s100, 192
    s_cbranch_scc1 L_fb118
    s_waitcnt vmcnt(25)
    s_cmp_ge_u32 s100, 64
    s_cbranch_scc1 L_fb118
    s_waitcnt vmcnt(19)
L_fb118:
    buffer_load_dwordx4 v2, s[28:31], s60 offen offset:0 nt lds
    s_add_u32 s65, s65, 8192
    buffer_load_dwordx4 v3, s[28:31], s60 offen offset:1024 nt lds
    buffer_load_dwordx4 v2, s[28:31], s60 offen offset:2048 nt lds
    buffer_load_dwordx4 v3, s[28:31], s60 offen offset:3072 nt lds
    s_mov_b32 m0, 57344
    s_nop 0
    buffer_load_dwordx4 v51, s[32:35], s61 offen offset:3072 lds
    s_add_u32 s60, s65, 0
    ds_read_b32 v8, v7
    s_mov_b32 m0, 32768
    ds_read_b32 v65, v64
    s_waitcnt vmcnt(30)
    s_cmp_ge_u32 s100, 192
    s_cbranch_scc1 L_fb119
    s_waitcnt vmcnt(24)
    s_cmp_ge_u32 s100, 64
    s_cbranch_scc1 L_fb119
    s_waitcnt vmcnt(19)
L_fb119:
    s_waitcnt lgkmcnt(0)
    v_cmp_gt_u32 vcc, 54, v8
    s_cbranch_vccnz L_pc120
L_pc120r:
    buffer_load_dwordx4 v2, s[24:27], s60 offen offset:0 nt lds
    v_readfirstlane_b32 s9, v8
    buffer_load_dwordx4 v3, s[24:27], s60 offen offset:1024 nt lds
    s_add_u32 s7, s7, 2
    buffer_load_dwordx4 v2, s[24:27], s60 offen offset:2048 nt lds
    s_lshl4_add_u32 s9, s9, 32
    buffer_load_dwordx4 v3, s[24:27], s60 offen offset:3072 nt lds
    s_mov_b32 m0, 61440
    s_add_u32 s61, s36, 106496
    buffer_load_dwordx4 v48, s[32:35], s61 offen offset:0 lds
    buffer_load_dwordx4 v49, s[32:35], s61 offen offset:1024 lds
    s_min_u32 s6, s6, s9
    s_add_u32 s6, s6, s8
    s_add_u32 s60, s65, 4096
    s_add_u32 s6, s6, 16
    s_lshr_b32 s9, s6, 4
    s_min_u32 s9, s9, s7
    s_mov_b32 m0, 36864
    s_waitcnt vmcnt(30)
    v_mov_b32 v9, s9
    ds_write_b32 v6, v9
    v_add_u32 v250, 0, v252
    v_add_u32 v251, 0, v253
    ds_read_b64_tr_b16 a[128:129], v250 offset:0
    ds_read_b64_tr_b16 a[130:131], v251 offset:0
    ds_read_b64_tr_b16 a[132:133], v250 offset:8
    ds_read_b64_tr_b16 a[134:135], v251 offset:8
    ds_read_b64_tr_b16 a[136:137], v250 offset:8192
    ds_read_b64_tr_b16 a[138:139], v251 offset:8192
    ds_read_b64_tr_b16 a[140:141], v250 offset:8200
    ds_read_b64_tr_b16 a[142:143], v251 offset:8200
    s_cmp_ge_u32 s100, 192
    s_cbranch_scc1 L_fb121
    s_waitcnt vmcnt(25)
    s_cmp_ge_u32 s100, 64
    s_cbranch_scc1 L_fb121
    s_waitcnt vmcnt(19)
L_fb121:
    buffer_load_dwordx4 v2, s[24:27], s60 offen offset:0 nt lds
    buffer_load_dwordx4 v3, s[24:27], s60 offen offset:1024 nt lds
    buffer_load_dwordx4 v2, s[24:27], s60 offen offset:2048 nt lds
    buffer_load_dwordx4 v3, s[24:27], s60 offen offset:3072 nt lds
    s_mov_b32 m0, 61440
    s_nop 0
    buffer_load_dwordx4 v50, s[32:35], s61 offen offset:2048 lds
    buffer_load_dwordx4 v51, s[32:35], s61 offen offset:3072 lds
    s_sub_u32 s60, s65, 8192
    s_mov_b32 m0, 40960
    s_waitcnt vmcnt(31)
    s_cmp_ge_u32 s100, 192
    s_cbranch_scc1 L_fb122
    s_waitcnt vmcnt(25)
    s_cmp_ge_u32 s100, 64
    s_cbranch_scc1 L_fb122
    s_waitcnt vmcnt(19)
L_fb122:
    buffer_load_dwordx4 v2, s[28:31], s60 offen offset:0 nt lds
    buffer_load_dwordx4 v3, s[28:31], s60 offen offset:1024 nt lds
    buffer_load_dwordx4 v2, s[28:31], s60 offen offset:2048 nt lds
    buffer_load_dwordx4 v3, s[28:31], s60 offen offset:3072 nt lds
    ds_read_b32 v8, v7
    s_waitcnt lgkmcnt(0)
    v_cmp_gt_u32 vcc, 58, v8
    s_cbranch_vccnz L_pc123
L_pc123r:
    s_mov_b32 m0, 98304
    s_add_u32 s61, s37, 0
    buffer_load_dwordx4 v48, s[32:35], s61 offen offset:0 lds
    buffer_load_dwordx4 v49, s[32:35], s61 offen offset:1024 lds
    s_sub_u32 s60, s65, 4096
    s_mov_b32 m0, 45056
    s_waitcnt vmcnt(31)
    s_cmp_ge_u32 s100, 192
    s_cbranch_scc1 L_fb124
    s_waitcnt vmcnt(25)
    s_cmp_ge_u32 s100, 64
    s_cbranch_scc1 L_fb124
    s_waitcnt vmcnt(19)
L_fb124:
    buffer_load_dwordx4 v2, s[28:31], s60 offen offset:0 nt lds
    s_add_u32 s65, s65, 8192
    buffer_load_dwordx4 v3, s[28:31], s60 offen offset:1024 nt lds
    buffer_load_dwordx4 v2, s[28:31], s60 offen offset:2048 nt lds
    buffer_load_dwordx4 v3, s[28:31], s60 offen offset:3072 nt lds
    s_mov_b32 m0, 98304
    s_nop 0
    buffer_load_dwordx4 v50, s[32:35], s61 offen offset:2048 lds
    s_add_u32 s60, s65, 0
    ds_read_b32 v8, v7
    s_mov_b32 m0, 65536
    ds_read_b32 v65, v64
    s_waitcnt vmcnt(30)
    s_cmp_ge_u32 s100, 192
    s_cbranch_scc1 L_fb125
    s_waitcnt vmcnt(24)
    s_cmp_ge_u32 s100, 64
    s_cbranch_scc1 L_fb125
    s_waitcnt vmcnt(19)
L_fb125:
    s_waitcnt lgkmcnt(0)
    v_cmp_gt_u32 vcc, 56, v8
    s_cbranch_vccnz L_pc126
L_pc126r:
    v_readfirstlane_b32 s100, v65
    buffer_load_dwordx4 v2, s[24:27], s60 offen offset:0 nt lds
    v_readfirstlane_b32 s9, v8
    buffer_load_dwordx4 v3, s[24:27], s60 offen offset:1024 nt lds
    s_add_u32 s7, s7, 1
    buffer_load_dwordx4 v2, s[24:27], s60 offen offset:2048 nt lds
    s_lshl4_add_u32 s9, s9, 32
    buffer_load_dwordx4 v3, s[24:27], s60 offen offset:3072 nt lds
    s_mov_b32 m0, 98304
    s_nop 0
    buffer_load_dwordx4 v51, s[32:35], s61 offen offset:3072 lds
    s_mov_b32 m0, 102400
    s_add_u32 s61, s37, 8192
    buffer_load_dwordx4 v48, s[32:35], s61 offen offset:0 lds
    s_min_u32 s6, s6, s9
    s_add_u32 s6, s6, s8
    s_add_u32 s60, s65, 4096
    s_lshr_b32 s9, s6, 4
    s_min_u32 s9, s9, s7
    s_mov_b32 m0, 69632
    s_waitcnt vmcnt(30)
    v_mov_b32 v9, s9
    ds_write_b32 v6, v9
    s_cmp_ge_u32 s100, 192
    s_cbranch_scc1 L_fb127
    s_waitcnt vmcnt(25)
    s_cmp_ge_u32 s100, 64
    s_cbranch_scc1 L_fb127
    s_waitcnt vmcnt(19)
L_fb127:
    buffer_load_dwordx4 v2, s[24:27], s60 offen offset:0 nt lds
    buffer_load_dwordx4 v3, s[24:27], s60 offen offset:1024 nt lds
    buffer_load_dwordx4 v2, s[24:27], s60 offen offset:2048 nt lds
    buffer_load_dwordx4 v3, s[24:27], s60 offen offset:3072 nt lds
    s_mov_b32 m0, 102400
    s_nop 0
    buffer_load_dwordx4 v49, s[32:35], s61 offen offset:1024 lds
    buffer_load_dwordx4 v50, s[32:35], s61 offen offset:2048 lds
    s_sub_u32 s60, s65, 8192
    s_mov_b32 m0, 73728
    s_waitcnt vmcnt(31)
    s_cmp_ge_u32 s100, 192
    s_cbranch_scc1 L_fb128
    s_waitcnt vmcnt(25)
    s_cmp_ge_u32 s100, 64
    s_cbranch_scc1 L_fb128
    s_waitcnt vmcnt(19)
L_fb128:
    buffer_load_dwordx4 v2, s[28:31], s60 offen offset:0 nt lds
    buffer_load_dwordx4 v3, s[28:31], s60 offen offset:1024 nt lds
    buffer_load_dwordx4 v2, s[28:31], s60 offen offset:2048 nt lds
    buffer_load_dwordx4 v3, s[28:31], s60 offen offset:3072 nt lds
    s_mov_b32 m0, 102400
    s_nop 0
    buffer_load_dwordx4 v51, s[32:35], s61 offen offset:3072 lds
    s_mov_b32 m0, 106496
    s_add_u32 s61, s37, 32768
    buffer_load_dwordx4 v48, s[32:35], s61 offen offset:0 lds
    s_sub_u32 s60, s65, 4096
    s_mov_b32 m0, 77824
    s_waitcnt vmcnt(31)
    s_cmp_ge_u32 s100, 192
    s_cbranch_scc1 L_fb129
    s_waitcnt vmcnt(25)
    s_cmp_ge_u32 s100, 64
    s_cbranch_scc1 L_fb129
    s_waitcnt vmcnt(19)
L_fb129:
    buffer_load_dwordx4 v2, s[28:31], s60 offen offset:0 nt lds
    s_add_u32 s65, s65, 8192
    buffer_load_dwordx4 v3, s[28:31], s60 offen offset:1024 nt lds
    buffer_load_dwordx4 v2, s[28:31], s60 offen offset:2048 nt lds
    buffer_load_dwordx4 v3, s[28:31], s60 offen offset:3072 nt lds
    s_mov_b32 m0, 106496
    s_nop 0
    buffer_load_dwordx4 v49, s[32:35], s61 offen offset:1024 lds
    s_add_u32 s60, s65, 0
    ds_read_b32 v8, v7
    s_mov_b32 m0, 81920
    ds_read_b32 v65, v64
    s_waitcnt vmcnt(30)
    s_cmp_ge_u32 s100, 192
    s_cbranch_scc1 L_fb130
    s_waitcnt vmcnt(24)
    s_cmp_ge_u32 s100, 64
    s_cbranch_scc1 L_fb130
    s_waitcnt vmcnt(19)
L_fb130:
    s_waitcnt lgkmcnt(0)
    v_cmp_gt_u32 vcc, 57, v8
    s_cbranch_vccnz L_pc131
L_pc131r:
    v_readfirstlane_b32 s100, v65
    buffer_load_dwordx4 v2, s[24:27], s60 offen offset:0 nt lds
    v_readfirstlane_b32 s9, v8
    buffer_load_dwordx4 v3, s[24:27], s60 offen offset:1024 nt lds
    s_add_u32 s7, s7, 2
    buffer_load_dwordx4 v2, s[24:27], s60 offen offset:2048 nt lds
    s_lshl4_add_u32 s9, s9, 32
    buffer_load_dwordx4 v3, s[24:27], s60 offen offset:3072 nt lds
    s_mov_b32 m0, 106496
    s_nop 0
    buffer_load_dwordx4 v50, s[32:35], s61 offen offset:2048 lds
    buffer_load_dwordx4 v51, s[32:35], s61 offen offset:3072 lds
    s_min_u32 s6, s6, s9
    s_add_u32 s6, s6, s8
    s_add_u32 s60, s65, 4096
    s_add_u32 s6, s6, 16
    s_lshr_b32 s9, s6, 4
    s_min_u32 s9, s9, s7
    s_mov_b32 m0, 86016
    s_waitcnt vmcnt(30)
    v_mov_b32 v9, s9
    ds_write_b32 v6, v9
    v_add_u32 v250, 49152, v252
    v_add_u32 v251, 49152, v253
    ds_read_b64_tr_b16 a[144:145], v250 offset:0
    ds_read_b64_tr_b16 a[146:147], v251 offset:0
    ds_read_b64_tr_b16 a[148:149], v250 offset:8
    ds_read_b64_tr_b16 a[150:151], v251 offset:8
    ds_read_b64_tr_b16 a[152:153], v250 offset:8192
    ds_read_b64_tr_b16 a[154:155], v251 offset:8192
    ds_read_b64_tr_b16 a[156:157], v250 offset:8200
    ds_read_b64_tr_b16 a[158:159], v251 offset:8200
    s_cmp_ge_u32 s100, 192
    s_cbranch_scc1 L_fb132
    s_waitcnt vmcnt(25)
    s_cmp_ge_u32 s100, 64
    s_cbranch_scc1 L_fb132
    s_waitcnt vmcnt(19)
L_fb132:
    buffer_load_dwordx4 v2, s[24:27], s60 offen offset:0 nt lds
    buffer_load_dwordx4 v3, s[24:27], s60 offen offset:1024 nt lds
    buffer_load_dwordx4 v2, s[24:27], s60 offen offset:2048 nt lds
    buffer_load_dwordx4 v3, s[24:27], s60 offen offset:3072 nt lds
    s_mov_b32 m0, 110592
    s_add_u32 s61, s37, 40960
    buffer_load_dwordx4 v48, s[32:35], s61 offen offset:0 lds
    buffer_load_dwordx4 v49, s[32:35], s61 offen offset:1024 lds
    s_sub_u32 s60, s65, 8192
    s_mov_b32 m0, 90112
    s_waitcnt vmcnt(31)
    s_cmp_ge_u32 s100, 192
    s_cbranch_scc1 L_fb133
    s_waitcnt vmcnt(25)
    s_cmp_ge_u32 s100, 64
    s_cbranch_scc1 L_fb133
    s_waitcnt vmcnt(19)
L_fb133:
    buffer_load_dwordx4 v2, s[28:31], s60 offen offset:0 nt lds
    buffer_load_dwordx4 v3, s[28:31], s60 offen offset:1024 nt lds
    buffer_load_dwordx4 v2, s[28:31], s60 offen offset:2048 nt lds
    buffer_load_dwordx4 v3, s[28:31], s60 offen offset:3072 nt lds
    s_mov_b32 m0, 110592
    s_nop 0
    buffer_load_dwordx4 v50, s[32:35], s61 offen offset:2048 lds
    buffer_load_dwordx4 v51, s[32:35], s61 offen offset:3072 lds
    s_sub_u32 s60, s65, 4096
    s_mov_b32 m0, 94208
    s_waitcnt vmcnt(31)
    s_cmp_ge_u32 s100, 192
    s_cbranch_scc1 L_fb134
    s_waitcnt vmcnt(25)
    s_cmp_ge_u32 s100, 64
    s_cbranch_scc1 L_fb134
    s_waitcnt vmcnt(19)
L_fb134:
    buffer_load_dwordx4 v2, s[28:31], s60 offen offset:0 nt lds
    s_add_u32 s65, s65, 8192
    buffer_load_dwordx4 v3, s[28:31], s60 offen offset:1024 nt lds
    buffer_load_dwordx4 v2, s[28:31], s60 offen offset:2048 nt lds
    buffer_load_dwordx4 v3, s[28:31], s60 offen offset:3072 nt lds
    ds_read_b32 v8, v7
    s_waitcnt lgkmcnt(0)
    v_cmp_gt_u32 vcc, 63, v8
    s_cbranch_vccnz L_pc135
L_pc135r:
    s_mov_b32 m0, 32768
    s_add_u32 s61, s37, 65536
    buffer_load_dwordx4 v48, s[32:35], s61 offen offset:0 lds
    s_add_u32 s60, s65, 0
    ds_read_b32 v8, v7
    s_mov_b32 m0, 114688
    ds_read_b32 v65, v64
    s_waitcnt vmcnt(30)
    s_cmp_ge_u32 s100, 192
    s_cbranch_scc1 L_fb136
    s_waitcnt vmcnt(24)
    s_cmp_ge_u32 s100, 64
    s_cbranch_scc1 L_fb136
    s_waitcnt vmcnt(19)
L_fb136:
    s_waitcnt lgkmcnt(0)
    v_cmp_gt_u32 vcc, 59, v8
    s_cbranch_vccnz L_pc137
L_pc137r:
    v_readfirstlane_b32 s100, v65
    buffer_load_dwordx4 v2, s[24:27], s60 offen offset:0 nt lds
    v_readfirstlane_b32 s9, v8
    buffer_load_dwordx4 v3, s[24:27], s60 offen offset:1024 nt lds
    s_add_u32 s7, s7, 1
    buffer_load_dwordx4 v2, s[24:27], s60 offen offset:2048 nt lds
    s_lshl4_add_u32 s9, s9, 32
    buffer_load_dwordx4 v3, s[24:27], s60 offen offset:3072 nt lds
    s_mov_b32 m0, 32768
    s_nop 0
    buffer_load_dwordx4 v49, s[32:35], s61 offen offset:1024 lds
    buffer_load_dwordx4 v50, s[32:35], s61 offen offset:2048 lds
    s_min_u32 s6, s6, s9
    s_add_u32 s6, s6, s8
    s_add_u32 s60, s65, 4096
    s_lshr_b32 s9, s6, 4
    s_min_u32 s9, s9, s7
    s_mov_b32 m0, 118784
    s_waitcnt vmcnt(30)
    v_mov_b32 v9, s9
    ds_write_b32 v6, v9
    s_cmp_ge_u32 s100, 192
    s_cbranch_scc1 L_fb138
    s_waitcnt vmcnt(25)
    s_cmp_ge_u32 s100, 64
    s_cbranch_scc1 L_fb138
    s_waitcnt vmcnt(19)
L_fb138:
    buffer_load_dwordx4 v2, s[24:27], s60 offen offset:0 nt lds
    buffer_load_dwordx4 v3, s[24:27], s60 offen offset:1024 nt lds
    buffer_load_dwordx4 v2, s[24:27], s60 offen offset:2048 nt lds
    buffer_load_dwordx4 v3, s[24:27], s60 offen offset:3072 nt lds
    s_mov_b32 m0, 32768
    s_nop 0
    buffer_load_dwordx4 v51, s[32:35], s61 offen offset:3072 lds
    s_mov_b32 m0, 36864
    s_add_u32 s61, s37, 73728
    buffer_load_dwordx4 v48, s[32:35], s61 offen offset:0 lds
    s_sub_u32 s60, s65, 8192
    s_mov_b32 m0, 122880
    s_waitcnt vmcnt(31)
    s_cmp_ge_u32 s100, 192
    s_cbranch_scc1 L_fb139
    s_waitcnt vmcnt(25)
    s_cmp_ge_u32 s100, 64
    s_cbranch_scc1 L_fb139
    s_waitcnt vmcnt(19)
L_fb139:
    buffer_load_dwordx4 v2, s[28:31], s60 offen offset:0 nt lds
    buffer_load_dwordx4 v3, s[28:31], s60 offen offset:1024 nt lds
    buffer_load_dwordx4 v2, s[28:31], s60 offen offset:2048 nt lds
    buffer_load_dwordx4 v3, s[28:31], s60 offen offset:3072 nt lds
    s_mov_b32 m0, 36864
    s_nop 0
    buffer_load_dwordx4 v49, s[32:35], s61 offen offset:1024 lds
    buffer_load_dwordx4 v50, s[32:35], s61 offen offset:2048 lds
    s_sub_u32 s60, s65, 4096
    s_mov_b32 m0, 126976
    s_waitcnt vmcnt(31)
    s_cmp_ge_u32 s100, 192
    s_cbranch_scc1 L_fb140
    s_waitcnt vmcnt(25)
    s_cmp_ge_u32 s100, 64
    s_cbranch_scc1 L_fb140
    s_waitcnt vmcnt(19)
L_fb140:
    buffer_load_dwordx4 v2, s[28:31], s60 offen offset:0 nt lds
    s_add_u32 s65, s65, 8192
    buffer_load_dwordx4 v3, s[28:31], s60 offen offset:1024 nt lds
    buffer_load_dwordx4 v2, s[28:31], s60 offen offset:2048 nt lds
    buffer_load_dwordx4 v3, s[28:31], s60 offen offset:3072 nt lds
    s_mov_b32 m0, 36864
    s_nop 0
    buffer_load_dwordx4 v51, s[32:35], s61 offen offset:3072 lds
    s_add_u32 s60, s65, 0
    ds_read_b32 v8, v7
    s_mov_b32 m0, 131072
    ds_read_b32 v65, v64
    s_waitcnt vmcnt(30)
    s_cmp_ge_u32 s100, 192
    s_cbranch_scc1 L_fb141
    s_waitcnt vmcnt(24)
    s_cmp_ge_u32 s100, 64
    s_cbranch_scc1 L_fb141
    s_waitcnt vmcnt(19)
L_fb141:
    s_waitcnt lgkmcnt(0)
    v_cmp_gt_u32 vcc, 60, v8
    s_cbranch_vccnz L_pc142
L_pc142r:
    v_readfirstlane_b32 s100, v65
    buffer_load_dwordx4 v2, s[24:27], s60 offen offset:0 nt lds
    v_readfirstlane_b32 s9, v8
    buffer_load_dwordx4 v3, s[24:27], s60 offen offset:1024 nt lds
    s_add_u32 s7, s7, 2
    buffer_load_dwordx4 v2, s[24:27], s60 offen offset:2048 nt lds
    s_lshl4_add_u32 s9, s9, 32
    buffer_load_dwordx4 v3, s[24:27], s60 offen offset:3072 nt lds
    s_mov_b32 m0, 40960
    s_add_u32 s61, s37, 98304
    buffer_load_dwordx4 v48, s[32:35], s61 offen offset:0 lds
    buffer_load_dwordx4 v49, s[32:35], s61 offen offset:1024 lds
    s_min_u32 s6, s6, s9
    s_add_u32 s6, s6, s8
    s_add_u32 s60, s65, 4096
    s_add_u32 s6, s6, 16
    s_lshr_b32 s9, s6, 4
    s_min_u32 s9, s9, s7
    s_mov_b32 m0, 135168
    s_waitcnt vmcnt(30)
    v_mov_b32 v9, s9
    ds_write_b32 v6, v9
    v_add_u32 v250, 98304, v252
    v_add_u32 v251, 98304, v253
    ds_read_b64_tr_b16 a[160:161], v250 offset:0
    ds_read_b64_tr_b16 a[162:163], v251 offset:0
    ds_read_b64_tr_b16 a[164:165], v250 offset:8
    ds_read_b64_tr_b16 a[166:167], v251 offset:8
    ds_read_b64_tr_b16 a[168:169], v250 offset:8192
    ds_read_b64_tr_b16 a[170:171], v251 offset:8192
    ds_read_b64_tr_b16 a[172:173], v250 offset:8200
    ds_read_b64_tr_b16 a[174:175], v251 offset:8200
    s_cmp_ge_u32 s100, 192
    s_cbranch_scc1 L_fb143
    s_waitcnt vmcnt(25)
    s_cmp_ge_u32 s100, 64
    s_cbranch_scc1 L_fb143
    s_waitcnt vmcnt(19)
L_fb143:
    buffer_load_dwordx4 v2, s[24:27], s60 offen offset:0 nt lds
    buffer_load_dwordx4 v3, s[24:27], s60 offen offset:1024 nt lds
    buffer_load_dwordx4 v2, s[24:27], s60 offen offset:2048 nt lds
    buffer_load_dwordx4 v3, s[24:27], s60 offen offset:3072 nt lds
    s_mov_b32 m0, 40960
    s_nop 0
    buffer_load_dwordx4 v50, s[32:35], s61 offen offset:2048 lds
    buffer_load_dwordx4 v51, s[32:35], s61 offen offset:3072 lds
    s_sub_u32 s60, s65, 8192
    s_mov_b32 m0, 139264
    s_waitcnt vmcnt(31)
    s_cmp_ge_u32 s100, 192
    s_cbranch_scc1 L_fb144
    s_waitcnt vmcnt(25)
    s_cmp_ge_u32 s100, 64
    s_cbranch_scc1 L_fb144
    s_waitcnt vmcnt(19)
L_fb144:
    buffer_load_dwordx4 v2, s[28:31], s60 offen offset:0 nt lds
    buffer_load_dwordx4 v3, s[28:31], s60 offen offset:1024 nt lds
    buffer_load_dwordx4 v2, s[28:31], s60 offen offset:2048 nt lds
    buffer_load_dwordx4 v3, s[28:31], s60 offen offset:3072 nt lds
    s_mov_b32 m0, 45056
    s_add_u32 s61, s37, 106496
    buffer_load_dwordx4 v48, s[32:35], s61 offen offset:0 lds
    buffer_load_dwordx4 v49, s[32:35], s61 offen offset:1024 lds
    s_sub_u32 s60, s65, 4096
    s_mov_b32 m0, 143360
    s_waitcnt vmcnt(31)
    s_cmp_ge_u32 s100, 192
    s_cbranch_scc1 L_fb145
    s_waitcnt vmcnt(25)
    s_cmp_ge_u32 s100, 64
    s_cbranch_scc1 L_fb145
    s_waitcnt vmcnt(19)
L_fb145:
    buffer_load_dwordx4 v2, s[28:31], s60 offen offset:0 nt lds
    s_add_u32 s65, s65, 8192
    buffer_load_dwordx4 v3, s[28:31], s60 offen offset:1024 nt lds
    buffer_load_dwordx4 v2, s[28:31], s60 offen offset:2048 nt lds
    buffer_load_dwordx4 v3, s[28:31], s60 offen offset:3072 nt lds
    s_mov_b32 m0, 45056
    s_nop 0
    buffer_load_dwordx4 v50, s[32:35], s61 offen offset:2048 lds
    s_add_u32 s60, s65, 0
    ds_read_b32 v8, v7
    s_mov_b32 m0, 0
    ds_read_b32 v65, v64
    s_waitcnt vmcnt(30)
    s_cmp_ge_u32 s100, 192
    s_cbranch_scc1 L_fb146
    s_waitcnt vmcnt(24)
    s_cmp_ge_u32 s100, 64
    s_cbranch_scc1 L_fb146
    s_waitcnt vmcnt(19)
L_fb146:
    s_waitcnt lgkmcnt(0)
    v_cmp_gt_u32 vcc, 61, v8
    s_cbranch_vccnz L_pc147
L_pc147r:
    v_readfirstlane_b32 s100, v65
    buffer_load_dwordx4 v2, s[24:27], s60 offen offset:0 nt lds
    v_readfirstlane_b32 s9, v8
    buffer_load_dwordx4 v3, s[24:27], s60 offen offset:1024 nt lds
    s_add_u32 s7, s7, 1
    buffer_load_dwordx4 v2, s[24:27], s60 offen offset:2048 nt lds
    s_lshl4_add_u32 s9, s9, 32
    buffer_load_dwordx4 v3, s[24:27], s60 offen offset:3072 nt lds
    s_mov_b32 m0, 45056
    s_nop 0
    buffer_load_dwordx4 v51, s[32:35], s61 offen offset:3072 lds
    ds_read_b32 v8, v7
    s_waitcnt lgkmcnt(0)
    v_cmp_gt_u32 vcc, 66, v8
    s_cbranch_vccnz L_pc148
L_pc148r:
    s_mov_b32 m0, 81920
    s_add_u32 s61, s38, 0
    buffer_load_dwordx4 v48, s[32:35], s61 offen offset:0 lds
    s_min_u32 s6, s6, s9
    s_add_u32 s6, s6, s8
    s_add_u32 s60, s65, 4096
    s_lshr_b32 s9, s6, 4
    s_min_u32 s9, s9, s7
    s_mov_b32 m0, 4096
    s_waitcnt vmcnt(30)
    v_mov_b32 v9, s9
    ds_write_b32 v6, v9
    s_cmp_ge_u32 s100, 192
    s_cbranch_scc1 L_fb149
    s_waitcnt vmcnt(25)
    s_cmp_ge_u32 s100, 64
    s_cbranch_scc1 L_fb149
    s_waitcnt vmcnt(19)
L_fb149:
    buffer_load_dwordx4 v2, s[24:27], s60 offen offset:0 nt lds
    buffer_load_dwordx4 v3, s[24:27], s60 offen offset:1024 nt lds
    buffer_load_dwordx4 v2, s[24:27], s60 offen offset:2048 nt lds
    buffer_load_dwordx4 v3, s[24:27], s60 offen offset:3072 nt lds
    s_mov_b32 m0, 81920
    s_nop 0
    buffer_load_dwordx4 v49, s[32:35], s61 offen offset:1024 lds
    buffer_load_dwordx4 v50, s[32:35], s61 offen offset:2048 lds
    s_sub_u32 s60, s65, 8192
    s_mov_b32 m0, 8192
    s_waitcnt vmcnt(31)
    s_cmp_ge_u32 s100, 192
    s_cbranch_scc1 L_fb150
    s_waitcnt vmcnt(25)
    s_cmp_ge_u32 s100, 64
    s_cbranch_scc1 L_fb150
    s_waitcnt vmcnt(19)
L_fb150:
    buffer_load_dwordx4 v2, s[28:31], s60 offen offset:0 nt lds
    buffer_load_dwordx4 v3, s[28:31], s60 offen offset:1024 nt lds
    buffer_load_dwordx4 v2, s[28:31], s60 offen offset:2048 nt lds
    buffer_load_dwordx4 v3, s[28:31], s60 offen offset:3072 nt lds
    s_mov_b32 m0, 81920
    s_nop 0
    buffer_load_dwordx4 v51, s[32:35], s61 offen offset:3072 lds
    s_mov_b32 m0, 86016
    s_add_u32 s61, s38, 8192
    buffer_load_dwordx4 v48, s[32:35], s61 offen offset:0 lds
    s_sub_u32 s60, s65, 4096
    s_mov_b32 m0, 12288
    s_waitcnt vmcnt(31)
    s_cmp_ge_u32 s100, 192
    s_cbranch_scc1 L_fb151
    s_waitcnt vmcnt(25)
    s_cmp_ge_u32 s100, 64
    s_cbranch_scc1 L_fb151
    s_waitcnt vmcnt(19)
L_fb151:
    buffer_load_dwordx4 v2, s[28:31], s60 offen offset:0 nt lds
    s_add_u32 s65, s65, 8192
    buffer_load_dwordx4 v3, s[28:31], s60 offen offset:1024 nt lds
    buffer_load_dwordx4 v2, s[28:31], s60 offen offset:2048 nt lds
    buffer_load_dwordx4 v3, s[28:31], s60 offen offset:3072 nt lds
    s_mov_b32 m0, 86016
    s_nop 0
    buffer_load_dwordx4 v49, s[32:35], s61 offen offset:1024 lds
    s_add_u32 s60, s65, 0
    ds_read_b32 v8, v7
    s_mov_b32 m0, 16384
    ds_read_b32 v65, v64
    s_waitcnt vmcnt(30)
    s_cmp_ge_u32 s100, 192
    s_cbranch_scc1 L_fb152
    s_waitcnt vmcnt(24)
    s_cmp_ge_u32 s100, 64
    s_cbranch_scc1 L_fb152
    s_waitcnt vmcnt(19)
L_fb152:
    s_waitcnt lgkmcnt(0)
    v_cmp_gt_u32 vcc, 62, v8
    s_cbranch_vccnz L_pc153
L_pc153r:
    v_readfirstlane_b32 s100, v65
    buffer_load_dwordx4 v2, s[24:27], s60 offen offset:0 nt lds
    v_readfirstlane_b32 s9, v8
    buffer_load_dwordx4 v3, s[24:27], s60 offen offset:1024 nt lds
    s_add_u32 s7, s7, 1
    buffer_load_dwordx4 v2, s[24:27], s60 offen offset:2048 nt lds
    s_lshl4_add_u32 s9, s9, 32
    buffer_load_dwordx4 v3, s[24:27], s60 offen offset:3072 nt lds
    s_mov_b32 m0, 86016
    s_nop 0
    buffer_load_dwordx4 v50, s[32:35], s61 offen offset:2048 lds
    buffer_load_dwordx4 v51, s[32:35], s61 offen offset:3072 lds
    s_min_u32 s6, s6, s9
    s_add_u32 s6, s6, s8
    s_add_u32 s60, s65, 4096
    s_lshr_b32 s9, s6, 4
    s_min_u32 s9, s9, s7
    s_mov_b32 m0, 20480
    s_waitcnt vmcnt(30)
    v_mov_b32 v9, s9
    ds_write_b32 v6, v9
    s_cmp_ge_u32 s100, 192
    s_cbranch_scc1 L_fb154
    s_waitcnt vmcnt(25)
    s_cmp_ge_u32 s100, 64
    s_cbranch_scc1 L_fb154
    s_waitcnt vmcnt(19)
L_fb154:
    buffer_load_dwordx4 v2, s[24:27], s60 offen offset:0 nt lds
    buffer_load_dwordx4 v3, s[24:27], s60 offen offset:1024 nt lds
    buffer_load_dwordx4 v2, s[24:27], s60 offen offset:2048 nt lds
    buffer_load_dwordx4 v3, s[24:27], s60 offen offset:3072 nt lds
    s_mov_b32 m0, 90112
    s_add_u32 s61, s38, 32768
    buffer_load_dwordx4 v48, s[32:35], s61 offen offset:0 lds
    buffer_load_dwordx4 v49, s[32:35], s61 offen offset:1024 lds
    s_sub_u32 s60, s65, 8192
    s_mov_b32 m0, 24576
    s_waitcnt vmcnt(31)
    s_cmp_ge_u32 s100, 192
    s_cbranch_scc1 L_fb155
    s_waitcnt vmcnt(25)
    s_cmp_ge_u32 s100, 64
    s_cbranch_scc1 L_fb155
    s_waitcnt vmcnt(19)
L_fb155:
    buffer_load_dwordx4 v2, s[28:31], s60 offen offset:0 nt lds
    buffer_load_dwordx4 v3, s[28:31], s60 offen offset:1024 nt lds
    buffer_load_dwordx4 v2, s[28:31], s60 offen offset:2048 nt lds
    buffer_load_dwordx4 v3, s[28:31], s60 offen offset:3072 nt lds
    s_mov_b32 m0, 90112
    s_nop 0
    buffer_load_dwordx4 v50, s[32:35], s61 offen offset:2048 lds
    buffer_load_dwordx4 v51, s[32:35], s61 offen offset:3072 lds
    s_sub_u32 s60, s65, 4096
    s_mov_b32 m0, 28672
    s_waitcnt vmcnt(31)
    s_cmp_ge_u32 s100, 192
    s_cbranch_scc1 L_fb156
    s_waitcnt vmcnt(25)
    s_cmp_ge_u32 s100, 64
    s_cbranch_scc1 L_fb156
    s_waitcnt vmcnt(19)
L_fb156:
    buffer_load_dwordx4 v2, s[28:31], s60 offen offset:0 nt lds
    s_add_u32 s65, s65, 8192
    buffer_load_dwordx4 v3, s[28:31], s60 offen offset:1024 nt lds
    buffer_load_dwordx4 v2, s[28:31], s60 offen offset:2048 nt lds
    buffer_load_dwordx4 v3, s[28:31], s60 offen offset:3072 nt lds
    s_mov_b32 m0, 94208
    s_add_u32 s61, s38, 40960
    buffer_load_dwordx4 v48, s[32:35], s61 offen offset:0 lds
    s_add_u32 s60, s65, 0
    ds_read_b32 v8, v7
    s_mov_b32 m0, 49152
    ds_read_b32 v65, v64
    s_waitcnt vmcnt(30)
    s_cmp_ge_u32 s100, 192
    s_cbranch_scc1 L_fb157
    s_waitcnt vmcnt(24)
    s_cmp_ge_u32 s100, 64
    s_cbranch_scc1 L_fb157
    s_waitcnt vmcnt(19)
L_fb157:
    s_waitcnt lgkmcnt(0)
    v_cmp_gt_u32 vcc, 64, v8
    s_cbranch_vccnz L_pc158
L_pc158r:
    v_readfirstlane_b32 s100, v65
    buffer_load_dwordx4 v2, s[24:27], s60 offen offset:0 nt lds
    v_readfirstlane_b32 s9, v8
    buffer_load_dwordx4 v3, s[24:27], s60 offen offset:1024 nt lds
    s_add_u32 s7, s7, 1
    buffer_load_dwordx4 v2, s[24:27], s60 offen offset:2048 nt lds
    s_lshl4_add_u32 s9, s9, 32
    buffer_load_dwordx4 v3, s[24:27], s60 offen offset:3072 nt lds
    s_mov_b32 m0, 94208
    s_nop 0
    buffer_load_dwordx4 v49, s[32:35], s61 offen offset:1024 lds
    buffer_load_dwordx4 v50, s[32:35], s61 offen offset:2048 lds
    s_min_u32 s6, s6, s9
    s_add_u32 s6, s6, s8
    s_add_u32 s60, s65, 4096
    s_lshr_b32 s9, s6, 4
    s_min_u32 s9, s9, s7
    s_mov_b32 m0, 53248
    s_waitcnt vmcnt(30)
    v_mov_b32 v9, s9
    ds_write_b32 v6, v9
    s_cmp_ge_u32 s100, 192
    s_cbranch_scc1 L_fb159
    s_waitcnt vmcnt(25)
    s_cmp_ge_u32 s100, 64
    s_cbranch_scc1 L_fb159
    s_waitcnt vmcnt(19)
L_fb159:
    buffer_load_dwordx4 v2, s[24:27], s60 offen offset:0 nt lds
    buffer_load_dwordx4 v3, s[24:27], s60 offen offset:1024 nt lds
    buffer_load_dwordx4 v2, s[24:27], s60 offen offset:2048 nt lds
    buffer_load_dwordx4 v3, s[24:27], s60 offen offset:3072 nt lds
    s_mov_b32 m0, 94208
    s_nop 0
    buffer_load_dwordx4 v51, s[32:35], s61 offen offset:3072 lds
    ds_read_b32 v8, v7
    s_waitcnt lgkmcnt(0)
    v_cmp_gt_u32 vcc, 69, v8
    s_cbranch_vccnz L_pc160
L_pc160r:
    s_mov_b32 m0, 131072
    s_add_u32 s61, s38, 65536
    buffer_load_dwordx4 v48, s[32:35], s61 offen offset:0 lds
    s_sub_u32 s60, s65, 8192
    s_mov_b32 m0, 57344
    s_waitcnt vmcnt(31)
    s_cmp_ge_u32 s100, 192
    s_cbranch_scc1 L_fb161
    s_waitcnt vmcnt(25)
    s_cmp_ge_u32 s100, 64
    s_cbranch_scc1 L_fb161
    s_waitcnt vmcnt(19)
L_fb161:
    buffer_load_dwordx4 v2, s[28:31], s60 offen offset:0 nt lds
    buffer_load_dwordx4 v3, s[28:31], s60 offen offset:1024 nt lds
    buffer_load_dwordx4 v2, s[28:31], s60 offen offset:2048 nt lds
    buffer_load_dwordx4 v3, s[28:31], s60 offen offset:3072 nt lds
    s_mov_b32 m0, 131072
    s_nop 0
    buffer_load_dwordx4 v49, s[32:35], s61 offen offset:1024 lds
    buffer_load_dwordx4 v50, s[32:35], s61 offen offset:2048 lds
    s_sub_u32 s60, s65, 4096
    s_mov_b32 m0, 61440
    s_waitcnt vmcnt(31)
    s_cmp_ge_u32 s100, 192
    s_cbranch_scc1 L_fb162
    s_waitcnt vmcnt(25)
    s_cmp_ge_u32 s100, 64
    s_cbranch_scc1 L_fb162
    s_waitcnt vmcnt(19)
L_fb162:
    buffer_load_dwordx4 v2, s[28:31], s60 offen offset:0 nt lds
    s_add_u32 s65, s65, 8192
    buffer_load_dwordx4 v3, s[28:31], s60 offen offset:1024 nt lds
    buffer_load_dwordx4 v2, s[28:31], s60 offen offset:2048 nt lds
    buffer_load_dwordx4 v3, s[28:31], s60 offen offset:3072 nt lds
    s_mov_b32 m0, 131072
    s_nop 0
    buffer_load_dwordx4 v51, s[32:35], s61 offen offset:3072 lds
    s_add_u32 s60, s65, 0
    ds_read_b32 v8, v7
    s_mov_b32 m0, 65536
    ds_read_b32 v65, v64
    s_waitcnt vmcnt(30)
    s_cmp_ge_u32 s100, 192
    s_cbranch_scc1 L_fb163
    s_waitcnt vmcnt(24)
    s_cmp_ge_u32 s100, 64
    s_cbranch_scc1 L_fb163
    s_waitcnt vmcnt(19)
L_fb163:
    s_waitcnt lgkmcnt(0)
    v_cmp_gt_u32 vcc, 65, v8
    s_cbranch_vccnz L_pc164
L_pc164r:
    v_readfirstlane_b32 s100, v65
    buffer_load_dwordx4 v2, s[24:27], s60 offen offset:0 nt lds
    v_readfirstlane_b32 s9, v8
    buffer_load_dwordx4 v3, s[24:27], s60 offen offset:1024 nt lds
    s_add_u32 s7, s7, 2
    buffer_load_dwordx4 v2, s[24:27], s60 offen offset:2048 nt lds
    s_lshl4_add_u32 s9, s9, 32
    buffer_load_dwordx4 v3, s[24:27], s60 offen offset:3072 nt lds
    s_mov_b32 m0, 135168
    s_add_u32 s61, s38, 73728
    buffer_load_dwordx4 v48, s[32:35], s61 offen offset:0 lds
    buffer_load_dwordx4 v49, s[32:35], s61 offen offset:1024 lds
    s_min_u32 s6, s6, s9
    s_add_u32 s6, s6, s8
    s_add_u32 s60, s65, 4096
    s_add_u32 s6, s6, 16
    s_lshr_b32 s9, s6, 4
    s_min_u32 s9, s9, s7
    s_mov_b32 m0, 69632
    s_waitcnt vmcnt(30)
    v_mov_b32 v9, s9
    ds_write_b32 v6, v9
    v_add_u32 v250, 32768, v252
    v_add_u32 v251, 32768, v253
    ds_read_b64_tr_b16 a[176:177], v250 offset:0
    ds_read_b64_tr_b16 a[178:179], v251 offset:0
    ds_read_b64_tr_b16 a[180:181], v250 offset:8
    ds_read_b64_tr_b16 a[182:183], v251 offset:8
    ds_read_b64_tr_b16 a[184:185], v250 offset:8192
    ds_read_b64_tr_b16 a[186:187], v251 offset:8192
    ds_read_b64_tr_b16 a[188:189], v250 offset:8200
    ds_read_b64_tr_b16 a[190:191], v251 offset:8200
    s_cmp_ge_u32 s100, 192
    s_cbranch_scc1 L_fb165
    s_waitcnt vmcnt(25)
    s_cmp_ge_u32 s100, 64
    s_cbranch_scc1 L_fb165
    s_waitcnt vmcnt(19)
L_fb165:
    buffer_load_dwordx4 v2, s[24:27], s60 offen offset:0 nt lds
    buffer_load_dwordx4 v3, s[24:27], s60 offen offset:1024 nt lds
    buffer_load_dwordx4 v2, s[24:27], s60 offen offset:2048 nt lds
    buffer_load_dwordx4 v3, s[24:27], s60 offen offset:3072 nt lds
    s_mov_b32 m0, 135168
    s_nop 0
    buffer_load_dwordx4 v50, s[32:35], s61 offen offset:2048 lds
    buffer_load_dwordx4 v51, s[32:35], s61 offen offset:3072 lds
    s_sub_u32 s60, s65, 8192
    s_mov_b32 m0, 73728
    s_waitcnt vmcnt(31)
    s_cmp_ge_u32 s100, 192
    s_cbranch_scc1 L_fb166
    s_waitcnt vmcnt(25)
    s_cmp_ge_u32 s100, 64
    s_cbranch_scc1 L_fb166
    s_waitcnt vmcnt(19)
L_fb166:
    buffer_load_dwordx4 v2, s[28:31], s60 offen offset:0 nt lds
    buffer_load_dwordx4 v3, s[28:31], s60 offen offset:1024 nt lds
    buffer_load_dwordx4 v2, s[28:31], s60 offen offset:2048 nt lds
    buffer_load_dwordx4 v3, s[28:31], s60 offen offset:3072 nt lds
    s_mov_b32 m0, 139264
    s_add_u32 s61, s38, 98304
    buffer_load_dwordx4 v48, s[32:35], s61 offen offset:0 lds
    buffer_load_dwordx4 v49, s[32:35], s61 offen offset:1024 lds
    s_sub_u32 s60, s65, 4096
    s_mov_b32 m0, 77824
    s_waitcnt vmcnt(31)
    s_cmp_ge_u32 s100, 192
    s_cbranch_scc1 L_fb167
    s_waitcnt vmcnt(25)
    s_cmp_ge_u32 s100, 64
    s_cbranch_scc1 L_fb167
    s_waitcnt vmcnt(19)
L_fb167:
    buffer_load_dwordx4 v2, s[28:31], s60 offen offset:0 nt lds
    s_add_u32 s65, s65, 8192
    buffer_load_dwordx4 v3, s[28:31], s60 offen offset:1024 nt lds
    buffer_load_dwordx4 v2, s[28:31], s60 offen offset:2048 nt lds
    buffer_load_dwordx4 v3, s[28:31], s60 offen offset:3072 nt lds
    s_mov_b32 m0, 139264
    s_nop 0
    buffer_load_dwordx4 v50, s[32:35], s61 offen offset:2048 lds
    s_add_u32 s60, s65, 0
    ds_read_b32 v8, v7
    s_mov_b32 m0, 98304
    ds_read_b32 v65, v64
    s_waitcnt vmcnt(30)
    s_cmp_ge_u32 s100, 192
    s_cbranch_scc1 L_fb168
    s_waitcnt vmcnt(24)
    s_cmp_ge_u32 s100, 64
    s_cbranch_scc1 L_fb168
    s_waitcnt vmcnt(19)
L_fb168:
    s_waitcnt lgkmcnt(0)
    v_cmp_gt_u32 vcc, 67, v8
    s_cbranch_vccnz L_pc169
L_pc169r:
    v_readfirstlane_b32 s100, v65
    buffer_load_dwordx4 v2, s[24:27], s60 offen offset:0 nt lds
    v_readfirstlane_b32 s9, v8
    buffer_load_dwordx4 v3, s[24:27], s60 offen offset:1024 nt lds
    s_add_u32 s7, s7, 1
    buffer_load_dwordx4 v2, s[24:27], s60 offen offset:2048 nt lds
    s_lshl4_add_u32 s9, s9, 32
    buffer_load_dwordx4 v3, s[24:27], s60 offen offset:3072 nt lds
    s_mov_b32 m0, 139264
    s_nop 0
    buffer_load_dwordx4 v51, s[32:35], s61 offen offset:3072 lds
    s_mov_b32 m0, 143360
    s_add_u32 s61, s38, 106496
    buffer_load_dwordx4 v48, s[32:35], s61 offen offset:0 lds
    s_min_u32 s6, s6, s9
    s_add_u32 s6, s6, s8
    s_add_u32 s60, s65, 4096
    s_lshr_b32 s9, s6, 4
    s_min_u32 s9, s9, s7
    s_mov_b32 m0, 102400
    s_waitcnt vmcnt(30)
    v_mov_b32 v9, s9
    ds_write_b32 v6, v9
    s_cmp_ge_u32 s100, 192
    s_cbranch_scc1 L_fb170
    s_waitcnt vmcnt(25)
    s_cmp_ge_u32 s100, 64
    s_cbranch_scc1 L_fb170
    s_waitcnt vmcnt(19)
L_fb170:
    buffer_load_dwordx4 v2, s[24:27], s60 offen offset:0 nt lds
    buffer_load_dwordx4 v3, s[24:27], s60 offen offset:1024 nt lds
    buffer_load_dwordx4 v2, s[24:27], s60 offen offset:2048 nt lds
    buffer_load_dwordx4 v3, s[24:27], s60 offen offset:3072 nt lds
    s_mov_b32 m0, 143360
    s_nop 0
    buffer_load_dwordx4 v49, s[32:35], s61 offen offset:1024 lds
    buffer_load_dwordx4 v50, s[32:35], s61 offen offset:2048 lds
    s_sub_u32 s60, s65, 8192
    s_mov_b32 m0, 106496
    s_waitcnt vmcnt(31)
    s_cmp_ge_u32 s100, 192
    s_cbranch_scc1 L_fb171
    s_waitcnt vmcnt(25)
    s_cmp_ge_u32 s100, 64
    s_cbranch_scc1 L_fb171
    s_waitcnt vmcnt(19)
L_fb171:
    buffer_load_dwordx4 v2, s[28:31], s60 offen offset:0 nt lds
    buffer_load_dwordx4 v3, s[28:31], s60 offen offset:1024 nt lds
    buffer_load_dwordx4 v2, s[28:31], s60 offen offset:2048 nt lds
    buffer_load_dwordx4 v3, s[28:31], s60 offen offset:3072 nt lds
    s_mov_b32 m0, 143360
    s_nop 0
    buffer_load_dwordx4 v51, s[32:35], s61 offen offset:3072 lds
    ds_read_b32 v8, v7
    s_waitcnt lgkmcnt(0)
    v_cmp_gt_u32 vcc, 72, v8
    s_cbranch_vccnz L_pc172
L_pc172r:
    s_mov_b32 m0, 32768
    s_add_u32 s61, s39, 0
    buffer_load_dwordx4 v48, s[32:35], s61 offen offset:0 lds
    s_sub_u32 s60, s65, 4096
    s_mov_b32 m0, 110592
    s_waitcnt vmcnt(31)
    s_cmp_ge_u32 s100, 192
    s_cbranch_scc1 L_fb173
    s_waitcnt vmcnt(25)
    s_cmp_ge_u32 s100, 64
    s_cbranch_scc1 L_fb173
    s_waitcnt vmcnt(19)
L_fb173:
    buffer_load_dwordx4 v2, s[28:31], s60 offen offset:0 nt lds
    s_add_u32 s65, s65, 8192
    buffer_load_dwordx4 v3, s[28:31], s60 offen offset:1024 nt lds
    buffer_load_dwordx4 v2, s[28:31], s60 offen offset:2048 nt lds
    buffer_load_dwordx4 v3, s[28:31], s60 offen offset:3072 nt lds
    s_mov_b32 m0, 32768
    s_nop 0
    buffer_load_dwordx4 v49, s[32:35], s61 offen offset:1024 lds
    s_add_u32 s60, s65, 0
    ds_read_b32 v8, v7
    s_mov_b32 m0, 114688
    ds_read_b32 v65, v64
    s_waitcnt vmcnt(30)
    s_cmp_ge_u32 s100, 192
    s_cbranch_scc1 L_fb174
    s_waitcnt vmcnt(24)
    s_cmp_ge_u32 s100, 64
    s_cbranch_scc1 L_fb174
    s_waitcnt vmcnt(19)
L_fb174:
    s_waitcnt lgkmcnt(0)
    v_cmp_gt_u32 vcc, 68, v8
    s_cbranch_vccnz L_pc175
L_pc175r:
    v_readfirstlane_b32 s100, v65
    buffer_load_dwordx4 v2, s[24:27], s60 offen offset:0 nt lds
    v_readfirstlane_b32 s9, v8
    buffer_load_dwordx4 v3, s[24:27], s60 offen offset:1024 nt lds
    s_add_u32 s7, s7, 2
    buffer_load_dwordx4 v2, s[24:27], s60 offen offset:2048 nt lds
    s_lshl4_add_u32 s9, s9, 32
    buffer_load_dwordx4 v3, s[24:27], s60 offen offset:3072 nt lds
    s_mov_b32 m0, 32768
    s_nop 0
    buffer_load_dwordx4 v50, s[32:35], s61 offen offset:2048 lds
    buffer_load_dwordx4 v51, s[32:35], s61 offen offset:3072 lds
    s_min_u32 s6, s6, s9
    s_add_u32 s6, s6, s8
    s_add_u32 s60, s65, 4096
    s_add_u32 s6, s6, 16
    s_lshr_b32 s9, s6, 4
    s_min_u32 s9, s9, s7
    s_mov_b32 m0, 118784
    s_waitcnt vmcnt(30)
    v_mov_b32 v9, s9
    ds_write_b32 v6, v9
    v_add_u32 v250, 81920, v252
    v_add_u32 v251, 81920, v253
    ds_read_b64_tr_b16 a[192:193], v250 offset:0
    ds_read_b64_tr_b16 a[194:195], v251 offset:0
    ds_read_b64_tr_b16 a[196:197], v250 offset:8
    ds_read_b64_tr_b16 a[198:199], v251 offset:8
    ds_read_b64_tr_b16 a[200:201], v250 offset:8192
    ds_read_b64_tr_b16 a[202:203], v251 offset:8192
    ds_read_b64_tr_b16 a[204:205], v250 offset:8200
    ds_read_b64_tr_b16 a[206:207], v251 offset:8200
    s_cmp_ge_u32 s100, 192
    s_cbranch_scc1 L_fb176
    s_waitcnt vmcnt(25)
    s_cmp_ge_u32 s100, 64
    s_cbranch_scc1 L_fb176
    s_waitcnt vmcnt(19)
L_fb176:
    buffer_load_dwordx4 v2, s[24:27], s60 offen offset:0 nt lds
    buffer_load_dwordx4 v3, s[24:27], s60 offen offset:1024 nt lds
    buffer_load_dwordx4 v2, s[24:27], s60 offen offset:2048 nt lds
    buffer_load_dwordx4 v3, s[24:27], s60 offen offset:3072 nt lds
    s_mov_b32 m0, 36864
    s_add_u32 s61, s39, 8192
    buffer_load_dwordx4 v48, s[32:35], s61 offen offset:0 lds
    buffer_load_dwordx4 v49, s[32:35], s61 offen offset:1024 lds
    s_sub_u32 s60, s65, 8192
    s_mov_b32 m0, 122880
    s_waitcnt vmcnt(31)
    s_cmp_ge_u32 s100, 192
    s_cbranch_scc1 L_fb177
    s_waitcnt vmcnt(25)
    s_cmp_ge_u32 s100, 64
    s_cbranch_scc1 L_fb177
    s_waitcnt vmcnt(19)
L_fb177:
    buffer_load_dwordx4 v2, s[28:31], s60 offen offset:0 nt lds
    buffer_load_dwordx4 v3, s[28:31], s60 offen offset:1024 nt lds
    buffer_load_dwordx4 v2, s[28:31], s60 offen offset:2048 nt lds
    buffer_load_dwordx4 v3, s[28:31], s60 offen offset:3072 nt lds
    s_mov_b32 m0, 36864
    s_nop 0
    buffer_load_dwordx4 v50, s[32:35], s61 offen offset:2048 lds
    buffer_load_dwordx4 v51, s[32:35], s61 offen offset:3072 lds
    s_sub_u32 s60, s65, 4096
    s_mov_b32 m0, 126976
    s_waitcnt vmcnt(31)
    s_cmp_ge_u32 s100, 192
    s_cbranch_scc1 L_fb178
    s_waitcnt vmcnt(25)
    s_cmp_ge_u32 s100, 64
    s_cbranch_scc1 L_fb178
    s_waitcnt vmcnt(19)
L_fb178:
    buffer_load_dwordx4 v2, s[28:31], s60 offen offset:0 nt lds
    s_add_u32 s65, s65, 8192
    buffer_load_dwordx4 v3, s[28:31], s60 offen offset:1024 nt lds
    buffer_load_dwordx4 v2, s[28:31], s60 offen offset:2048 nt lds
    buffer_load_dwordx4 v3, s[28:31], s60 offen offset:3072 nt lds
    s_mov_b32 m0, 40960
    s_add_u32 s61, s39, 32768
    buffer_load_dwordx4 v48, s[32:35], s61 offen offset:0 lds
    s_add_u32 s60, s65, 0
    ds_read_b32 v8, v7
    s_mov_b32 m0, 0
    ds_read_b32 v65, v64
    s_waitcnt vmcnt(30)
    s_cmp_ge_u32 s100, 192
    s_cbranch_scc1 L_fb179
    s_waitcnt vmcnt(24)
    s_cmp_ge_u32 s100, 64
    s_cbranch_scc1 L_fb179
    s_waitcnt vmcnt(19)
L_fb179:
    s_waitcnt lgkmcnt(0)
    v_cmp_gt_u32 vcc, 70, v8
    s_cbranch_vccnz L_pc180
L_pc180r:
    v_readfirstlane_b32 s100, v65
    buffer_load_dwordx4 v2, s[24:27], s60 offen offset:0 nt lds
    v_readfirstlane_b32 s9, v8
    buffer_load_dwordx4 v3, s[24:27], s60 offen offset:1024 nt lds
    s_add_u32 s7, s7, 1
    buffer_load_dwordx4 v2, s[24:27], s60 offen offset:2048 nt lds
    s_lshl4_add_u32 s9, s9, 32
    buffer_load_dwordx4 v3, s[24:27], s60 offen offset:3072 nt lds
    s_mov_b32 m0, 40960
    s_nop 0
    buffer_load_dwordx4 v49, s[32:35], s61 offen offset:1024 lds
    buffer_load_dwordx4 v50, s[32:35], s61 offen offset:2048 lds
    s_min_u32 s6, s6, s9
    s_add_u32 s6, s6, s8
    s_add_u32 s60, s65, 4096
    s_lshr_b32 s9, s6, 4
    s_min_u32 s9, s9, s7
    s_mov_b32 m0, 4096
    s_waitcnt vmcnt(30)
    v_mov_b32 v9, s9
    ds_write_b32 v6, v9
    s_cmp_ge_u32 s100, 192
    s_cbranch_scc1 L_fb181
    s_waitcnt vmcnt(25)
    s_cmp_ge_u32 s100, 64
    s_cbranch_scc1 L_fb181
    s_waitcnt vmcnt(19)
L_fb181:
    buffer_load_dwordx4 v2, s[24:27], s60 offen offset:0 nt lds
    buffer_load_dwordx4 v3, s[24:27], s60 offen offset:1024 nt lds
    buffer_load_dwordx4 v2, s[24:27], s60 offen offset:2048 nt lds
    buffer_load_dwordx4 v3, s[24:27], s60 offen offset:3072 nt lds
    s_mov_b32 m0, 40960
    s_nop 0
    buffer_load_dwordx4 v51, s[32:35], s61 offen offset:3072 lds
    s_mov_b32 m0, 45056
    s_add_u32 s61, s39, 40960
    buffer_load_dwordx4 v48, s[32:35], s61 offen offset:0 lds
    s_sub_u32 s60, s65, 8192
    s_mov_b32 m0, 8192
    s_waitcnt vmcnt(31)
    s_cmp_ge_u32 s100, 192
    s_cbranch_scc1 L_fb182
    s_waitcnt vmcnt(25)
    s_cmp_ge_u32 s100, 64
    s_cbranch_scc1 L_fb182
    s_waitcnt vmcnt(19)
L_fb182:
    buffer_load_dwordx4 v2, s[28:31], s60 offen offset:0 nt lds
    buffer_load_dwordx4 v3, s[28:31], s60 offen offset:1024 nt lds
    buffer_load_dwordx4 v2, s[28:31], s60 offen offset:2048 nt lds
    buffer_load_dwordx4 v3, s[28:31], s60 offen offset:3072 nt lds
    s_mov_b32 m0, 45056
    s_nop 0
    buffer_load_dwordx4 v49, s[32:35], s61 offen offset:1024 lds
    buffer_load_dwordx4 v50, s[32:35], s61 offen offset:2048 lds
    s_sub_u32 s60, s65, 4096
    s_mov_b32 m0, 12288
    s_waitcnt vmcnt(31)
    s_cmp_ge_u32 s100, 192
    s_cbranch_scc1 L_fb183
    s_waitcnt vmcnt(25)
    s_cmp_ge_u32 s100, 64
    s_cbranch_scc1 L_fb183
    s_waitcnt vmcnt(19)
L_fb183:
    buffer_load_dwordx4 v2, s[28:31], s60 offen offset:0 nt lds
    s_add_u32 s65, s65, 8192
    buffer_load_dwordx4 v3, s[28:31], s60 offen offset:1024 nt lds
    buffer_load_dwordx4 v2, s[28:31], s60 offen offset:2048 nt lds
    buffer_load_dwordx4 v3, s[28:31], s60 offen offset:3072 nt lds
    s_mov_b32 m0, 45056
    s_nop 0
    buffer_load_dwordx4 v51, s[32:35], s61 offen offset:3072 lds
    s_add_u32 s60, s65, 0
    ds_read_b32 v8, v7
    s_mov_b32 m0, 16384
    ds_read_b32 v65, v64
    s_waitcnt vmcnt(30)
    s_cmp_ge_u32 s100, 192
    s_cbranch_scc1 L_fb184
    s_waitcnt vmcnt(24)
    s_cmp_ge_u32 s100, 64
    s_cbranch_scc1 L_fb184
    s_waitcnt vmcnt(19)
L_fb184:
    s_waitcnt lgkmcnt(0)
    v_cmp_gt_u32 vcc, 71, v8
    s_cbranch_vccnz L_pc185
L_pc185r:
    v_readfirstlane_b32 s100, v65
    buffer_load_dwordx4 v2, s[24:27], s60 offen offset:0 nt lds
    v_readfirstlane_b32 s9, v8
    buffer_load_dwordx4 v3, s[24:27], s60 offen offset:1024 nt lds
    s_add_u32 s7, s7, 2
    buffer_load_dwordx4 v2, s[24:27], s60 offen offset:2048 nt lds
    s_lshl4_add_u32 s9, s9, 32
    buffer_load_dwordx4 v3, s[24:27], s60 offen offset:3072 nt lds
    ds_read_b32 v8, v7
    s_waitcnt lgkmcnt(0)
    v_cmp_gt_u32 vcc, 75, v8
    s_cbranch_vccnz L_pc186
L_pc186r:
    s_mov_b32 m0, 81920
    s_add_u32 s61, s39, 65536
    buffer_load_dwordx4 v48, s[32:35], s61 offen offset:0 lds
    buffer_load_dwordx4 v49, s[32:35], s61 offen offset:1024 lds
    s_min_u32 s6, s6, s9
    s_add_u32 s6, s6, s8
    s_add_u32 s60, s65, 4096
    s_add_u32 s6, s6, 16
    s_lshr_b32 s9, s6, 4
    s_min_u32 s9, s9, s7
    s_mov_b32 m0, 20480
    s_waitcnt vmcnt(30)
    v_mov_b32 v9, s9
    ds_write_b32 v6, v9
    v_add_u32 v250, 131072, v252
    v_add_u32 v251, 131072, v253
    ds_read_b64_tr_b16 a[208:209], v250 offset:0
    ds_read_b64_tr_b16 a[210:211], v251 offset:0
    ds_read_b64_tr_b16 a[212:213], v250 offset:8
    ds_read_b64_tr_b16 a[214:215], v251 offset:8
    ds_read_b64_tr_b16 a[216:217], v250 offset:8192
    ds_read_b64_tr_b16 a[218:219], v251 offset:8192
    ds_read_b64_tr_b16 a[220:221], v250 offset:8200
    ds_read_b64_tr_b16 a[222:223], v251 offset:8200
    s_cmp_ge_u32 s100, 192
    s_cbranch_scc1 L_fb187
    s_waitcnt vmcnt(25)
    s_cmp_ge_u32 s100, 64
    s_cbranch_scc1 L_fb187
    s_waitcnt vmcnt(19)
L_fb187:
    buffer_load_dwordx4 v2, s[24:27], s60 offen offset:0 nt lds
    buffer_load_dwordx4 v3, s[24:27], s60 offen offset:1024 nt lds
    buffer_load_dwordx4 v2, s[24:27], s60 offen offset:2048 nt lds
    buffer_load_dwordx4 v3, s[24:27], s60 offen offset:3072 nt lds
    s_mov_b32 m0, 81920
    s_nop 0
    buffer_load_dwordx4 v50, s[32:35], s61 offen offset:2048 lds
    buffer_load_dwordx4 v51, s[32:35], s61 offen offset:3072 lds
    s_sub_u32 s60, s65, 8192
    s_mov_b32 m0, 24576
    s_waitcnt vmcnt(31)
    s_cmp_ge_u32 s100, 192
    s_cbranch_scc1 L_fb188
    s_waitcnt vmcnt(25)
    s_cmp_ge_u32 s100, 64
    s_cbranch_scc1 L_fb188
    s_waitcnt vmcnt(19)
L_fb188:
    buffer_load_dwordx4 v2, s[28:31], s60 offen offset:0 nt lds
    buffer_load_dwordx4 v3, s[28:31], s60 offen offset:1024 nt lds
    buffer_load_dwordx4 v2, s[28:31], s60 offen offset:2048 nt lds
    buffer_load_dwordx4 v3, s[28:31], s60 offen offset:3072 nt lds
    s_mov_b32 m0, 86016
    s_add_u32 s61, s39, 73728
    buffer_load_dwordx4 v48, s[32:35], s61 offen offset:0 lds
    buffer_load_dwordx4 v49, s[32:35], s61 offen offset:1024 lds
    s_sub_u32 s60, s65, 4096
    s_mov_b32 m0, 28672
    s_waitcnt vmcnt(31)
    s_cmp_ge_u32 s100, 192
    s_cbranch_scc1 L_fb189
    s_waitcnt vmcnt(25)
    s_cmp_ge_u32 s100, 64
    s_cbranch_scc1 L_fb189
    s_waitcnt vmcnt(19)
L_fb189:
    buffer_load_dwordx4 v2, s[28:31], s60 offen offset:0 nt lds
    s_add_u32 s65, s65, 8192
    buffer_load_dwordx4 v3, s[28:31], s60 offen offset:1024 nt lds
    buffer_load_dwordx4 v2, s[28:31], s60 offen offset:2048 nt lds
    buffer_load_dwordx4 v3, s[28:31], s60 offen offset:3072 nt lds
    s_mov_b32 m0, 86016
    s_nop 0
    buffer_load_dwordx4 v50, s[32:35], s61 offen offset:2048 lds
    s_add_u32 s60, s65, 0
    ds_read_b32 v8, v7
    s_mov_b32 m0, 49152
    ds_read_b32 v65, v64
    s_waitcnt vmcnt(30)
    s_cmp_ge_u32 s100, 192
    s_cbranch_scc1 L_fb190
    s_waitcnt vmcnt(24)
    s_cmp_ge_u32 s100, 64
    s_cbranch_scc1 L_fb190
    s_waitcnt vmcnt(19)
L_fb190:
    s_waitcnt lgkmcnt(0)
    v_cmp_gt_u32 vcc, 73, v8
    s_cbranch_vccnz L_pc191
L_pc191r:
    v_readfirstlane_b32 s100, v65
    buffer_load_dwordx4 v2, s[24:27], s60 offen offset:0 nt lds
    v_readfirstlane_b32 s9, v8
    buffer_load_dwordx4 v3, s[24:27], s60 offen offset:1024 nt lds
    s_add_u32 s7, s7, 1
    buffer_load_dwordx4 v2, s[24:27], s60 offen offset:2048 nt lds
    s_lshl4_add_u32 s9, s9, 32
    buffer_load_dwordx4 v3, s[24:27], s60 offen offset:3072 nt lds
    s_mov_b32 m0, 86016
    s_nop 0
    buffer_load_dwordx4 v51, s[32:35], s61 offen offset:3072 lds
    s_mov_b32 m0, 90112
    s_add_u32 s61, s39, 98304
    buffer_load_dwordx4 v48, s[32:35], s61 offen offset:0 lds
    s_min_u32 s6, s6, s9
    s_add_u32 s6, s6, s8
    s_add_u32 s60, s65, 4096
    s_lshr_b32 s9, s6, 4
    s_min_u32 s9, s9, s7
    s_mov_b32 m0, 53248
    s_waitcnt vmcnt(30)
    v_mov_b32 v9, s9
    ds_write_b32 v6, v9
    s_cmp_ge_u32 s100, 192
    s_cbranch_scc1 L_fb192
    s_waitcnt vmcnt(25)
    s_cmp_ge_u32 s100, 64
    s_cbranch_scc1 L_fb192
    s_waitcnt vmcnt(19)
L_fb192:
    buffer_load_dwordx4 v2, s[24:27], s60 offen offset:0 nt lds
    buffer_load_dwordx4 v3, s[24:27], s60 offen offset:1024 nt lds
    buffer_load_dwordx4 v2, s[24:27], s60 offen offset:2048 nt lds
    buffer_load_dwordx4 v3, s[24:27], s60 offen offset:3072 nt lds
    s_mov_b32 m0, 90112
    s_nop 0
    buffer_load_dwordx4 v49, s[32:35], s61 offen offset:1024 lds
    buffer_load_dwordx4 v50, s[32:35], s61 offen offset:2048 lds
    s_sub_u32 s60, s65, 8192
    s_mov_b32 m0, 57344
    s_waitcnt vmcnt(31)
    s_cmp_ge_u32 s100, 192
    s_cbranch_scc1 L_fb193
    s_waitcnt vmcnt(25)
    s_cmp_ge_u32 s100, 64
    s_cbranch_scc1 L_fb193
    s_waitcnt vmcnt(19)
L_fb193:
    buffer_load_dwordx4 v2, s[28:31], s60 offen offset:0 nt lds
    buffer_load_dwordx4 v3, s[28:31], s60 offen offset:1024 nt lds
    buffer_load_dwordx4 v2, s[28:31], s60 offen offset:2048 nt lds
    buffer_load_dwordx4 v3, s[28:31], s60 offen offset:3072 nt lds
    s_mov_b32 m0, 90112
    s_nop 0
    buffer_load_dwordx4 v51, s[32:35], s61 offen offset:3072 lds
    s_mov_b32 m0, 94208
    s_add_u32 s61, s39, 106496
    buffer_load_dwordx4 v48, s[32:35], s61 offen offset:0 lds
    s_sub_u32 s60, s65, 4096
    s_mov_b32 m0, 61440
    s_waitcnt vmcnt(31)
    s_cmp_ge_u32 s100, 192
    s_cbranch_scc1 L_fb194
    s_waitcnt vmcnt(25)
    s_cmp_ge_u32 s100, 64
    s_cbranch_scc1 L_fb194
    s_waitcnt vmcnt(19)
L_fb194:
    buffer_load_dwordx4 v2, s[28:31], s60 offen offset:0 nt lds
    s_add_u32 s65, s65, 8192
    buffer_load_dwordx4 v3, s[28:31], s60 offen offset:1024 nt lds
    buffer_load_dwordx4 v2, s[28:31], s60 offen offset:2048 nt lds
    buffer_load_dwordx4 v3, s[28:31], s60 offen offset:3072 nt lds
    s_mov_b32 m0, 94208
    s_nop 0
    buffer_load_dwordx4 v49, s[32:35], s61 offen offset:1024 lds
    s_add_u32 s60, s65, 0
    ds_read_b32 v8, v7
    s_mov_b32 m0, 65536
    ds_read_b32 v65, v64
    s_waitcnt vmcnt(30)
    s_cmp_ge_u32 s100, 192
    s_cbranch_scc1 L_fb195
    s_waitcnt vmcnt(24)
    s_cmp_ge_u32 s100, 64
    s_cbranch_scc1 L_fb195
    s_waitcnt vmcnt(19)
L_fb195:
    s_waitcnt lgkmcnt(0)
    v_cmp_gt_u32 vcc, 74, v8
    s_cbranch_vccnz L_pc196
L_pc196r:
    v_readfirstlane_b32 s100, v65
    buffer_load_dwordx4 v2, s[24:27], s60 offen offset:0 nt lds
    v_readfirstlane_b32 s9, v8
    buffer_load_dwordx4 v3, s[24:27], s60 offen offset:1024 nt lds
    s_add_u32 s7, s7, 2
    buffer_load_dwordx4 v2, s[24:27], s60 offen offset:2048 nt lds
    s_lshl4_add_u32 s9, s9, 32
    buffer_load_dwordx4 v3, s[24:27], s60 offen offset:3072 nt lds
    s_mov_b32 m0, 94208
    s_nop 0
    buffer_load_dwordx4 v50, s[32:35], s61 offen offset:2048 lds
    buffer_load_dwordx4 v51, s[32:35], s61 offen offset:3072 lds
    s_min_u32 s6, s6, s9
    s_add_u32 s6, s6, s8
    s_add_u32 s60, s65, 4096
    s_add_u32 s6, s6, 16
    s_lshr_b32 s9, s6, 4
    s_min_u32 s9, s9, s7
    s_mov_b32 m0, 69632
    s_waitcnt vmcnt(30)
    v_mov_b32 v9, s9
    ds_write_b32 v6, v9
    v_add_u32 v250, 32768, v252
    v_add_u32 v251, 32768, v253
    ds_read_b64_tr_b16 a[224:225], v250 offset:0
    ds_read_b64_tr_b16 a[226:227], v251 offset:0
    ds_read_b64_tr_b16 a[228:229], v250 offset:8
    ds_read_b64_tr_b16 a[230:231], v251 offset:8
    ds_read_b64_tr_b16 a[232:233], v250 offset:8192
    ds_read_b64_tr_b16 a[234:235], v251 offset:8192
    ds_read_b64_tr_b16 a[236:237], v250 offset:8200
    ds_read_b64_tr_b16 a[238:239], v251 offset:8200
    s_cmp_ge_u32 s100, 192
    s_cbranch_scc1 L_fb197
    s_waitcnt vmcnt(25)
    s_cmp_ge_u32 s100, 64
    s_cbranch_scc1 L_fb197
    s_waitcnt vmcnt(19)
L_fb197:
    buffer_load_dwordx4 v2, s[24:27], s60 offen offset:0 nt lds
    buffer_load_dwordx4 v3, s[24:27], s60 offen offset:1024 nt lds
    buffer_load_dwordx4 v2, s[24:27], s60 offen offset:2048 nt lds
    buffer_load_dwordx4 v3, s[24:27], s60 offen offset:3072 nt lds
    s_sub_u32 s60, s65, 8192
    s_mov_b32 m0, 73728
    s_waitcnt vmcnt(29)
    s_cmp_ge_u32 s100, 192
    s_cbranch_scc1 L_fb198
    s_waitcnt vmcnt(23)
    s_cmp_ge_u32 s100, 64
    s_cbranch_scc1 L_fb198
    s_waitcnt vmcnt(17)
L_fb198:
    buffer_load_dwordx4 v2, s[28:31], s60 offen offset:0 nt lds
    buffer_load_dwordx4 v3, s[28:31], s60 offen offset:1024 nt lds
    buffer_load_dwordx4 v2, s[28:31], s60 offen offset:2048 nt lds
    buffer_load_dwordx4 v3, s[28:31], s60 offen offset:3072 nt lds
    s_sub_u32 s60, s65, 4096
    s_mov_b32 m0, 77824
    s_waitcnt vmcnt(27)
    s_cmp_ge_u32 s100, 192
    s_cbranch_scc1 L_fb199
    s_waitcnt vmcnt(21)
    s_cmp_ge_u32 s100, 64
    s_cbranch_scc1 L_fb199
    s_waitcnt vmcnt(15)
L_fb199:
    buffer_load_dwordx4 v2, s[28:31], s60 offen offset:0 nt lds
    s_add_u32 s65, s65, 8192
    buffer_load_dwordx4 v3, s[28:31], s60 offen offset:1024 nt lds
    buffer_load_dwordx4 v2, s[28:31], s60 offen offset:2048 nt lds
    buffer_load_dwordx4 v3, s[28:31], s60 offen offset:3072 nt lds
    s_add_u32 s60, s65, 0
    ds_read_b32 v8, v7
    s_mov_b32 m0, 98304
    ds_read_b32 v65, v64
    s_waitcnt vmcnt(25)
    s_cmp_ge_u32 s100, 192
    s_cbranch_scc1 L_fb200
    s_waitcnt vmcnt(19)
    s_cmp_ge_u32 s100, 64
    s_cbranch_scc1 L_fb200
    s_waitcnt vmcnt(14)
L_fb200:
    s_waitcnt lgkmcnt(0)
    v_cmp_gt_u32 vcc, 76, v8
    s_cbranch_vccnz L_pc201
L_pc201r:
    v_readfirstlane_b32 s100, v65
    buffer_load_dwordx4 v2, s[24:27], s60 offen offset:0 nt lds
    v_readfirstlane_b32 s9, v8
    buffer_load_dwordx4 v3, s[24:27], s60 offen offset:1024 nt lds
    s_add_u32 s7, s7, 1
    buffer_load_dwordx4 v2, s[24:27], s60 offen offset:2048 nt lds
    s_lshl4_add_u32 s9, s9, 32
    buffer_load_dwordx4 v3, s[24:27], s60 offen offset:3072 nt lds
    s_min_u32 s6, s6, s9
    s_add_u32 s6, s6, s8
    s_add_u32 s60, s65, 4096
    s_lshr_b32 s9, s6, 4
    s_min_u32 s9, s9, s7
    s_mov_b32 m0, 102400
    s_waitcnt vmcnt(23)
    v_mov_b32 v9, s9
    ds_write_b32 v6, v9
    s_cmp_ge_u32 s100, 192
    s_cbranch_scc1 L_fb202
    s_waitcnt vmcnt(18)
    s_cmp_ge_u32 s100, 64
    s_cbranch_scc1 L_fb202
    s_waitcnt vmcnt(12)
L_fb202:
    buffer_load_dwordx4 v2, s[24:27], s60 offen offset:0 nt lds
    buffer_load_dwordx4 v3, s[24:27], s60 offen offset:1024 nt lds
    buffer_load_dwordx4 v2, s[24:27], s60 offen offset:2048 nt lds
    buffer_load_dwordx4 v3, s[24:27], s60 offen offset:3072 nt lds
    s_sub_u32 s60, s65, 8192
    s_mov_b32 m0, 106496
    s_waitcnt vmcnt(22)
    s_cmp_ge_u32 s100, 192
    s_cbranch_scc1 L_fb203
    s_waitcnt vmcnt(16)
    s_cmp_ge_u32 s100, 64
    s_cbranch_scc1 L_fb203
    s_waitcnt vmcnt(12)
L_fb203:
    buffer_load_dwordx4 v2, s[28:31], s60 offen offset:0 nt lds
    buffer_load_dwordx4 v3, s[28:31], s60 offen offset:1024 nt lds
    buffer_load_dwordx4 v2, s[28:31], s60 offen offset:2048 nt lds
    buffer_load_dwordx4 v3, s[28:31], s60 offen offset:3072 nt lds
    s_sub_u32 s60, s65, 4096
    s_mov_b32 m0, 110592
    s_waitcnt vmcnt(20)
    s_cmp_ge_u32 s100, 192
    s_cbranch_scc1 L_fb204
    s_waitcnt vmcnt(16)
    s_cmp_ge_u32 s100, 64
    s_cbranch_scc1 L_fb204
    s_waitcnt vmcnt(12)
L_fb204:
    buffer_load_dwordx4 v2, s[28:31], s60 offen offset:0 nt lds
    s_add_u32 s65, s65, 8192
    buffer_load_dwordx4 v3, s[28:31], s60 offen offset:1024 nt lds
    buffer_load_dwordx4 v2, s[28:31], s60 offen offset:2048 nt lds
    buffer_load_dwordx4 v3, s[28:31], s60 offen offset:3072 nt lds
    s_add_u32 s60, s65, 0
    ds_read_b32 v8, v7
    s_mov_b32 m0, 0
    ds_read_b32 v65, v64
    s_waitcnt vmcnt(20)
    s_cmp_ge_u32 s100, 192
    s_cbranch_scc1 L_fb205
    s_waitcnt vmcnt(16)
    s_cmp_ge_u32 s100, 64
    s_cbranch_scc1 L_fb205
    s_waitcnt vmcnt(12)
L_fb205:
    s_waitcnt lgkmcnt(0)
    v_cmp_gt_u32 vcc, 79, v8
    s_cbranch_vccnz L_pc206
L_pc206r:
    v_readfirstlane_b32 s100, v65
    buffer_load_dwordx4 v2, s[24:27], s60 offen offset:0 nt lds
    v_readfirstlane_b32 s9, v8
    buffer_load_dwordx4 v3, s[24:27], s60 offen offset:1024 nt lds
    s_add_u32 s7, s7, 2
    buffer_load_dwordx4 v2, s[24:27], s60 offen offset:2048 nt lds
    s_lshl4_add_u32 s9, s9, 32
    buffer_load_dwordx4 v3, s[24:27], s60 offen offset:3072 nt lds
    s_min_u32 s6, s6, s9
    s_add_u32 s6, s6, s8
    s_add_u32 s60, s65, 4096
    s_add_u32 s6, s6, 16
    s_lshr_b32 s9, s6, 4
    s_min_u32 s9, s9, s7
    s_mov_b32 m0, 4096
    s_waitcnt vmcnt(20)
    v_mov_b32 v9, s9
    ds_write_b32 v6, v9
    v_add_u32 v250, 81920, v252
    v_add_u32 v251, 81920, v253
    ds_read_b64_tr_b16 a[240:241], v250 offset:0
    ds_read_b64_tr_b16 a[242:243], v251 offset:0
    ds_read_b64_tr_b16 a[244:245], v250 offset:8
    ds_read_b64_tr_b16 a[246:247], v251 offset:8
    ds_read_b64_tr_b16 a[248:249], v250 offset:8192
    ds_read_b64_tr_b16 a[250:251], v251 offset:8192
    ds_read_b64_tr_b16 a[252:253], v250 offset:8200
    ds_read_b64_tr_b16 a[254:255], v251 offset:8200
    s_cmp_ge_u32 s100, 192
    s_cbranch_scc1 L_fb207
    s_waitcnt vmcnt(16)
    s_cmp_ge_u32 s100, 64
    s_cbranch_scc1 L_fb207
    s_waitcnt vmcnt(12)
L_fb207:
    buffer_load_dwordx4 v2, s[24:27], s60 offen offset:0 nt lds
    buffer_load_dwordx4 v3, s[24:27], s60 offen offset:1024 nt lds
    buffer_load_dwordx4 v2, s[24:27], s60 offen offset:2048 nt lds
    buffer_load_dwordx4 v3, s[24:27], s60 offen offset:3072 nt lds
    s_sub_u32 s60, s65, 8192
    s_mov_b32 m0, 8192
    s_waitcnt vmcnt(20)
    s_cmp_ge_u32 s100, 192
    s_cbranch_scc1 L_fb208
    s_waitcnt vmcnt(16)
    s_cmp_ge_u32 s100, 64
    s_cbranch_scc1 L_fb208
    s_waitcnt vmcnt(12)
L_fb208:
    buffer_load_dwordx4 v2, s[28:31], s60 offen offset:0 nt lds
    buffer_load_dwordx4 v3, s[28:31], s60 offen offset:1024 nt lds
    buffer_load_dwordx4 v2, s[28:31], s60 offen offset:2048 nt lds
    buffer_load_dwordx4 v3, s[28:31], s60 offen offset:3072 nt lds
    s_sub_u32 s60, s65, 4096
    s_mov_b32 m0, 12288
    s_waitcnt vmcnt(20)
    s_cmp_ge_u32 s100, 192
    s_cbranch_scc1 L_fb209
    s_waitcnt vmcnt(16)
    s_cmp_ge_u32 s100, 64
    s_cbranch_scc1 L_fb209
    s_waitcnt vmcnt(12)
L_fb209:
    buffer_load_dwordx4 v2, s[28:31], s60 offen offset:0 nt lds
    s_add_u32 s65, s65, 8192
    buffer_load_dwordx4 v3, s[28:31], s60 offen offset:1024 nt lds
    buffer_load_dwordx4 v2, s[28:31], s60 offen offset:2048 nt lds
    buffer_load_dwordx4 v3, s[28:31], s60 offen offset:3072 nt lds
    s_add_u32 s60, s65, 0
    ds_read_b32 v8, v7
    s_mov_b32 m0, 16384
    ds_read_b32 v65, v64
    s_waitcnt vmcnt(20)
    s_cmp_ge_u32 s100, 192
    s_cbranch_scc1 L_fb210
    s_waitcnt vmcnt(16)
    s_cmp_ge_u32 s100, 64
    s_cbranch_scc1 L_fb210
    s_waitcnt vmcnt(12)
L_fb210:
    s_waitcnt lgkmcnt(0)
    v_cmp_gt_u32 vcc, 80, v8
    s_cbranch_vccnz L_pc211
L_pc211r:
    ds_read_b32 v8, v7
    s_waitcnt lgkmcnt(0)
    v_cmp_gt_u32 vcc, 78, v8
    s_cbranch_vccnz L_pc212
L_pc212r:
    v_readfirstlane_b32 s100, v65
    buffer_load_dwordx4 v2, s[24:27], s60 offen offset:0 nt lds
    v_readfirstlane_b32 s9, v8
    buffer_load_dwordx4 v3, s[24:27], s60 offen offset:1024 nt lds
    s_add_u32 s7, s7, 1
    buffer_load_dwordx4 v2, s[24:27], s60 offen offset:2048 nt lds
    s_lshl4_add_u32 s9, s9, 32
    buffer_load_dwordx4 v3, s[24:27], s60 offen offset:3072 nt lds
    s_min_u32 s6, s6, s9
    s_add_u32 s6, s6, s8
    s_add_u32 s60, s65, 4096
    s_lshr_b32 s9, s6, 4
    s_min_u32 s9, s9, s7
    s_mov_b32 m0, 20480
    ds_write_b128 v62, v[80:83] offset:0
    ds_write_b128 v62, v[84:87] offset:1024
    ds_write_b128 v62, v[88:91] offset:2048
    s_waitcnt vmcnt(20)
    v_mov_b32 v9, s9
    ds_write_b32 v6, v9
    s_cmp_ge_u32 s100, 192
    s_cbranch_scc1 L_fb213
    s_waitcnt vmcnt(16)
    s_cmp_ge_u32 s100, 64
    s_cbranch_scc1 L_fb213
    s_waitcnt vmcnt(12)
L_fb213:
    buffer_load_dwordx4 v2, s[24:27], s60 offen offset:0 nt lds
    buffer_load_dwordx4 v3, s[24:27], s60 offen offset:1024 nt lds
    buffer_load_dwordx4 v2, s[24:27], s60 offen offset:2048 nt lds
    buffer_load_dwordx4 v3, s[24:27], s60 offen offset:3072 nt lds
    s_sub_u32 s60, s65, 8192
    s_mov_b32 m0, 24576
    ds_write_b128 v62, v[92:95] offset:3072
    ds_write_b128 v62, v[96:99] offset:4096
    ds_write_b128 v62, v[100:103] offset:5120
    s_waitcnt vmcnt(20)
    s_cmp_ge_u32 s100, 192
    s_cbranch_scc1 L_fb214
    s_waitcnt vmcnt(16)
    s_cmp_ge_u32 s100, 64
    s_cbranch_scc1 L_fb214
    s_waitcnt vmcnt(12)
L_fb214:
    buffer_load_dwordx4 v2, s[28:31], s60 offen offset:0 nt lds
    buffer_load_dwordx4 v3, s[28:31], s60 offen offset:1024 nt lds
    buffer_load_dwordx4 v2, s[28:31], s60 offen offset:2048 nt lds
    buffer_load_dwordx4 v3, s[28:31], s60 offen offset:3072 nt lds
    s_sub_u32 s60, s65, 4096
    s_mov_b32 m0, 28672
    ds_write_b128 v62, v[104:107] offset:6144
    ds_write_b128 v62, v[108:111] offset:7168
    ds_write_b128 v62, v[112:115] offset:8192
    s_waitcnt vmcnt(20)
    s_cmp_ge_u32 s100, 192
    s_cbranch_scc1 L_fb215
    s_waitcnt vmcnt(16)
    s_cmp_ge_u32 s100, 64
    s_cbranch_scc1 L_fb215
    s_waitcnt vmcnt(12)
L_fb215:
    buffer_load_dwordx4 v2, s[28:31], s60 offen offset:0 nt lds
    s_add_u32 s65, s65, 8192
    buffer_load_dwordx4 v3, s[28:31], s60 offen offset:1024 nt lds
    buffer_load_dwordx4 v2, s[28:31], s60 offen offset:2048 nt lds
    buffer_load_dwordx4 v3, s[28:31], s60 offen offset:3072 nt lds
    s_mul_i32 s62, s77, 73728
    buffer_store_dwordx4 v[80:83], v55, s[40:43], s62 offen offset:0 sc1
    buffer_store_dwordx4 v[84:87], v55, s[40:43], s62 offen offset:1024 sc1
    buffer_store_dwordx4 v[88:91], v55, s[40:43], s62 offen offset:2048 sc1
    s_add_u32 s60, s65, 0
    buffer_store_dwordx4 v[92:95], v55, s[40:43], s62 offen offset:3072 sc1
    ds_read_b32 v8, v7
    s_mov_b32 m0, 32768
    ds_write_b128 v62, v[116:119] offset:9216
    ds_write_b128 v62, v[120:123] offset:10240
    ds_write_b128 v62, v[124:127] offset:11264
    ds_read_b32 v65, v64
    s_waitcnt vmcnt(24)
    s_cmp_ge_u32 s100, 192
    s_cbranch_scc1 L_fb216
    s_waitcnt vmcnt(20)
    s_cmp_ge_u32 s100, 64
    s_cbranch_scc1 L_fb216
    s_waitcnt vmcnt(16)
L_fb216:
    s_waitcnt lgkmcnt(0)
    v_cmp_gt_u32 vcc, 81, v8
    s_cbranch_vccnz L_pc217
L_pc217r:
    v_readfirstlane_b32 s100, v65
    buffer_load_dwordx4 v2, s[24:27], s60 offen offset:0 nt lds
    v_readfirstlane_b32 s9, v8
    buffer_load_dwordx4 v3, s[24:27], s60 offen offset:1024 nt lds
    s_add_u32 s7, s7, 1
    buffer_load_dwordx4 v2, s[24:27], s60 offen offset:2048 nt lds
    s_lshl4_add_u32 s9, s9, 32
    buffer_load_dwordx4 v3, s[24:27], s60 offen offset:3072 nt lds
    s_add_u32 s62, s62, 4096
    buffer_store_dwordx4 v[96:99], v55, s[40:43], s62 offen offset:0 sc1
    s_min_u32 s6, s6, s9
    buffer_store_dwordx4 v[100:103], v55, s[40:43], s62 offen offset:1024 sc1
    s_add_u32 s6, s6, s8
    buffer_store_dwordx4 v[104:107], v55, s[40:43], s62 offen offset:2048 sc1
    s_add_u32 s60, s65, 4096
    s_lshr_b32 s9, s6, 4
    buffer_store_dwordx4 v[108:111], v55, s[40:43], s62 offen offset:3072 sc1
    s_min_u32 s9, s9, s7
    s_mov_b32 m0, 36864
    ds_write_b128 v62, v[128:131] offset:12288
    ds_write_b128 v62, v[132:135] offset:13312
    ds_write_b128 v62, v[136:139] offset:14336
    s_waitcnt vmcnt(28)
    v_mov_b32 v9, s9
    ds_write_b32 v6, v9
    s_cmp_ge_u32 s100, 192
    s_cbranch_scc1 L_fb218
    s_waitcnt vmcnt(24)
    s_cmp_ge_u32 s100, 64
    s_cbranch_scc1 L_fb218
    s_waitcnt vmcnt(20)
L_fb218:
    buffer_load_dwordx4 v2, s[24:27], s60 offen offset:0 nt lds
    buffer_load_dwordx4 v3, s[24:27], s60 offen offset:1024 nt lds
    buffer_load_dwordx4 v2, s[24:27], s60 offen offset:2048 nt lds
    buffer_load_dwordx4 v3, s[24:27], s60 offen offset:3072 nt lds
    s_add_u32 s62, s62, 4096
    buffer_store_dwordx4 v[112:115], v55, s[40:43], s62 offen offset:0 sc1
    buffer_store_dwordx4 v[116:119], v55, s[40:43], s62 offen offset:1024 sc1
    buffer_store_dwordx4 v[120:123], v55, s[40:43], s62 offen offset:2048 sc1
    s_sub_u32 s60, s65, 8192
    buffer_store_dwordx4 v[124:127], v55, s[40:43], s62 offen offset:3072 sc1
    s_mov_b32 m0, 40960
    ds_write_b128 v62, v[140:143] offset:15360
    ds_write_b128 v62, v[144:147] offset:16384
    ds_write_b128 v62, v[148:151] offset:17408
    s_waitcnt vmcnt(32)
    s_cmp_ge_u32 s100, 192
    s_cbranch_scc1 L_fb219
    s_waitcnt vmcnt(28)
    s_cmp_ge_u32 s100, 64
    s_cbranch_scc1 L_fb219
    s_waitcnt vmcnt(24)
L_fb219:
    buffer_load_dwordx4 v2, s[28:31], s60 offen offset:0 nt lds
    buffer_load_dwordx4 v3, s[28:31], s60 offen offset:1024 nt lds
    buffer_load_dwordx4 v2, s[28:31], s60 offen offset:2048 nt lds
    buffer_load_dwordx4 v3, s[28:31], s60 offen offset:3072 nt lds
    s_add_u32 s62, s62, 4096
    buffer_store_dwordx4 v[128:131], v55, s[40:43], s62 offen offset:0 sc1
    buffer_store_dwordx4 v[132:135], v55, s[40:43], s62 offen offset:1024 sc1
    buffer_store_dwordx4 v[136:139], v55, s[40:43], s62 offen offset:2048 sc1
    s_sub_u32 s60, s65, 4096
    buffer_store_dwordx4 v[140:143], v55, s[40:43], s62 offen offset:3072 sc1
    s_mov_b32 m0, 45056
    ds_write_b128 v62, v[152:155] offset:18432
    ds_write_b128 v62, v[156:159] offset:19456
    ds_write_b128 v62, v[160:163] offset:20480
    s_waitcnt vmcnt(36)
    s_cmp_ge_u32 s100, 192
    s_cbranch_scc1 L_fb220
    s_waitcnt vmcnt(32)
    s_cmp_ge_u32 s100, 64
    s_cbranch_scc1 L_fb220
    s_waitcnt vmcnt(28)
L_fb220:
    buffer_load_dwordx4 v2, s[28:31], s60 offen offset:0 nt lds
    s_add_u32 s65, s65, 8192
    buffer_load_dwordx4 v3, s[28:31], s60 offen offset:1024 nt lds
    buffer_load_dwordx4 v2, s[28:31], s60 offen offset:2048 nt lds
    buffer_load_dwordx4 v3, s[28:31], s60 offen offset:3072 nt lds
    s_add_u32 s62, s62, 4096
    buffer_store_dwordx4 v[144:147], v55, s[40:43], s62 offen offset:0 sc1
    buffer_store_dwordx4 v[148:151], v55, s[40:43], s62 offen offset:1024 sc1
    buffer_store_dwordx4 v[152:155], v55, s[40:43], s62 offen offset:2048 sc1
    s_add_u32 s60, s65, 0
    buffer_store_dwordx4 v[156:159], v55, s[40:43], s62 offen offset:3072 sc1
    ds_read_b32 v8, v7
    s_mov_b32 m0, 49152
    ds_write_b128 v62, v[164:167] offset:21504
    ds_write_b128 v62, v[168:171] offset:22528
    ds_write_b128 v62, v[172:175] offset:23552
    ds_read_b32 v65, v64
    s_waitcnt vmcnt(40)
    s_cmp_ge_u32 s100, 192
    s_cbranch_scc1 L_fb221
    s_waitcnt vmcnt(36)
    s_cmp_ge_u32 s100, 64
    s_cbranch_scc1 L_fb221
    s_waitcnt vmcnt(28)
L_fb221:
    s_waitcnt lgkmcnt(0)
    v_cmp_gt_u32 vcc, 82, v8
    s_cbranch_vccnz L_pc222
L_pc222r:
    v_readfirstlane_b32 s100, v65
    buffer_load_dwordx4 v2, s[24:27], s60 offen offset:0 nt lds
    v_readfirstlane_b32 s9, v8
    buffer_load_dwordx4 v3, s[24:27], s60 offen offset:1024 nt lds
    s_add_u32 s7, s7, 1
    buffer_load_dwordx4 v2, s[24:27], s60 offen offset:2048 nt lds
    s_lshl4_add_u32 s9, s9, 32
    buffer_load_dwordx4 v3, s[24:27], s60 offen offset:3072 nt lds
    s_add_u32 s62, s62, 4096
    buffer_store_dwordx4 v[160:163], v55, s[40:43], s62 offen offset:0 sc1
    s_min_u32 s6, s6, s9
    buffer_store_dwordx4 v[164:167], v55, s[40:43], s62 offen offset:1024 sc1
    s_add_u32 s6, s6, s8
    buffer_store_dwordx4 v[168:171], v55, s[40:43], s62 offen offset:2048 sc1
    s_add_u32 s60, s65, 4096
    s_lshr_b32 s9, s6, 4
    buffer_store_dwordx4 v[172:175], v55, s[40:43], s62 offen offset:3072 sc1
    s_min_u32 s9, s9, s7
    s_mov_b32 m0, 53248
    ds_write_b128 v62, v[176:179] offset:24576
    ds_write_b128 v62, v[180:183] offset:25600
    ds_write_b128 v62, v[184:187] offset:26624
    s_waitcnt vmcnt(44)
    v_mov_b32 v9, s9
    ds_write_b32 v6, v9
    s_cmp_ge_u32 s100, 192
    s_cbranch_scc1 L_fb223
    s_waitcnt vmcnt(36)
    s_cmp_ge_u32 s100, 64
    s_cbranch_scc1 L_fb223
    s_waitcnt vmcnt(28)
L_fb223:
    buffer_load_dwordx4 v2, s[24:27], s60 offen offset:0 nt lds
    buffer_load_dwordx4 v3, s[24:27], s60 offen offset:1024 nt lds
    buffer_load_dwordx4 v2, s[24:27], s60 offen offset:2048 nt lds
    buffer_load_dwordx4 v3, s[24:27], s60 offen offset:3072 nt lds
    s_add_u32 s62, s62, 4096
    buffer_store_dwordx4 v[176:179], v55, s[40:43], s62 offen offset:0 sc1
    buffer_store_dwordx4 v[180:183], v55, s[40:43], s62 offen offset:1024 sc1
    buffer_store_dwordx4 v[184:187], v55, s[40:43], s62 offen offset:2048 sc1
    s_sub_u32 s60, s65, 8192
    buffer_store_dwordx4 v[188:191], v55, s[40:43], s62 offen offset:3072 sc1
    s_mov_b32 m0, 57344
    ds_write_b128 v62, v[188:191] offset:27648
    ds_write_b128 v62, v[192:195] offset:28672
    ds_write_b128 v62, v[196:199] offset:29696
    s_waitcnt vmcnt(44)
    s_cmp_ge_u32 s100, 192
    s_cbranch_scc1 L_fb224
    s_waitcnt vmcnt(36)
    s_cmp_ge_u32 s100, 64
    s_cbranch_scc1 L_fb224
    s_waitcnt vmcnt(28)
L_fb224:
    buffer_load_dwordx4 v2, s[28:31], s60 offen offset:0 nt lds
    buffer_load_dwordx4 v3, s[28:31], s60 offen offset:1024 nt lds
    buffer_load_dwordx4 v2, s[28:31], s60 offen offset:2048 nt lds
    buffer_load_dwordx4 v3, s[28:31], s60 offen offset:3072 nt lds
    s_add_u32 s62, s62, 4096
    buffer_store_dwordx4 v[192:195], v55, s[40:43], s62 offen offset:0 sc1
    buffer_store_dwordx4 v[196:199], v55, s[40:43], s62 offen offset:1024 sc1
    buffer_store_dwordx4 v[200:203], v55, s[40:43], s62 offen offset:2048 sc1
    s_sub_u32 s60, s65, 4096
    buffer_store_dwordx4 v[204:207], v55, s[40:43], s62 offen offset:3072 sc1
    s_mov_b32 m0, 61440
    ds_write_b128 v62, v[200:203] offset:30720
    ds_write_b128 v62, v[204:207] offset:31744
    ds_write_b128 v62, v[208:211] offset:32768
    s_waitcnt vmcnt(44)
    s_cmp_ge_u32 s100, 192
    s_cbranch_scc1 L_fb225
    s_waitcnt vmcnt(36)
    s_cmp_ge_u32 s100, 64
    s_cbranch_scc1 L_fb225
    s_waitcnt vmcnt(28)
L_fb225:
    buffer_load_dwordx4 v2, s[28:31], s60 offen offset:0 nt lds
    s_add_u32 s65, s65, 8192
    buffer_load_dwordx4 v3, s[28:31], s60 offen offset:1024 nt lds
    buffer_load_dwordx4 v2, s[28:31], s60 offen offset:2048 nt lds
    buffer_load_dwordx4 v3, s[28:31], s60 offen offset:3072 nt lds
    s_add_u32 s62, s62, 4096
    buffer_store_dwordx4 v[208:211], v55, s[40:43], s62 offen offset:0 sc1
    buffer_store_dwordx4 v[212:215], v55, s[40:43], s62 offen offset:1024 sc1
    buffer_store_dwordx4 v[216:219], v55, s[40:43], s62 offen offset:2048 sc1
    s_add_u32 s60, s65, 0
    buffer_store_dwordx4 v[220:223], v55, s[40:43], s62 offen offset:3072 sc1
    s_mov_b32 m0, 49152
    ds_write_b128 v62, v[212:215] offset:33792
    ds_write_b128 v62, v[216:219] offset:34816
    ds_write_b128 v62, v[220:223] offset:35840
    s_waitcnt vmcnt(44)
    s_cmp_ge_u32 s100, 192
    s_cbranch_scc1 L_fb226
    s_waitcnt vmcnt(36)
    s_cmp_ge_u32 s100, 64
    s_cbranch_scc1 L_fb226
    s_waitcnt vmcnt(28)
L_fb226:
    s_bfe_u32 s63, s2, 0x30003
    s_lshr_b32 s64, s63, 1
    s_and_b32 s63, s63, 1
    s_lshl_b32 s64, s64, 18
    s_lshl_b32 s63, s63, 16
    s_add_u32 s63, s63, s64
    s_add_u32 s63, s63, 131072
    v_lshrrev_b32 v30, 1, v1
    v_and_b32 v31, 1, v1
    v_lshlrev_b32 v30, 10, v30
    v_lshl_add_u32 v30, v31, 7, v30
    s_add_u32 s64, s63, 32768
    buffer_load_dword v52, v30, s[32:35], s63 offen
    buffer_load_dword v52, v30, s[32:35], s64 offen
    s_waitcnt vmcnt(38)
    v_mov_b32 v9, 88
    ds_write_b32 v6, v9
    ds_read_b32 v8, v7
    s_waitcnt lgkmcnt(0)
    v_cmp_gt_u32 vcc, 83, v8
    s_cbranch_vccnz L_pc227
L_pc227r:
    s_mov_b32 m0, 65536
    s_add_u32 s63, s36, 131072
    buffer_load_dwordx4 v48, s[32:35], s63 offen offset:0 lds
    buffer_load_dwordx4 v49, s[32:35], s63 offen offset:1024 lds
    buffer_load_dwordx4 v50, s[32:35], s63 offen offset:2048 lds
    buffer_load_dwordx4 v51, s[32:35], s63 offen offset:3072 lds
    s_mov_b32 m0, 69632
    s_add_u32 s64, s36, 139264
    buffer_load_dwordx4 v48, s[32:35], s64 offen offset:0 lds
    buffer_load_dwordx4 v49, s[32:35], s64 offen offset:1024 lds
    buffer_load_dwordx4 v50, s[32:35], s64 offen offset:2048 lds
    buffer_load_dwordx4 v51, s[32:35], s64 offen offset:3072 lds
    s_mov_b32 m0, 73728
    s_add_u32 s63, s36, 163840
    buffer_load_dwordx4 v48, s[32:35], s63 offen offset:0 lds
    buffer_load_dwordx4 v49, s[32:35], s63 offen offset:1024 lds
    buffer_load_dwordx4 v50, s[32:35], s63 offen offset:2048 lds
    buffer_load_dwordx4 v51, s[32:35], s63 offen offset:3072 lds
    s_mov_b32 m0, 77824
    s_add_u32 s64, s36, 172032
    buffer_load_dwordx4 v48, s[32:35], s64 offen offset:0 lds
    buffer_load_dwordx4 v49, s[32:35], s64 offen offset:1024 lds
    buffer_load_dwordx4 v50, s[32:35], s64 offen offset:2048 lds
    buffer_load_dwordx4 v51, s[32:35], s64 offen offset:3072 lds
    ds_read_b32 v8, v7
    s_waitcnt lgkmcnt(0)
    v_cmp_gt_u32 vcc, 84, v8
    s_cbranch_vccnz L_pc228
L_pc228r:
    s_mov_b32 m0, 81920
    s_add_u32 s63, s36, 196608
    buffer_load_dwordx4 v48, s[32:35], s63 offen offset:0 lds
    buffer_load_dwordx4 v49, s[32:35], s63 offen offset:1024 lds
    buffer_load_dwordx4 v50, s[32:35], s63 offen offset:2048 lds
    buffer_load_dwordx4 v51, s[32:35], s63 offen offset:3072 lds
    s_mov_b32 m0, 86016
    s_add_u32 s64, s36, 204800
    buffer_load_dwordx4 v48, s[32:35], s64 offen offset:0 lds
    buffer_load_dwordx4 v49, s[32:35], s64 offen offset:1024 lds
    buffer_load_dwordx4 v50, s[32:35], s64 offen offset:2048 lds
    buffer_load_dwordx4 v51, s[32:35], s64 offen offset:3072 lds
    s_mov_b32 m0, 90112
    s_add_u32 s63, s36, 229376
    buffer_load_dwordx4 v48, s[32:35], s63 offen offset:0 lds
    buffer_load_dwordx4 v49, s[32:35], s63 offen offset:1024 lds
    buffer_load_dwordx4 v50, s[32:35], s63 offen offset:2048 lds
    buffer_load_dwordx4 v51, s[32:35], s63 offen offset:3072 lds
    s_mov_b32 m0, 94208
    s_add_u32 s64, s36, 237568
    buffer_load_dwordx4 v48, s[32:35], s64 offen offset:0 lds
    buffer_load_dwordx4 v49, s[32:35], s64 offen offset:1024 lds
    buffer_load_dwordx4 v50, s[32:35], s64 offen offset:2048 lds
    buffer_load_dwordx4 v51, s[32:35], s64 offen offset:3072 lds
    ds_read_b32 v8, v7
    s_waitcnt lgkmcnt(0)
    v_cmp_gt_u32 vcc, 85, v8
    s_cbranch_vccnz L_pc229
L_pc229r:
    s_mov_b32 m0, 98304
    s_add_u32 s63, s37, 131072
    buffer_load_dwordx4 v48, s[32:35], s63 offen offset:0 lds
    buffer_load_dwordx4 v49, s[32:35], s63 offen offset:1024 lds
    buffer_load_dwordx4 v50, s[32:35], s63 offen offset:2048 lds
    buffer_load_dwordx4 v51, s[32:35], s63 offen offset:3072 lds
    s_mov_b32 m0, 102400
    s_add_u32 s64, s37, 139264
    buffer_load_dwordx4 v48, s[32:35], s64 offen offset:0 lds
    buffer_load_dwordx4 v49, s[32:35], s64 offen offset:1024 lds
    buffer_load_dwordx4 v50, s[32:35], s64 offen offset:2048 lds
    buffer_load_dwordx4 v51, s[32:35], s64 offen offset:3072 lds
    s_mov_b32 m0, 106496
    s_add_u32 s63, s37, 163840
    buffer_load_dwordx4 v48, s[32:35], s63 offen offset:0 lds
    buffer_load_dwordx4 v49, s[32:35], s63 offen offset:1024 lds
    buffer_load_dwordx4 v50, s[32:35], s63 offen offset:2048 lds
    buffer_load_dwordx4 v51, s[32:35], s63 offen offset:3072 lds
    s_mov_b32 m0, 110592
    s_add_u32 s64, s37, 172032
    buffer_load_dwordx4 v48, s[32:35], s64 offen offset:0 lds
    buffer_load_dwordx4 v49, s[32:35], s64 offen offset:1024 lds
    buffer_load_dwordx4 v50, s[32:35], s64 offen offset:2048 lds
    buffer_load_dwordx4 v51, s[32:35], s64 offen offset:3072 lds
    s_waitcnt vmcnt(54)
    v_mov_b32 v9, 89
    ds_write_b32 v6, v9
    s_waitcnt vmcnt(16)
L_wdone:
    v_mov_b32 v9, 90
    ds_write_b32 v6, v9
    s_and_b32 s60, s79, 0xfc
    s_lshl_b32 s60, s60, 13
    s_lshl_b32 s61, s77, 2
    s_add_u32 s61, s61, s3
    s_lshl_b32 s61, s61, 7
    s_add_u32 s60, s60, s61
    s_add_u32 s60, s60, 0
    v_lshlrev_b32 v4, 13, v1
    v_mov_b32 v60, s4
    v_mov_b32 v61, s5
    s_waitcnt vmcnt(50)
    s_mov_b64 exec, 15
    buffer_store_dwordx2 v[60:61], v4, s[52:55], s60 offen sc1
    s_mov_b64 exec, -1
    v_mov_b32 v31, 163616
    ds_write_b64 v31, v[56:57]
    s_lshl_b32 s83, s79, 13
    ds_read_b32 v8, v7
    s_waitcnt lgkmcnt(0)
    v_cmp_gt_u32 vcc, 86, v8
    s_cbranch_vccnz L_pc230
L_pc230r:
    s_mov_b32 m0, 0
    s_add_u32 s63, s37, 196608
    buffer_load_dwordx4 v48, s[32:35], s63 offen offset:0 lds
    buffer_load_dwordx4 v49, s[32:35], s63 offen offset:1024 lds
    buffer_load_dwordx4 v50, s[32:35], s63 offen offset:2048 lds
    buffer_load_dwordx4 v51, s[32:35], s63 offen offset:3072 lds
    s_mov_b32 m0, 4096
    s_add_u32 s64, s37, 204800
    buffer_load_dwordx4 v48, s[32:35], s64 offen offset:0 lds
    buffer_load_dwordx4 v49, s[32:35], s64 offen offset:1024 lds
    buffer_load_dwordx4 v50, s[32:35], s64 offen offset:2048 lds
    buffer_load_dwordx4 v51, s[32:35], s64 offen offset:3072 lds
    s_mov_b32 m0, 8192
    s_add_u32 s63, s37, 229376
    buffer_load_dwordx4 v48, s[32:35], s63 offen offset:0 lds
    buffer_load_dwordx4 v49, s[32:35], s63 offen offset:1024 lds
    buffer_load_dwordx4 v50, s[32:35], s63 offen offset:2048 lds
    buffer_load_dwordx4 v51, s[32:35], s63 offen offset:3072 lds
    s_mov_b32 m0, 12288
    s_add_u32 s64, s37, 237568
    buffer_load_dwordx4 v48, s[32:35], s64 offen offset:0 lds
    buffer_load_dwordx4 v49, s[32:35], s64 offen offset:1024 lds
    buffer_load_dwordx4 v50, s[32:35], s64 offen offset:2048 lds
    buffer_load_dwordx4 v51, s[32:35], s64 offen offset:3072 lds
    buffer_load_dwordx2 v[58:59], v53, s[52:55], s83 offen sc1
    ds_read_b64_tr_b16 a[0:1], v254 offset:0
    ds_read_b64_tr_b16 a[2:3], v255 offset:0
    ds_read_b64_tr_b16 a[4:5], v254 offset:8
    ds_read_b64_tr_b16 a[6:7], v255 offset:8
    ds_read_b64_tr_b16 a[8:9], v254 offset:8192
    ds_read_b64_tr_b16 a[10:11], v255 offset:8192
    ds_read_b64_tr_b16 a[12:13], v254 offset:8200
    ds_read_b64_tr_b16 a[14:15], v255 offset:8200
    ds_read_b64_tr_b16 a[16:17], v254 offset:16384
    ds_read_b64_tr_b16 a[18:19], v255 offset:16384
    ds_read_b64_tr_b16 a[20:21], v254 offset:16392
    ds_read_b64_tr_b16 a[22:23], v255 offset:16392
    ds_read_b64_tr_b16 a[24:25], v254 offset:24576
    ds_read_b64_tr_b16 a[26:27], v255 offset:24576
    ds_read_b64_tr_b16 a[28:29], v254 offset:24584
    ds_read_b64_tr_b16 a[30:31], v255 offset:24584
    ds_read_b32 v8, v7
    s_waitcnt lgkmcnt(0)
    v_cmp_gt_u32 vcc, 90, v8
    s_cbranch_vccnz L_pc231
L_pc231r:
    s_waitcnt vmcnt(1)
    v_mov_b32 v9, 91
    ds_write_b32 v6, v9
    ds_read_b64_tr_b16 a[32:33], v254 offset:32768
    ds_read_b64_tr_b16 a[34:35], v255 offset:32768
    ds_read_b64_tr_b16 a[36:37], v254 offset:32776
    ds_read_b64_tr_b16 a[38:39], v255 offset:32776
    ds_read_b64_tr_b16 a[40:41], v254 offset:40960
    ds_read_b64_tr_b16 a[42:43], v255 offset:40960
    ds_read_b64_tr_b16 a[44:45], v254 offset:40968
    ds_read_b64_tr_b16 a[46:47], v255 offset:40968
    ds_read_b64_tr_b16 a[48:49], v252 offset:0
    ds_read_b64_tr_b16 a[50:51], v253 offset:0
    ds_read_b64_tr_b16 a[52:53], v252 offset:8
    ds_read_b64_tr_b16 a[54:55], v253 offset:8
    ds_read_b64_tr_b16 a[56:57], v252 offset:8192
    ds_read_b64_tr_b16 a[58:59], v253 offset:8192
    ds_read_b64_tr_b16 a[60:61], v252 offset:8200
    ds_read_b64_tr_b16 a[62:63], v253 offset:8200
    ds_read_b128 v[16:19], v238 offset:0
    ds_read_b128 v[20:23], v238 offset:1024
    ds_read_b128 v[24:27], v238 offset:2048
    ds_read_b128 v[28:31], v238 offset:3072
    ds_read_b128 v[32:35], v238 offset:4096
    ds_read_b128 v[36:39], v238 offset:5120
    ds_read_b128 v[40:43], v238 offset:6144
    ds_read_b128 v[44:47], v238 offset:7168
    s_waitcnt vmcnt(0)
L_poll0:
    v_cmp_ne_u64 vcc, s[4:5], v[58:59]
    s_cbranch_vccnz L_poll0b
L_poll0r:
    s_waitcnt lgkmcnt(0)
    s_barrier
    v_mov_b32 v4, 163600
    ds_read_b32 v4, v4
    s_waitcnt lgkmcnt(0)
    v_cmp_ne_u32 vcc, 0, v4
    s_cbranch_vccnz L_hredo
    s_branch L_tail
L_hredo:
    s_waitcnt vmcnt(0)
    s_barrier
    s_mul_i32 s67, s68, 40
    s_add_u32 s67, s67, 10
    s_add_u32 s60, s67, 5
    v_mov_b32 v9, s60
    s_mov_b32 s7, s60
    s_add_u32 s60, s67, 6
    v_mov_b32 v8, s60
    s_lshl_b32 s6, s60, 4
    ds_write_b32 v6, v9
    s_mov_b32 s69, 0
    s_lshl_b32 s65, s68, 18
    s_mov_b32 s66, 0
L_hmloop:
    s_add_u32 m0, s66, 0
    s_add_u32 s60, s65, 0
    buffer_load_dwordx4 v2, s[24:27], s60 offen offset:0 nt lds
    buffer_load_dwordx4 v3, s[24:27], s60 offen offset:1024 nt lds
    buffer_load_dwordx4 v2, s[24:27], s60 offen offset:2048 nt lds
    buffer_load_dwordx4 v3, s[24:27], s60 offen offset:3072 nt lds
    s_add_u32 m0, s66, 4096
    s_add_u32 s60, s65, 4096
    buffer_load_dwordx4 v2, s[24:27], s60 offen offset:0 nt lds
    buffer_load_dwordx4 v3, s[24:27], s60 offen offset:1024 nt lds
    buffer_load_dwordx4 v2, s[24:27], s60 offen offset:2048 nt lds
    buffer_load_dwordx4 v3, s[24:27], s60 offen offset:3072 nt lds
    s_add_u32 s65, s65, 8192
    s_waitcnt vmcnt(0) lgkmcnt(0)
    s_barrier
    s_barrier
    s_add_u32 s69, s69, 1
    s_cmp_lt_u32 s69, 32
    s_cbranch_scc1 L_hmloop
    s_lshl_b32 s65, s68, 18
    s_mul_i32 s66, s68, 98304
    s_cmp_eq_u32 s68, 0
    s_cselect_b32 s69, 51, 83
    s_add_u32 m0, s66, 0
    s_add_u32 s60, s65, 0
L_hploop:
    buffer_load_dwordx4 v2, s[24:27], s60 offen offset:0 nt lds
    buffer_load_dwordx4 v3, s[24:27], s60 offen offset:1024 nt lds
    buffer_load_dwordx4 v2, s[24:27], s60 offen offset:2048 nt lds
    buffer_load_dwordx4 v3, s[24:27], s60 offen offset:3072 nt lds
    s_add_u32 s60, s65, 4096
    s_add_u32 m0, s66, 4096
    s_waitcnt vmcnt(16)
    buffer_load_dwordx4 v2, s[24:27], s60 offen offset:0 nt lds
    buffer_load_dwordx4 v3, s[24:27], s60 offen offset:1024 nt lds
    buffer_load_dwordx4 v2, s[24:27], s60 offen offset:2048 nt lds
    buffer_load_dwordx4 v3, s[24:27], s60 offen offset:3072 nt lds
    s_sub_u32 s60, s65, 8192
    s_add_u32 m0, s66, 8192
    s_waitcnt vmcnt(16)
    buffer_load_dwordx4 v2, s[28:31], s60 offen offset:0 nt lds
    buffer_load_dwordx4 v3, s[28:31], s60 offen offset:1024 nt lds
    buffer_load_dwordx4 v2, s[28:31], s60 offen offset:2048 nt lds
    buffer_load_dwordx4 v3, s[28:31], s60 offen offset:3072 nt lds
    s_sub_u32 s60, s65, 4096
    s_add_u32 m0, s66, 12288
    s_waitcnt vmcnt(16)
    buffer_load_dwordx4 v2, s[28:31], s60 offen offset:0 nt lds
    s_add_u32 s65, s65, 8192
    v_readfirstlane_b32 s9, v8
    buffer_load_dwordx4 v3, s[28:31], s60 offen offset:1024 nt lds
    s_add_u32 s67, s67, 1
    s_add_u32 s7, s7, 1
    buffer_load_dwordx4 v2, s[28:31], s60 offen offset:2048 nt lds
    s_add_u32 s66, s66, 16384
    s_lshl4_add_u32 s9, s9, 32
    buffer_load_dwordx4 v3, s[28:31], s60 offen offset:3072 nt lds
    s_min_u32 s6, s6, s9
    s_cmp_eq_u32 s66, 114688
    s_cselect_b32 s66, 0, s66
    s_add_u32 s6, s6, s8
    s_add_u32 s60, s65, 0
    s_lshr_b32 s9, s6, 4
    s_min_u32 s9, s9, s7
    ds_read_b32 v8, v7
    s_add_u32 m0, s66, 0
    s_waitcnt vmcnt(16)
    v_mov_b32 v9, s9
    ds_write_b32 v6, v9
    s_waitcnt lgkmcnt(0)
    v_cmp_gt_u32 vcc, s67, v8
    s_cbranch_vccnz L_pc232
L_pc232r:
    s_cmp_lt_u32 s67, s69
    s_cbranch_scc1 L_hploop
    s_cmp_eq_u32 s68, 0
    s_cbranch_scc1 L_s0
    s_waitcnt vmcnt(0)
    v_mov_b32 v9, 89
    ds_write_b32 v6, v9
    ds_read_b32 v8, v7
    s_waitcnt lgkmcnt(0)
    v_cmp_gt_u32 vcc, 89, v8
    s_cbranch_vccnz L_pc233
L_pc233r:
    s_mov_b32 m0, 65536
    s_add_u32 s63, s36, 131072
    buffer_load_dwordx4 v48, s[32:35], s63 offen offset:0 lds
    buffer_load_dwordx4 v49, s[32:35], s63 offen offset:1024 lds
    buffer_load_dwordx4 v50, s[32:35], s63 offen offset:2048 lds
    buffer_load_dwordx4 v51, s[32:35], s63 offen offset:3072 lds
    s_mov_b32 m0, 69632
    s_add_u32 s64, s36, 139264
    buffer_load_dwordx4 v48, s[32:35], s64 offen offset:0 lds
    buffer_load_dwordx4 v49, s[32:35], s64 offen offset:1024 lds
    buffer_load_dwordx4 v50, s[32:35], s64 offen offset:2048 lds
    buffer_load_dwordx4 v51, s[32:35], s64 offen offset:3072 lds
    s_mov_b32 m0, 73728
    s_add_u32 s63, s36, 163840
    buffer_load_dwordx4 v48, s[32:35], s63 offen offset:0 lds
    buffer_load_dwordx4 v49, s[32:35], s63 offen offset:1024 lds
    buffer_load_dwordx4 v50, s[32:35], s63 offen offset:2048 lds
    buffer_load_dwordx4 v51, s[32:35], s63 offen offset:3072 lds
    s_mov_b32 m0, 77824
    s_add_u32 s64, s36, 172032
    buffer_load_dwordx4 v48, s[32:35], s64 offen offset:0 lds
    buffer_load_dwordx4 v49, s[32:35], s64 offen offset:1024 lds
    buffer_load_dwordx4 v50, s[32:35], s64 offen offset:2048 lds
    buffer_load_dwordx4 v51, s[32:35], s64 offen offset:3072 lds
    s_waitcnt vmcnt(16)
    s_mov_b32 m0, 81920
    s_add_u32 s63, s36, 196608
    buffer_load_dwordx4 v48, s[32:35], s63 offen offset:0 lds
    buffer_load_dwordx4 v49, s[32:35], s63 offen offset:1024 lds
    buffer_load_dwordx4 v50, s[32:35], s63 offen offset:2048 lds
    buffer_load_dwordx4 v51, s[32:35], s63 offen offset:3072 lds
    s_mov_b32 m0, 86016
    s_add_u32 s64, s36, 204800
    buffer_load_dwordx4 v48, s[32:35], s64 offen offset:0 lds
    buffer_load_dwordx4 v49, s[32:35], s64 offen offset:1024 lds
    buffer_load_dwordx4 v50, s[32:35], s64 offen offset:2048 lds
    buffer_load_dwordx4 v51, s[32:35], s64 offen offset:3072 lds
    s_mov_b32 m0, 90112
    s_add_u32 s63, s36, 229376
    buffer_load_dwordx4 v48, s[32:35], s63 offen offset:0 lds
    buffer_load_dwordx4 v49, s[32:35], s63 offen offset:1024 lds
    buffer_load_dwordx4 v50, s[32:35], s63 offen offset:2048 lds
    buffer_load_dwordx4 v51, s[32:35], s63 offen offset:3072 lds
    s_mov_b32 m0, 94208
    s_add_u32 s64, s36, 237568
    buffer_load_dwordx4 v48, s[32:35], s64 offen offset:0 lds
    buffer_load_dwordx4 v49, s[32:35], s64 offen offset:1024 lds
    buffer_load_dwordx4 v50, s[32:35], s64 offen offset:2048 lds
    buffer_load_dwordx4 v51, s[32:35], s64 offen offset:3072 lds
    s_waitcnt vmcnt(16)
    s_mov_b32 m0, 98304
    s_add_u32 s63, s37, 131072
    buffer_load_dwordx4 v48, s[32:35], s63 offen offset:0 lds
    buffer_load_dwordx4 v49, s[32:35], s63 offen offset:1024 lds
    buffer_load_dwordx4 v50, s[32:35], s63 offen offset:2048 lds
    buffer_load_dwordx4 v51, s[32:35], s63 offen offset:3072 lds
    s_mov_b32 m0, 102400
    s_add_u32 s64, s37, 139264
    buffer_load_dwordx4 v48, s[32:35], s64 offen offset:0 lds
    buffer_load_dwordx4 v49, s[32:35], s64 offen offset:1024 lds
    buffer_load_dwordx4 v50, s[32:35], s64 offen offset:2048 lds
    buffer_load_dwordx4 v51, s[32:35], s64 offen offset:3072 lds
    s_mov_b32 m0, 106496
    s_add_u32 s63, s37, 163840
    buffer_load_dwordx4 v48, s[32:35], s63 offen offset:0 lds
    buffer_load_dwordx4 v49, s[32:35], s63 offen offset:1024 lds
    buffer_load_dwordx4 v50, s[32:35], s63 offen offset:2048 lds
    buffer_load_dwordx4 v51, s[32:35], s63 offen offset:3072 lds
    s_mov_b32 m0, 110592
    s_add_u32 s64, s37, 172032
    buffer_load_dwordx4 v48, s[32:35], s64 offen offset:0 lds
    buffer_load_dwordx4 v49, s[32:35], s64 offen offset:1024 lds
    buffer_load_dwordx4 v50, s[32:35], s64 offen offset:2048 lds
    buffer_load_dwordx4 v51, s[32:35], s64 offen offset:3072 lds
    s_waitcnt vmcnt(16)
    s_waitcnt vmcnt(0)
    s_branch L_wdone
L_attn:
    s_lshl_b32 s67, s67, 7
    v_lshlrev_b32 v5, 4, v1
    s_add_u32 s60, s65, 58112
    v_lshrrev_b32 v59, 4, v1
    v_and_b32 v60, 7, v1
    v_xor_b32 v59, v59, v60
    v_lshlrev_b32 v59, 4, v59
    v_and_b32 v60, 15, v1
    v_lshl_add_u32 v59, v60, 7, v59
    v_xor_b32 v60, 64, v59
    v_add_u32 v24, s60, v59
    v_add_u32 v25, s60, v60
    v_lshrrev_b32 v59, 4, v1
    v_lshlrev_b32 v59, 11, v59
    v_bfe_u32 v60, v1, 2, 2
    v_lshl_add_u32 v59, v60, 6, v59
    v_add_u32 v59, 76544, v59
    v_and_b32 v60, 3, v1
    v_lshl_add_u32 v26, v60, 4, v59
    v_xor_b32 v60, 2, v60
    v_lshl_add_u32 v27, v60, 4, v59
    v_add_u32 v27, 1024, v27
    v_add_u32 v28, 69632, v24
    v_add_u32 v29, 69632, v25
    v_add_u32 v30, 69632, v26
    v_add_u32 v31, 69632, v27
    s_lshl_b32 s60, s3, 8
    s_add_u32 s60, s60, 162816
    v_lshl_add_u32 v7, v1, 2, s60
    v_mov_b32 v6, 162560
    v_mov_b32 v8, 0
    s_add_u32 s52, s18, 41943040
    s_addc_u32 s53, s19, 0
    s_and_b32 s53, s53, 0xffff
    s_mov_b32 s54, 2105344
    s_mov_b32 s55, 0x00020000
    s_add_u32 s44, s18, 25165824
    s_addc_u32 s45, s19, 0
    s_and_b32 s45, s45, 0xffff
    s_mov_b32 s46, 12582912
    s_mov_b32 s47, 0x00020000
    s_lshl_b32 s60, s78, 2
    s_add_u32 s60, s60, s76
    s_mul_i32 s60, s60, 294912
    s_add_u32 s40, s18, s60
    s_addc_u32 s41, s19, 0
    s_and_b32 s41, s41, 0xffff
    s_mov_b32 s42, 299008
    s_mov_b32 s43, 0x00020000
    s_mul_i32 s60, s78, 147456
    s_lshl_b32 s61, s77, 8
    s_add_u32 s60, s60, s61
    s_add_u32 s48, s14, s60
    s_addc_u32 s49, s15, 0
    s_and_b32 s49, s49, 0xffff
    s_mov_b32 s50, 147456
    s_mov_b32 s51, 0x00020000
    s_sub_u32 s50, s50, s61
    s_mov_b32 s68, 0
    s_mov_b32 s70, 0
    s_mov_b32 s72, 0x3e0293ee
    s_mul_i32 s60, s79, 73728
    s_add_u32 s60, s60, 4096
    s_add_u32 s36, s18, s60
    s_addc_u32 s37, s19, 0
    s_and_b32 s37, s37, 0xffff
    s_mov_b32 s38, 73728
    s_mov_b32 s39, 0x00020000
    s_add_u32 s56, s16, 0
    s_addc_u32 s57, s17, 0
    s_and_b32 s57, s57, 0xffff
    s_mov_b32 s58, 256
    s_mov_b32 s59, 0x00020000
    v_and_b32 v59, 1, v3
    v_lshlrev_b32 v59, 1, v59
    v_xor_b32 v59, v59, v2
    v_lshlrev_b32 v59, 4, v59
    v_lshl_add_u32 v13, v3, 10, v59
    v_lshl_add_u32 v13, v4, 6, v13
    v_lshlrev_b32 v59, 10, v2
    v_lshl_add_u32 v59, v3, 6, v59
    v_lshl_add_u32 v59, v4, 3, v59
    v_add_u32 v59, 8192, v59
    v_and_b32 v60, 1, v2
    v_lshl_add_u32 v14, v60, 5, v59
    v_xor_b32 v60, 1, v60
    v_lshl_add_u32 v15, v60, 5, v59
    v_mov_b32 v52, 0x3f803f80
    v_mov_b32 v53, 0x3f803f80
    v_mov_b32 v54, 0x3f803f80
    v_mov_b32 v55, 0x3f803f80
    v_mov_b32 v56, 0xff800000
    v_mov_b32 v57, 0xff800000
    v_mov_b32 v58, 0xff800000
    v_mov_b32 v62, s72
    v_mov_b32 v63, s72
    s_mov_b32 s66, 0
    s_or_b32 s60, s2, s3
    s_cselect_b32 s74, 64, 0
    s_mov_b32 s100, 114688
    s_mov_b32 s101, 114688
    v_add_u32 v10, s66, v13
    v_add_u32 v11, s66, v14
    v_add_u32 v12, s66, v15
    s_barrier
    s_add_u32 m0, s65, 127744
    s_add_u32 s61, s67, 32768
    buffer_load_dwordx4 v19, s[32:35], s67 offen offset:0 lds
    buffer_load_dwordx4 v20, s[32:35], s67 offen offset:1024 lds
    buffer_load_dwordx4 v21, s[32:35], s67 offen offset:2048 lds
    buffer_load_dwordx4 v22, s[32:35], s67 offen offset:3072 lds
    s_add_u32 m0, s65, 131840
    s_add_u32 s67, s67, 128
    buffer_load_dwordx4 v19, s[32:35], s61 offen offset:0 lds
    buffer_load_dwordx4 v20, s[32:35], s61 offen offset:1024 lds
    s_cmp_eq_u32 s67, 1024
    s_cselect_b32 s67, 128, s67
    s_lshl_b32 s60, s3, 8
    v_lshrrev_b32 v250, 4, v1
    v_lshlrev_b32 v250, 11, v250
    v_bfe_u32 v251, v1, 2, 2
    v_lshl_add_u32 v250, v251, 6, v250
    v_add_u32 v250, s60, v250
    v_and_b32 v251, 3, v1
    v_lshl_add_u32 v252, v251, 4, v250
    v_xor_b32 v251, 2, v251
    v_lshl_add_u32 v253, v251, 4, v250
    v_add_u32 v253, 1024, v253
    v_add_u32 v254, 65536, v252
    v_add_u32 v255, 65536, v253
    s_mul_i32 s61, s3, 3
    s_add_u32 s61, s61, 4
    s_lshr_b32 s62, s61, 2
    s_add_u32 s62, s62, s77
    s_and_b32 s62, s62, 3
    s_mul_i32 s62, s62, 73728
    s_and_b32 s61, s61, 3
    s_lshl_b32 s61, s61, 10
    s_add_u32 s61, s61, s62
    s_add_u32 s61, s61, 4096
    v_add_u32 v242, s61, v5
    s_mul_i32 s61, s3, 3
    s_add_u32 s61, s61, 5
    s_lshr_b32 s62, s61, 2
    s_add_u32 s62, s62, s77
    s_and_b32 s62, s62, 3
    s_mul_i32 s62, s62, 73728
    s_and_b32 s61, s61, 3
    s_lshl_b32 s61, s61, 10
    s_add_u32 s61, s61, s62
    s_add_u32 s61, s61, 3072
    v_add_u32 v243, s61, v5
    s_mul_i32 s61, s3, 3
    s_add_u32 s61, s61, 6
    s_lshr_b32 s62, s61, 2
    s_add_u32 s62, s62, s77
    s_and_b32 s62, s62, 3
    s_mul_i32 s62, s62, 73728
    s_and_b32 s61, s61, 3
    s_lshl_b32 s61, s61, 10
    s_add_u32 s61, s61, s62
    s_add_u32 s61, s61, 2048
    v_add_u32 v244, s61, v5
    s_lshl_b32 s61, s3, 12
    s_add_u32 s61, s61, 131072
    v_bfe_u32 v236, v1, 2, 2
    v_lshlrev_b32 v236, 10, v236
    v_lshrrev_b32 v237, 4, v1
    v_lshl_add_u32 v236, v237, 6, v236
    v_add_u32 v236, s61, v236
    v_and_b32 v237, 3, v1
    v_lshl_add_u32 v248, v237, 4, v236
    v_xor_b32 v237, 2, v237
    v_lshl_add_u32 v236, v237, 4, v236
    v_add_u32 v249, 15360, v236
    v_add_u32 v236, 65536, v5
    v_add_u32 v237, 131072, v5
    s_add_u32 s61, s76, 1
    s_and_b32 s61, s61, 3
    s_lshl_b32 s61, s61, 13
    s_add_u32 s61, s61, 122880
    v_add_u32 v238, s61, v5
    s_add_u32 s61, s76, 2
    s_and_b32 s61, s61, 3
    s_lshl_b32 s61, s61, 13
    s_add_u32 s61, s61, 122880
    v_add_u32 v239, s61, v5
    s_add_u32 s61, s76, 3
    s_and_b32 s61, s61, 3
    s_lshl_b32 s61, s61, 13
    s_add_u32 s61, s61, 122880
    v_add_u32 v240, s61, v5
    s_add_u32 s61, s76, 4
    s_and_b32 s61, s61, 3
    s_lshl_b32 s61, s61, 13
    s_add_u32 s61, s61, 122880
    v_add_u32 v241, s61, v5
    s_mul_i32 s60, s3, 3
    s_lshl_b32 s61, s76, 1
    s_sub_u32 s61, s60, s61
    s_add_u32 s62, s61, 6
    s_and_b32 s62, s62, 7
    s_lshl_b32 s62, s62, 12
    v_add_u32 v245, s62, v5
    s_add_u32 s62, s61, 7
    s_and_b32 s62, s62, 7
    s_lshl_b32 s62, s62, 12
    v_add_u32 v246, s62, v5
    s_add_u32 s62, s61, 8
    s_and_b32 s62, s62, 7
    s_cmp_eq_u32 s3, 2
    s_cselect_b32 s62, 8, s62
    s_lshl_b32 s62, s62, 12
    v_add_u32 v247, s62, v5
    ds_read_b32 v9, v6
    s_waitcnt vmcnt(6) lgkmcnt(0)
    v_cmp_gt_u32 vcc, v9, v8
    s_cbranch_vccz L_sp234
L_sp234r:
    ds_read_b64_tr_b16 a[128:129], v26 offset:34816
    ds_read_b64_tr_b16 a[130:131], v27 offset:34816
    ds_read_b128 a[160:163], v24 offset:34816
    ds_read_b128 a[164:167], v24 offset:36864
    ds_read_b128 a[168:171], v24 offset:38912
    ds_read_b64_tr_b16 a[132:133], v26 offset:34824
    ds_read_b64_tr_b16 a[134:135], v27 offset:34824
    s_add_u32 m0, s65, 58112
    ds_read_b64_tr_b16 a[136:137], v26 offset:35072
    s_add_u32 s61, s67, 32768
    ds_read_b64_tr_b16 a[138:139], v27 offset:35072
    ds_read_b64_tr_b16 a[140:141], v26 offset:35080
    ds_read_b64_tr_b16 a[142:143], v27 offset:35080
    ds_read_b64_tr_b16 a[144:145], v26 offset:35328
    buffer_load_dwordx4 v19, s[32:35], s67 offen offset:0 lds
    ds_read_b64_tr_b16 a[146:147], v27 offset:35328
    ds_read_b64_tr_b16 a[148:149], v26 offset:35336
    ds_read_b64_tr_b16 a[150:151], v27 offset:35336
    ds_read_b64_tr_b16 a[152:153], v26 offset:35584
    ds_read_b32 v9, v6
    buffer_load_dwordx4 v20, s[32:35], s67 offen offset:1024 lds
    ds_read_b64_tr_b16 a[154:155], v27 offset:35584
    ds_read_b64_tr_b16 a[156:157], v26 offset:35592
    ds_read_b64_tr_b16 a[158:159], v27 offset:35592
    v_add_u32 v8, 1, v8
    ds_write_b32 v7, v8
    buffer_load_dwordx4 v21, s[32:35], s67 offen offset:2048 lds
    buffer_load_dwordx4 v22, s[32:35], s67 offen offset:3072 lds
    s_add_u32 m0, s65, 62208
    s_nop 0
    buffer_load_dwordx4 v19, s[32:35], s61 offen offset:0 lds
    s_waitcnt lgkmcnt(1)
    v_cmp_gt_u32 vcc, v9, v8
    buffer_load_dwordx4 v20, s[32:35], s61 offen offset:1024 lds
    s_cbranch_vccz L_sp235
L_sp235r:
    s_add_u32 s67, s67, 128
    s_cmp_eq_u32 s67, 1024
    s_cselect_b32 s67, 128, s67
    v_mfma_f32_16x16x32_bf16 v[128:131], a[128:131], a[160:163], 0
    ds_read_b64_tr_b16 a[172:173], v26 offset:43008
    ds_read_b64_tr_b16 a[174:175], v27 offset:43008
    v_mfma_f32_16x16x32_bf16 v[160:163], a[128:131], a[164:167], 0
    ds_read_b128 a[204:207], v25 offset:34816
    ds_read_b128 a[208:211], v25 offset:36864
    v_mfma_f32_16x16x32_bf16 v[192:195], a[128:131], a[168:171], 0
    ds_read_b128 a[212:215], v25 offset:38912
    ds_read_b64_tr_b16 a[176:177], v26 offset:43016
    v_mfma_f32_16x16x32_bf16 v[132:135], a[132:135], a[160:163], 0
    ds_read_b64_tr_b16 a[178:179], v27 offset:43016
    s_add_u32 m0, s65, 92928
    v_mfma_f32_16x16x32_bf16 v[164:167], a[132:135], a[164:167], 0
    ds_read_b64_tr_b16 a[180:181], v26 offset:43264
    s_add_u32 s61, s67, 32768
    v_mfma_f32_16x16x32_bf16 v[196:199], a[132:135], a[168:171], 0
    ds_read_b64_tr_b16 a[182:183], v27 offset:43264
    v_mfma_f32_16x16x32_bf16 v[136:139], a[136:139], a[160:163], 0
    ds_read_b64_tr_b16 a[184:185], v26 offset:43272
    v_mfma_f32_16x16x32_bf16 v[168:171], a[136:139], a[164:167], 0
    ds_read_b64_tr_b16 a[186:187], v27 offset:43272
    v_mfma_f32_16x16x32_bf16 v[200:203], a[136:139], a[168:171], 0
    ds_read_b64_tr_b16 a[188:189], v26 offset:43520
    s_waitcnt lgkmcnt(7)
    v_mfma_f32_16x16x32_bf16 v[140:143], a[140:143], a[160:163], 0
    buffer_load_dwordx4 v19, s[32:35], s67 offen offset:0 lds
    v_mfma_f32_16x16x32_bf16 v[172:175], a[140:143], a[164:167], 0
    ds_read_b64_tr_b16 a[190:191], v27 offset:43520
    ds_read_b64_tr_b16 a[192:193], v26 offset:43528
    v_mfma_f32_16x16x32_bf16 v[204:207], a[140:143], a[168:171], 0
    ds_read_b64_tr_b16 a[194:195], v27 offset:43528
    v_mfma_f32_16x16x32_bf16 v[144:147], a[144:147], a[160:163], 0
    ds_read_b64_tr_b16 a[196:197], v26 offset:43776
    ds_read_b32 v9, v6
    v_mfma_f32_16x16x32_bf16 v[176:179], a[144:147], a[164:167], 0
    buffer_load_dwordx4 v20, s[32:35], s67 offen offset:1024 lds
    v_mfma_f32_16x16x32_bf16 v[208:211], a[144:147], a[168:171], 0
    ds_read_b64_tr_b16 a[198:199], v27 offset:43776
    ds_read_b64_tr_b16 a[200:201], v26 offset:43784
    v_mfma_f32_16x16x32_bf16 v[148:151], a[148:151], a[160:163], 0
    ds_read_b64_tr_b16 a[202:203], v27 offset:43784
    v_add_u32 v8, 1, v8
    v_mfma_f32_16x16x32_bf16 v[180:183], a[148:151], a[164:167], 0
    ds_write_b32 v7, v8
    v_mfma_f32_16x16x32_bf16 v[212:215], a[148:151], a[168:171], 0
    buffer_load_dwordx4 v21, s[32:35], s67 offen offset:2048 lds
    v_mfma_f32_16x16x32_bf16 v[152:155], a[152:155], a[160:163], 0
    v_mfma_f32_16x16x32_bf16 v[184:187], a[152:155], a[164:167], 0
    v_mfma_f32_16x16x32_bf16 v[216:219], a[152:155], a[168:171], 0
    s_waitcnt vmcnt(9) lgkmcnt(1)
    v_cmp_gt_u32 vcc, v9, v8
    v_mfma_f32_16x16x32_bf16 v[156:159], a[156:159], a[160:163], 0
    v_mfma_f32_16x16x32_bf16 v[188:191], a[156:159], a[164:167], 0
    s_cbranch_vccz L_sp236
L_sp236r:
    v_mfma_f32_16x16x32_bf16 v[220:223], a[156:159], a[168:171], 0
    v_mfma_f32_16x16x32_bf16 v[128:131], a[172:175], a[204:207], v[128:131]
    ds_read_b64_tr_b16 a[128:129], v30 offset:0
    ds_read_b64_tr_b16 a[130:131], v31 offset:0
    v_mfma_f32_16x16x32_bf16 v[160:163], a[172:175], a[208:211], v[160:163]
    ds_read_b128 a[160:163], v28 offset:0
    ds_read_b128 a[164:167], v28 offset:2048
    v_mfma_f32_16x16x32_bf16 v[192:195], a[172:175], a[212:215], v[192:195]
    ds_read_b128 a[168:171], v28 offset:4096
    ds_read_b64_tr_b16 a[132:133], v30 offset:8
    v_mfma_f32_16x16x32_bf16 v[132:135], a[176:179], a[204:207], v[132:135]
    ds_read_b64_tr_b16 a[134:135], v31 offset:8
    v_mfma_f32_16x16x32_bf16 v[164:167], a[176:179], a[208:211], v[164:167]
    ds_read_b64_tr_b16 a[136:137], v30 offset:256
    v_mfma_f32_16x16x32_bf16 v[196:199], a[176:179], a[212:215], v[196:199]
    ds_read_b64_tr_b16 a[138:139], v31 offset:256
    v_mfma_f32_16x16x32_bf16 v[136:139], a[180:183], a[204:207], v[136:139]
    ds_read_b64_tr_b16 a[140:141], v30 offset:264
    v_mfma_f32_16x16x32_bf16 v[168:171], a[180:183], a[208:211], v[168:171]
    ds_read_b64_tr_b16 a[142:143], v31 offset:264
    v_mfma_f32_16x16x32_bf16 v[200:203], a[180:183], a[212:215], v[200:203]
    ds_read_b64_tr_b16 a[144:145], v30 offset:512
    v_mfma_f32_16x16x32_bf16 v[140:143], a[184:187], a[204:207], v[140:143]
    buffer_load_dwordx4 v22, s[32:35], s67 offen offset:3072 lds
    v_mfma_f32_16x16x32_bf16 v[172:175], a[184:187], a[208:211], v[172:175]
    ds_read_b64_tr_b16 a[146:147], v31 offset:512
    ds_read_b64_tr_b16 a[148:149], v30 offset:520
    v_mfma_f32_16x16x32_bf16 v[204:207], a[184:187], a[212:215], v[204:207]
    ds_read_b64_tr_b16 a[150:151], v31 offset:520
    s_add_u32 m0, s65, 97024
    v_mfma_f32_16x16x32_bf16 v[144:147], a[188:191], a[204:207], v[144:147]
    ds_read_b64_tr_b16 a[152:153], v30 offset:768
    ds_read_b32 v9, v6
    v_mfma_f32_16x16x32_bf16 v[176:179], a[188:191], a[208:211], v[176:179]
    buffer_load_dwordx4 v19, s[32:35], s61 offen offset:0 lds
    v_mfma_f32_16x16x32_bf16 v[208:211], a[188:191], a[212:215], v[208:211]
    ds_read_b64_tr_b16 a[154:155], v31 offset:768
    ds_read_b64_tr_b16 a[156:157], v30 offset:776
    v_mfma_f32_16x16x32_bf16 v[148:151], a[192:195], a[204:207], v[148:151]
    ds_read_b64_tr_b16 a[158:159], v31 offset:776
    v_add_u32 v8, 1, v8
    v_mfma_f32_16x16x32_bf16 v[180:183], a[192:195], a[208:211], v[180:183]
    ds_write_b32 v7, v8
    v_mfma_f32_16x16x32_bf16 v[212:215], a[192:195], a[212:215], v[212:215]
    buffer_load_dwordx4 v20, s[32:35], s61 offen offset:1024 lds
    v_mfma_f32_16x16x32_bf16 v[152:155], a[196:199], a[204:207], v[152:155]
    s_add_u32 s67, s67, 128
    v_mfma_f32_16x16x32_bf16 v[184:187], a[196:199], a[208:211], v[184:187]
    s_cmp_eq_u32 s67, 1024
    s_cselect_b32 s67, 128, s67
    v_mfma_f32_16x16x32_bf16 v[216:219], a[196:199], a[212:215], v[216:219]
    s_waitcnt lgkmcnt(1)
    v_cmp_gt_u32 vcc, v9, v8
    v_mfma_f32_16x16x32_bf16 v[156:159], a[200:203], a[204:207], v[156:159]
    v_mfma_f32_16x16x32_bf16 v[188:191], a[200:203], a[208:211], v[188:191]
    s_cbranch_vccz L_sp237
L_sp237r:
    v_mfma_f32_16x16x32_bf16 v[220:223], a[200:203], a[212:215], v[220:223]
    v_mfma_f32_16x16x32_bf16 v[128:131], a[128:131], a[160:163], v[128:131]
    ds_read_b64_tr_b16 a[172:173], v30 offset:8192
    ds_read_b64_tr_b16 a[174:175], v31 offset:8192
    v_mfma_f32_16x16x32_bf16 v[160:163], a[128:131], a[164:167], v[160:163]
    ds_read_b128 a[204:207], v29 offset:0
    ds_read_b128 a[208:211], v29 offset:2048
    v_mfma_f32_16x16x32_bf16 v[192:195], a[128:131], a[168:171], v[192:195]
    ds_read_b128 a[212:215], v29 offset:4096
    ds_read_b64_tr_b16 a[176:177], v30 offset:8200
    v_mfma_f32_16x16x32_bf16 v[132:135], a[132:135], a[160:163], v[132:135]
    ds_read_b64_tr_b16 a[178:179], v31 offset:8200
    s_add_u32 m0, s65, 127744
    v_mfma_f32_16x16x32_bf16 v[164:167], a[132:135], a[164:167], v[164:167]
    ds_read_b64_tr_b16 a[180:181], v30 offset:8448
    s_add_u32 s61, s67, 32768
    v_mfma_f32_16x16x32_bf16 v[196:199], a[132:135], a[168:171], v[196:199]
    ds_read_b64_tr_b16 a[182:183], v31 offset:8448
    v_mfma_f32_16x16x32_bf16 v[136:139], a[136:139], a[160:163], v[136:139]
    ds_read_b64_tr_b16 a[184:185], v30 offset:8456
    v_mfma_f32_16x16x32_bf16 v[168:171], a[136:139], a[164:167], v[168:171]
    ds_read_b64_tr_b16 a[186:187], v31 offset:8456
    v_mfma_f32_16x16x32_bf16 v[200:203], a[136:139], a[168:171], v[200:203]
    ds_read_b64_tr_b16 a[188:189], v30 offset:8704
    s_waitcnt lgkmcnt(7)
    v_mfma_f32_16x16x32_bf16 v[140:143], a[140:143], a[160:163], v[140:143]
    buffer_load_dwordx4 v19, s[32:35], s67 offen offset:0 lds
    v_mfma_f32_16x16x32_bf16 v[172:175], a[140:143], a[164:167], v[172:175]
    ds_read_b64_tr_b16 a[190:191], v31 offset:8704
    ds_read_b64_tr_b16 a[192:193], v30 offset:8712
    v_mfma_f32_16x16x32_bf16 v[204:207], a[140:143], a[168:171], v[204:207]
    ds_read_b64_tr_b16 a[194:195], v31 offset:8712
    v_mfma_f32_16x16x32_bf16 v[144:147], a[144:147], a[160:163], v[144:147]
    ds_read_b64_tr_b16 a[196:197], v30 offset:8960
    ds_read_b32 v9, v6
    v_mfma_f32_16x16x32_bf16 v[176:179], a[144:147], a[164:167], v[176:179]
    buffer_load_dwordx4 v20, s[32:35], s67 offen offset:1024 lds
    v_mfma_f32_16x16x32_bf16 v[208:211], a[144:147], a[168:171], v[208:211]
    ds_read_b64_tr_b16 a[198:199], v31 offset:8960
    ds_read_b64_tr_b16 a[200:201], v30 offset:8968
    v_mfma_f32_16x16x32_bf16 v[148:151], a[148:151], a[160:163], v[148:151]
    ds_read_b64_tr_b16 a[202:203], v31 offset:8968
    v_add_u32 v8, 1, v8
    v_mfma_f32_16x16x32_bf16 v[180:183], a[148:151], a[164:167], v[180:183]
    ds_write_b32 v7, v8
    v_mfma_f32_16x16x32_bf16 v[212:215], a[148:151], a[168:171], v[212:215]
    buffer_load_dwordx4 v21, s[32:35], s67 offen offset:2048 lds
    v_mfma_f32_16x16x32_bf16 v[152:155], a[152:155], a[160:163], v[152:155]
    v_mfma_f32_16x16x32_bf16 v[184:187], a[152:155], a[164:167], v[184:187]
    v_mfma_f32_16x16x32_bf16 v[216:219], a[152:155], a[168:171], v[216:219]
    s_waitcnt vmcnt(9) lgkmcnt(1)
    v_cmp_gt_u32 vcc, v9, v8
    v_mfma_f32_16x16x32_bf16 v[156:159], a[156:159], a[160:163], v[156:159]
    v_mfma_f32_16x16x32_bf16 v[188:191], a[156:159], a[164:167], v[188:191]
    s_cbranch_vccz L_sp238
L_sp238r:
    v_mfma_f32_16x16x32_bf16 v[220:223], a[156:159], a[168:171], v[220:223]
    v_mfma_f32_16x16x32_bf16 v[128:131], a[172:175], a[204:207], v[128:131]
    ds_read_b64_tr_b16 a[128:129], v26 offset:0
    ds_read_b64_tr_b16 a[130:131], v27 offset:0
    v_mfma_f32_16x16x32_bf16 v[160:163], a[172:175], a[208:211], v[160:163]
    ds_read_b128 a[160:163], v24 offset:0
    ds_read_b128 a[164:167], v24 offset:2048
    v_mfma_f32_16x16x32_bf16 v[192:195], a[172:175], a[212:215], v[192:195]
    ds_read_b128 a[168:171], v24 offset:4096
    ds_read_b64_tr_b16 a[132:133], v26 offset:8
    v_mfma_f32_16x16x32_bf16 v[132:135], a[176:179], a[204:207], v[132:135]
    ds_read_b64_tr_b16 a[134:135], v27 offset:8
    v_mfma_f32_16x16x32_bf16 v[164:167], a[176:179], a[208:211], v[164:167]
    ds_read_b64_tr_b16 a[136:137], v26 offset:256
    v_mfma_f32_16x16x32_bf16 v[196:199], a[176:179], a[212:215], v[196:199]
    ds_read_b64_tr_b16 a[138:139], v27 offset:256
    v_mfma_f32_16x16x32_bf16 v[136:139], a[180:183], a[204:207], v[136:139]
    ds_read_b64_tr_b16 a[140:141], v26 offset:264
    v_mfma_f32_16x16x32_bf16 v[168:171], a[180:183], a[208:211], v[168:171]
    ds_read_b64_tr_b16 a[142:143], v27 offset:264
    v_mfma_f32_16x16x32_bf16 v[200:203], a[180:183], a[212:215], v[200:203]
    ds_read_b64_tr_b16 a[144:145], v26 offset:512
    v_mfma_f32_16x16x32_bf16 v[140:143], a[184:187], a[204:207], v[140:143]
    buffer_load_dwordx4 v22, s[32:35], s67 offen offset:3072 lds
    v_mfma_f32_16x16x32_bf16 v[172:175], a[184:187], a[208:211], v[172:175]
    ds_read_b64_tr_b16 a[146:147], v27 offset:512
    ds_read_b64_tr_b16 a[148:149], v26 offset:520
    v_mfma_f32_16x16x32_bf16 v[204:207], a[184:187], a[212:215], v[204:207]
    ds_read_b64_tr_b16 a[150:151], v27 offset:520
    s_add_u32 m0, s65, 131840
    v_mfma_f32_16x16x32_bf16 v[144:147], a[188:191], a[204:207], v[144:147]
    ds_read_b64_tr_b16 a[152:153], v26 offset:768
    ds_read_b32 v9, v6
    v_mfma_f32_16x16x32_bf16 v[176:179], a[188:191], a[208:211], v[176:179]
    buffer_load_dwordx4 v19, s[32:35], s61 offen offset:0 lds
    v_mfma_f32_16x16x32_bf16 v[208:211], a[188:191], a[212:215], v[208:211]
    ds_read_b64_tr_b16 a[154:155], v27 offset:768
    ds_read_b64_tr_b16 a[156:157], v26 offset:776
    v_mfma_f32_16x16x32_bf16 v[148:151], a[192:195], a[204:207], v[148:151]
    ds_read_b64_tr_b16 a[158:159], v27 offset:776
    v_add_u32 v8, 1, v8
    v_mfma_f32_16x16x32_bf16 v[180:183], a[192:195], a[208:211], v[180:183]
    ds_write_b32 v7, v8
    v_mfma_f32_16x16x32_bf16 v[212:215], a[192:195], a[212:215], v[212:215]
    buffer_load_dwordx4 v20, s[32:35], s61 offen offset:1024 lds
    v_mfma_f32_16x16x32_bf16 v[152:155], a[196:199], a[204:207], v[152:155]
    s_add_u32 s67, s67, 128
    v_mfma_f32_16x16x32_bf16 v[184:187], a[196:199], a[208:211], v[184:187]
    s_cmp_eq_u32 s67, 1024
    s_cselect_b32 s67, 128, s67
    v_mfma_f32_16x16x32_bf16 v[216:219], a[196:199], a[212:215], v[216:219]
    s_waitcnt lgkmcnt(1)
    v_cmp_gt_u32 vcc, v9, v8
    v_mfma_f32_16x16x32_bf16 v[156:159], a[200:203], a[204:207], v[156:159]
    v_mfma_f32_16x16x32_bf16 v[188:191], a[200:203], a[208:211], v[188:191]
    s_cbranch_vccz L_sp239
L_sp239r:
    v_mfma_f32_16x16x32_bf16 v[220:223], a[200:203], a[212:215], v[220:223]
    v_mfma_f32_16x16x32_bf16 v[128:131], a[128:131], a[160:163], v[128:131]
    ds_read_b64_tr_b16 a[172:173], v26 offset:8192
    ds_read_b64_tr_b16 a[174:175], v27 offset:8192
    v_mfma_f32_16x16x32_bf16 v[160:163], a[128:131], a[164:167], v[160:163]
    ds_read_b128 a[204:207], v25 offset:0
    ds_read_b128 a[208:211], v25 offset:2048
    v_mfma_f32_16x16x32_bf16 v[192:195], a[128:131], a[168:171], v[192:195]
    ds_read_b128 a[212:215], v25 offset:4096
    ds_read_b64_tr_b16 a[176:177], v26 offset:8200
    v_mfma_f32_16x16x32_bf16 v[132:135], a[132:135], a[160:163], v[132:135]
    ds_read_b64_tr_b16 a[178:179], v27 offset:8200
    s_add_u32 m0, s65, 58112
    v_mfma_f32_16x16x32_bf16 v[164:167], a[132:135], a[164:167], v[164:167]
    ds_read_b64_tr_b16 a[180:181], v26 offset:8448
    s_add_u32 s61, s67, 32768
    v_mfma_f32_16x16x32_bf16 v[196:199], a[132:135], a[168:171], v[196:199]
    ds_read_b64_tr_b16 a[182:183], v27 offset:8448
    v_mfma_f32_16x16x32_bf16 v[136:139], a[136:139], a[160:163], v[136:139]
    ds_read_b64_tr_b16 a[184:185], v26 offset:8456
    v_mfma_f32_16x16x32_bf16 v[168:171], a[136:139], a[164:167], v[168:171]
    ds_read_b64_tr_b16 a[186:187], v27 offset:8456
    v_mfma_f32_16x16x32_bf16 v[200:203], a[136:139], a[168:171], v[200:203]
    ds_read_b64_tr_b16 a[188:189], v26 offset:8704
    s_waitcnt lgkmcnt(7)
    v_mfma_f32_16x16x32_bf16 v[140:143], a[140:143], a[160:163], v[140:143]
    buffer_load_dwordx4 v19, s[32:35], s67 offen offset:0 lds
    v_mfma_f32_16x16x32_bf16 v[172:175], a[140:143], a[164:167], v[172:175]
    ds_read_b64_tr_b16 a[190:191], v27 offset:8704
    ds_read_b64_tr_b16 a[192:193], v26 offset:8712
    v_mfma_f32_16x16x32_bf16 v[204:207], a[140:143], a[168:171], v[204:207]
    ds_read_b64_tr_b16 a[194:195], v27 offset:8712
    v_mfma_f32_16x16x32_bf16 v[144:147], a[144:147], a[160:163], v[144:147]
    ds_read_b64_tr_b16 a[196:197], v26 offset:8960
    ds_read_b32 v9, v6
    v_mfma_f32_16x16x32_bf16 v[176:179], a[144:147], a[164:167], v[176:179]
    buffer_load_dwordx4 v20, s[32:35], s67 offen offset:1024 lds
    v_mfma_f32_16x16x32_bf16 v[208:211], a[144:147], a[168:171], v[208:211]
    ds_read_b64_tr_b16 a[198:199], v27 offset:8960
    ds_read_b64_tr_b16 a[200:201], v26 offset:8968
    v_mfma_f32_16x16x32_bf16 v[148:151], a[148:151], a[160:163], v[148:151]
    ds_read_b64_tr_b16 a[202:203], v27 offset:8968
    v_add_u32 v8, 1, v8
    v_mfma_f32_16x16x32_bf16 v[180:183], a[148:151], a[164:167], v[180:183]
    ds_write_b32 v7, v8
    v_mfma_f32_16x16x32_bf16 v[212:215], a[148:151], a[168:171], v[212:215]
    buffer_load_dwordx4 v21, s[32:35], s67 offen offset:2048 lds
    v_mfma_f32_16x16x32_bf16 v[152:155], a[152:155], a[160:163], v[152:155]
    v_mfma_f32_16x16x32_bf16 v[184:187], a[152:155], a[164:167], v[184:187]
    v_mfma_f32_16x16x32_bf16 v[216:219], a[152:155], a[168:171], v[216:219]
    s_waitcnt vmcnt(9) lgkmcnt(1)
    v_cmp_gt_u32 vcc, v9, v8
    v_mfma_f32_16x16x32_bf16 v[156:159], a[156:159], a[160:163], v[156:159]
    v_mfma_f32_16x16x32_bf16 v[188:191], a[156:159], a[164:167], v[188:191]
    s_cbranch_vccz L_sp240
L_sp240r:
    v_mfma_f32_16x16x32_bf16 v[220:223], a[156:159], a[168:171], v[220:223]
    v_mfma_f32_16x16x32_bf16 v[128:131], a[172:175], a[204:207], v[128:131]
    ds_read_b64_tr_b16 a[128:129], v26 offset:34816
    ds_read_b64_tr_b16 a[130:131], v27 offset:34816
    v_mfma_f32_16x16x32_bf16 v[160:163], a[172:175], a[208:211], v[160:163]
    ds_read_b128 a[160:163], v24 offset:34816
    ds_read_b128 a[164:167], v24 offset:36864
    v_mfma_f32_16x16x32_bf16 v[192:195], a[172:175], a[212:215], v[192:195]
    ds_read_b128 a[168:171], v24 offset:38912
    ds_read_b64_tr_b16 a[132:133], v26 offset:34824
    v_mfma_f32_16x16x32_bf16 v[132:135], a[176:179], a[204:207], v[132:135]
    ds_read_b64_tr_b16 a[134:135], v27 offset:34824
    v_mfma_f32_16x16x32_bf16 v[164:167], a[176:179], a[208:211], v[164:167]
    ds_read_b64_tr_b16 a[136:137], v26 offset:35072
    v_mfma_f32_16x16x32_bf16 v[196:199], a[176:179], a[212:215], v[196:199]
    ds_read_b64_tr_b16 a[138:139], v27 offset:35072
    v_mfma_f32_16x16x32_bf16 v[136:139], a[180:183], a[204:207], v[136:139]
    ds_read_b64_tr_b16 a[140:141], v26 offset:35080
    v_mfma_f32_16x16x32_bf16 v[168:171], a[180:183], a[208:211], v[168:171]
    ds_read_b64_tr_b16 a[142:143], v27 offset:35080
    v_mfma_f32_16x16x32_bf16 v[200:203], a[180:183], a[212:215], v[200:203]
    ds_read_b64_tr_b16 a[144:145], v26 offset:35328
    v_mfma_f32_16x16x32_bf16 v[140:143], a[184:187], a[204:207], v[140:143]
    buffer_load_dwordx4 v22, s[32:35], s67 offen offset:3072 lds
    v_mfma_f32_16x16x32_bf16 v[172:175], a[184:187], a[208:211], v[172:175]
    ds_read_b64_tr_b16 a[146:147], v27 offset:35328
    ds_read_b64_tr_b16 a[148:149], v26 offset:35336
    v_mfma_f32_16x16x32_bf16 v[204:207], a[184:187], a[212:215], v[204:207]
    ds_read_b64_tr_b16 a[150:151], v27 offset:35336
    s_add_u32 m0, s65, 62208
    v_mfma_f32_16x16x32_bf16 v[144:147], a[188:191], a[204:207], v[144:147]
    ds_read_b64_tr_b16 a[152:153], v26 offset:35584
    ds_read_b32 v9, v6
    v_mfma_f32_16x16x32_bf16 v[176:179], a[188:191], a[208:211], v[176:179]
    buffer_load_dwordx4 v19, s[32:35], s61 offen offset:0 lds
    v_mfma_f32_16x16x32_bf16 v[208:211], a[188:191], a[212:215], v[208:211]
    ds_read_b64_tr_b16 a[154:155], v27 offset:35584
    ds_read_b64_tr_b16 a[156:157], v26 offset:35592
    v_mfma_f32_16x16x32_bf16 v[148:151], a[192:195], a[204:207], v[148:151]
    ds_read_b64_tr_b16 a[158:159], v27 offset:35592
    v_add_u32 v8, 1, v8
    v_mfma_f32_16x16x32_bf16 v[180:183], a[192:195], a[208:211], v[180:183]
    ds_write_b32 v7, v8
    v_mfma_f32_16x16x32_bf16 v[212:215], a[192:195], a[212:215], v[212:215]
    buffer_load_dwordx4 v20, s[32:35], s61 offen offset:1024 lds
    v_mfma_f32_16x16x32_bf16 v[152:155], a[196:199], a[204:207], v[152:155]
    s_add_u32 s67, s67, 128
    v_mfma_f32_16x16x32_bf16 v[184:187], a[196:199], a[208:211], v[184:187]
    s_cmp_eq_u32 s67, 1024
    s_cselect_b32 s67, 128, s67
    v_mfma_f32_16x16x32_bf16 v[216:219], a[196:199], a[212:215], v[216:219]
    s_waitcnt lgkmcnt(1)
    v_cmp_gt_u32 vcc, v9, v8
    v_mfma_f32_16x16x32_bf16 v[156:159], a[200:203], a[204:207], v[156:159]
    v_mfma_f32_16x16x32_bf16 v[188:191], a[200:203], a[208:211], v[188:191]
    s_cbranch_vccz L_sp241
L_sp241r:
    v_mfma_f32_16x16x32_bf16 v[220:223], a[200:203], a[212:215], v[220:223]
    v_mfma_f32_16x16x32_bf16 v[128:131], a[128:131], a[160:163], v[128:131]
    ds_read_b64_tr_b16 a[172:173], v26 offset:43008
    ds_read_b64_tr_b16 a[174:175], v27 offset:43008
    v_mfma_f32_16x16x32_bf16 v[160:163], a[128:131], a[164:167], v[160:163]
    ds_read_b128 a[204:207], v25 offset:34816
    ds_read_b128 a[208:211], v25 offset:36864
    v_mfma_f32_16x16x32_bf16 v[192:195], a[128:131], a[168:171], v[192:195]
    ds_read_b128 a[212:215], v25 offset:38912
    ds_read_b64_tr_b16 a[176:177], v26 offset:43016
    v_mfma_f32_16x16x32_bf16 v[132:135], a[132:135], a[160:163], v[132:135]
    ds_read_b64_tr_b16 a[178:179], v27 offset:43016
    s_add_u32 m0, s65, 92928
    v_mfma_f32_16x16x32_bf16 v[164:167], a[132:135], a[164:167], v[164:167]
    ds_read_b64_tr_b16 a[180:181], v26 offset:43264
    s_add_u32 s61, s67, 32768
    v_mfma_f32_16x16x32_bf16 v[196:199], a[132:135], a[168:171], v[196:199]
    ds_read_b64_tr_b16 a[182:183], v27 offset:43264
    v_mfma_f32_16x16x32_bf16 v[136:139], a[136:139], a[160:163], v[136:139]
    ds_read_b64_tr_b16 a[184:185], v26 offset:43272
    v_mfma_f32_16x16x32_bf16 v[168:171], a[136:139], a[164:167], v[168:171]
    ds_read_b64_tr_b16 a[186:187], v27 offset:43272
    v_mfma_f32_16x16x32_bf16 v[200:203], a[136:139], a[168:171], v[200:203]
    ds_read_b64_tr_b16 a[188:189], v26 offset:43520
    s_waitcnt lgkmcnt(7)
    v_mfma_f32_16x16x32_bf16 v[140:143], a[140:143], a[160:163], v[140:143]
    buffer_load_dwordx4 v19, s[32:35], s67 offen offset:0 lds
    v_mfma_f32_16x16x32_bf16 v[172:175], a[140:143], a[164:167], v[172:175]
    ds_read_b64_tr_b16 a[190:191], v27 offset:43520
    ds_read_b64_tr_b16 a[192:193], v26 offset:43528
    v_mfma_f32_16x16x32_bf16 v[204:207], a[140:143], a[168:171], v[204:207]
    ds_read_b64_tr_b16 a[194:195], v27 offset:43528
    v_mfma_f32_16x16x32_bf16 v[144:147], a[144:147], a[160:163], v[144:147]
    ds_read_b64_tr_b16 a[196:197], v26 offset:43776
    ds_read_b32 v9, v6
    v_mfma_f32_16x16x32_bf16 v[176:179], a[144:147], a[164:167], v[176:179]
    buffer_load_dwordx4 v20, s[32:35], s67 offen offset:1024 lds
    v_mfma_f32_16x16x32_bf16 v[208:211], a[144:147], a[168:171], v[208:211]
    ds_read_b64_tr_b16 a[198:199], v27 offset:43776
    ds_read_b64_tr_b16 a[200:201], v26 offset:43784
    v_mfma_f32_16x16x32_bf16 v[148:151], a[148:151], a[160:163], v[148:151]
    ds_read_b64_tr_b16 a[202:203], v27 offset:43784
    v_add_u32 v8, 1, v8
    v_mfma_f32_16x16x32_bf16 v[180:183], a[148:151], a[164:167], v[180:183]
    ds_write_b32 v7, v8
    v_mfma_f32_16x16x32_bf16 v[212:215], a[148:151], a[168:171], v[212:215]
    buffer_load_dwordx4 v21, s[32:35], s67 offen offset:2048 lds
    v_mfma_f32_16x16x32_bf16 v[152:155], a[152:155], a[160:163], v[152:155]
    v_mfma_f32_16x16x32_bf16 v[184:187], a[152:155], a[164:167], v[184:187]
    v_mfma_f32_16x16x32_bf16 v[216:219], a[152:155], a[168:171], v[216:219]
    s_waitcnt vmcnt(9) lgkmcnt(1)
    v_cmp_gt_u32 vcc, v9, v8
    v_mfma_f32_16x16x32_bf16 v[156:159], a[156:159], a[160:163], v[156:159]
    v_mfma_f32_16x16x32_bf16 v[188:191], a[156:159], a[164:167], v[188:191]
    s_cbranch_vccz L_sp242
L_sp242r:
    v_mfma_f32_16x16x32_bf16 v[220:223], a[156:159], a[168:171], v[220:223]
    v_mfma_f32_16x16x32_bf16 v[128:131], a[172:175], a[204:207], v[128:131]
    ds_read_b64_tr_b16 a[128:129], v30 offset:0
    ds_read_b64_tr_b16 a[130:131], v31 offset:0
    v_mfma_f32_16x16x32_bf16 v[160:163], a[172:175], a[208:211], v[160:163]
    ds_read_b128 a[160:163], v28 offset:0
    ds_read_b128 a[164:167], v28 offset:2048
    v_mfma_f32_16x16x32_bf16 v[192:195], a[172:175], a[212:215], v[192:195]
    ds_read_b128 a[168:171], v28 offset:4096
    ds_read_b64_tr_b16 a[132:133], v30 offset:8
    v_mfma_f32_16x16x32_bf16 v[132:135], a[176:179], a[204:207], v[132:135]
    ds_read_b64_tr_b16 a[134:135], v31 offset:8
    v_mfma_f32_16x16x32_bf16 v[164:167], a[176:179], a[208:211], v[164:167]
    ds_read_b64_tr_b16 a[136:137], v30 offset:256
    v_mfma_f32_16x16x32_bf16 v[196:199], a[176:179], a[212:215], v[196:199]
    ds_read_b64_tr_b16 a[138:139], v31 offset:256
    v_mfma_f32_16x16x32_bf16 v[136:139], a[180:183], a[204:207], v[136:139]
    ds_read_b64_tr_b16 a[140:141], v30 offset:264
    v_mfma_f32_16x16x32_bf16 v[168:171], a[180:183], a[208:211], v[168:171]
    ds_read_b64_tr_b16 a[142:143], v31 offset:264
    v_mfma_f32_16x16x32_bf16 v[200:203], a[180:183], a[212:215], v[200:203]
    ds_read_b64_tr_b16 a[144:145], v30 offset:512
    v_mfma_f32_16x16x32_bf16 v[140:143], a[184:187], a[204:207], v[140:143]
    buffer_load_dwordx4 v22, s[32:35], s67 offen offset:3072 lds
    v_mfma_f32_16x16x32_bf16 v[172:175], a[184:187], a[208:211], v[172:175]
    ds_read_b64_tr_b16 a[146:147], v31 offset:512
    ds_read_b64_tr_b16 a[148:149], v30 offset:520
    v_mfma_f32_16x16x32_bf16 v[204:207], a[184:187], a[212:215], v[204:207]
    ds_read_b64_tr_b16 a[150:151], v31 offset:520
    s_add_u32 m0, s65, 97024
    v_mfma_f32_16x16x32_bf16 v[144:147], a[188:191], a[204:207], v[144:147]
    ds_read_b64_tr_b16 a[152:153], v30 offset:768
    ds_read_b32 v9, v6
    v_mfma_f32_16x16x32_bf16 v[176:179], a[188:191], a[208:211], v[176:179]
    buffer_load_dwordx4 v19, s[32:35], s61 offen offset:0 lds
    v_mfma_f32_16x16x32_bf16 v[208:211], a[188:191], a[212:215], v[208:211]
    ds_read_b64_tr_b16 a[154:155], v31 offset:768
    ds_read_b64_tr_b16 a[156:157], v30 offset:776
    v_mfma_f32_16x16x32_bf16 v[148:151], a[192:195], a[204:207], v[148:151]
    ds_read_b64_tr_b16 a[158:159], v31 offset:776
    v_add_u32 v8, 1, v8
    v_mfma_f32_16x16x32_bf16 v[180:183], a[192:195], a[208:211], v[180:183]
    ds_write_b32 v7, v8
    v_mfma_f32_16x16x32_bf16 v[212:215], a[192:195], a[212:215], v[212:215]
    buffer_load_dwordx4 v20, s[32:35], s61 offen offset:1024 lds
    v_mfma_f32_16x16x32_bf16 v[152:155], a[196:199], a[204:207], v[152:155]
    s_add_u32 s67, s67, 128
    v_mfma_f32_16x16x32_bf16 v[184:187], a[196:199], a[208:211], v[184:187]
    s_cmp_eq_u32 s67, 1024
    s_cselect_b32 s67, 128, s67
    v_mfma_f32_16x16x32_bf16 v[216:219], a[196:199], a[212:215], v[216:219]
    s_waitcnt lgkmcnt(1)
    v_cmp_gt_u32 vcc, v9, v8
    v_mfma_f32_16x16x32_bf16 v[156:159], a[200:203], a[204:207], v[156:159]
    v_mfma_f32_16x16x32_bf16 v[188:191], a[200:203], a[208:211], v[188:191]
    s_cbranch_vccz L_sp243
L_sp243r:
    v_mfma_f32_16x16x32_bf16 v[220:223], a[200:203], a[212:215], v[220:223]
    v_mfma_f32_16x16x32_bf16 v[128:131], a[128:131], a[160:163], v[128:131]
    ds_read_b64_tr_b16 a[172:173], v30 offset:8192
    ds_read_b64_tr_b16 a[174:175], v31 offset:8192
    v_mfma_f32_16x16x32_bf16 v[160:163], a[128:131], a[164:167], v[160:163]
    ds_read_b128 a[204:207], v29 offset:0
    ds_read_b128 a[208:211], v29 offset:2048
    v_mfma_f32_16x16x32_bf16 v[192:195], a[128:131], a[168:171], v[192:195]
    ds_read_b128 a[212:215], v29 offset:4096
    ds_read_b64_tr_b16 a[176:177], v30 offset:8200
    v_mfma_f32_16x16x32_bf16 v[132:135], a[132:135], a[160:163], v[132:135]
    ds_read_b64_tr_b16 a[178:179], v31 offset:8200
    s_add_u32 m0, s65, 127744
    v_mfma_f32_16x16x32_bf16 v[164:167], a[132:135], a[164:167], v[164:167]
    ds_read_b64_tr_b16 a[180:181], v30 offset:8448
    s_add_u32 s61, s67, 32768
    v_mfma_f32_16x16x32_bf16 v[196:199], a[132:135], a[168:171], v[196:199]
    ds_read_b64_tr_b16 a[182:183], v31 offset:8448
    v_mfma_f32_16x16x32_bf16 v[136:139], a[136:139], a[160:163], v[136:139]
    ds_read_b64_tr_b16 a[184:185], v30 offset:8456
    v_mfma_f32_16x16x32_bf16 v[168:171], a[136:139], a[164:167], v[168:171]
    ds_read_b64_tr_b16 a[186:187], v31 offset:8456
    v_mfma_f32_16x16x32_bf16 v[200:203], a[136:139], a[168:171], v[200:203]
    ds_read_b64_tr_b16 a[188:189], v30 offset:8704
    s_waitcnt lgkmcnt(7)
    v_mfma_f32_16x16x32_bf16 v[140:143], a[140:143], a[160:163], v[140:143]
    buffer_load_dwordx4 v19, s[32:35], s67 offen offset:0 lds
    v_mfma_f32_16x16x32_bf16 v[172:175], a[140:143], a[164:167], v[172:175]
    ds_read_b64_tr_b16 a[190:191], v31 offset:8704
    ds_read_b64_tr_b16 a[192:193], v30 offset:8712
    v_mfma_f32_16x16x32_bf16 v[204:207], a[140:143], a[168:171], v[204:207]
    ds_read_b64_tr_b16 a[194:195], v31 offset:8712
    v_mfma_f32_16x16x32_bf16 v[144:147], a[144:147], a[160:163], v[144:147]
    ds_read_b64_tr_b16 a[196:197], v30 offset:8960
    ds_read_b32 v9, v6
    v_mfma_f32_16x16x32_bf16 v[176:179], a[144:147], a[164:167], v[176:179]
    buffer_load_dwordx4 v20, s[32:35], s67 offen offset:1024 lds
    v_mfma_f32_16x16x32_bf16 v[208:211], a[144:147], a[168:171], v[208:211]
    ds_read_b64_tr_b16 a[198:199], v31 offset:8960
    ds_read_b64_tr_b16 a[200:201], v30 offset:8968
    v_mfma_f32_16x16x32_bf16 v[148:151], a[148:151], a[160:163], v[148:151]
    ds_read_b64_tr_b16 a[202:203], v31 offset:8968
    v_add_u32 v8, 1, v8
    v_mfma_f32_16x16x32_bf16 v[180:183], a[148:151], a[164:167], v[180:183]
    ds_write_b32 v7, v8
    v_mfma_f32_16x16x32_bf16 v[212:215], a[148:151], a[168:171], v[212:215]
    buffer_load_dwordx4 v21, s[32:35], s67 offen offset:2048 lds
    v_mfma_f32_16x16x32_bf16 v[152:155], a[152:155], a[160:163], v[152:155]
    v_mfma_f32_16x16x32_bf16 v[184:187], a[152:155], a[164:167], v[184:187]
    v_mfma_f32_16x16x32_bf16 v[216:219], a[152:155], a[168:171], v[216:219]
    s_waitcnt vmcnt(9) lgkmcnt(1)
    v_cmp_gt_u32 vcc, v9, v8
    v_mfma_f32_16x16x32_bf16 v[156:159], a[156:159], a[160:163], v[156:159]
    v_mfma_f32_16x16x32_bf16 v[188:191], a[156:159], a[164:167], v[188:191]
    s_cbranch_vccz L_sp244
L_sp244r:
    v_mfma_f32_16x16x32_bf16 v[220:223], a[156:159], a[168:171], v[220:223]
    v_mfma_f32_16x16x32_bf16 v[128:131], a[172:175], a[204:207], v[128:131]
    ds_read_b64_tr_b16 a[128:129], v26 offset:0
    ds_read_b64_tr_b16 a[130:131], v27 offset:0
    v_mfma_f32_16x16x32_bf16 v[160:163], a[172:175], a[208:211], v[160:163]
    ds_read_b128 a[160:163], v24 offset:0
    ds_read_b128 a[164:167], v24 offset:2048
    v_mfma_f32_16x16x32_bf16 v[192:195], a[172:175], a[212:215], v[192:195]
    ds_read_b128 a[168:171], v24 offset:4096
    ds_read_b64_tr_b16 a[132:133], v26 offset:8
    v_mfma_f32_16x16x32_bf16 v[132:135], a[176:179], a[204:207], v[132:135]
    ds_read_b64_tr_b16 a[134:135], v27 offset:8
    v_mfma_f32_16x16x32_bf16 v[164:167], a[176:179], a[208:211], v[164:167]
    ds_read_b64_tr_b16 a[136:137], v26 offset:256
    v_mfma_f32_16x16x32_bf16 v[196:199], a[176:179], a[212:215], v[196:199]
    ds_read_b64_tr_b16 a[138:139], v27 offset:256
    v_mfma_f32_16x16x32_bf16 v[136:139], a[180:183], a[204:207], v[136:139]
    ds_read_b64_tr_b16 a[140:141], v26 offset:264
    v_mfma_f32_16x16x32_bf16 v[168:171], a[180:183], a[208:211], v[168:171]
    ds_read_b64_tr_b16 a[142:143], v27 offset:264
    v_mfma_f32_16x16x32_bf16 v[200:203], a[180:183], a[212:215], v[200:203]
    ds_read_b64_tr_b16 a[144:145], v26 offset:512
    v_mfma_f32_16x16x32_bf16 v[140:143], a[184:187], a[204:207], v[140:143]
    buffer_load_dwordx4 v22, s[32:35], s67 offen offset:3072 lds
    v_mfma_f32_16x16x32_bf16 v[172:175], a[184:187], a[208:211], v[172:175]
    ds_read_b64_tr_b16 a[146:147], v27 offset:512
    ds_read_b64_tr_b16 a[148:149], v26 offset:520
    v_mfma_f32_16x16x32_bf16 v[204:207], a[184:187], a[212:215], v[204:207]
    ds_read_b64_tr_b16 a[150:151], v27 offset:520
    s_add_u32 m0, s65, 131840
    v_mfma_f32_16x16x32_bf16 v[144:147], a[188:191], a[204:207], v[144:147]
    ds_read_b64_tr_b16 a[152:153], v26 offset:768
    ds_read_b32 v9, v6
    v_mfma_f32_16x16x32_bf16 v[176:179], a[188:191], a[208:211], v[176:179]
    buffer_load_dwordx4 v19, s[32:35], s61 offen offset:0 lds
    v_mfma_f32_16x16x32_bf16 v[208:211], a[188:191], a[212:215], v[208:211]
    ds_read_b64_tr_b16 a[154:155], v27 offset:768
    ds_read_b64_tr_b16 a[156:157], v26 offset:776
    v_mfma_f32_16x16x32_bf16 v[148:151], a[192:195], a[204:207], v[148:151]
    ds_read_b64_tr_b16 a[158:159], v27 offset:776
    v_add_u32 v8, 1, v8
    v_mfma_f32_16x16x32_bf16 v[180:183], a[192:195], a[208:211], v[180:183]
    ds_write_b32 v7, v8
    v_mfma_f32_16x16x32_bf16 v[212:215], a[192:195], a[212:215], v[212:215]
    buffer_load_dwordx4 v20, s[32:35], s61 offen offset:1024 lds
    v_mfma_f32_16x16x32_bf16 v[152:155], a[196:199], a[204:207], v[152:155]
    s_add_u32 s67, s67, 128
    v_mfma_f32_16x16x32_bf16 v[184:187], a[196:199], a[208:211], v[184:187]
    s_cmp_eq_u32 s67, 1024
    s_cselect_b32 s67, 128, s67
    v_mfma_f32_16x16x32_bf16 v[216:219], a[196:199], a[212:215], v[216:219]
    s_waitcnt lgkmcnt(1)
    v_cmp_gt_u32 vcc, v9, v8
    v_mfma_f32_16x16x32_bf16 v[156:159], a[200:203], a[204:207], v[156:159]
    v_mfma_f32_16x16x32_bf16 v[188:191], a[200:203], a[208:211], v[188:191]
    s_cbranch_vccz L_sp245
L_sp245r:
    v_mfma_f32_16x16x32_bf16 v[220:223], a[200:203], a[212:215], v[220:223]
    v_mfma_f32_16x16x32_bf16 v[128:131], a[128:131], a[160:163], v[128:131]
    ds_read_b64_tr_b16 a[172:173], v26 offset:8192
    ds_read_b64_tr_b16 a[174:175], v27 offset:8192
    v_mfma_f32_16x16x32_bf16 v[160:163], a[128:131], a[164:167], v[160:163]
    ds_read_b128 a[204:207], v25 offset:0
    ds_read_b128 a[208:211], v25 offset:2048
    v_mfma_f32_16x16x32_bf16 v[192:195], a[128:131], a[168:171], v[192:195]
    ds_read_b128 a[212:215], v25 offset:4096
    ds_read_b64_tr_b16 a[176:177], v26 offset:8200
    v_mfma_f32_16x16x32_bf16 v[132:135], a[132:135], a[160:163], v[132:135]
    ds_read_b64_tr_b16 a[178:179], v27 offset:8200
    v_mfma_f32_16x16x32_bf16 v[164:167], a[132:135], a[164:167], v[164:167]
    ds_read_b64_tr_b16 a[180:181], v26 offset:8448
    v_mfma_f32_16x16x32_bf16 v[196:199], a[132:135], a[168:171], v[196:199]
    ds_read_b64_tr_b16 a[182:183], v27 offset:8448
    v_mfma_f32_16x16x32_bf16 v[136:139], a[136:139], a[160:163], v[136:139]
    ds_read_b64_tr_b16 a[184:185], v26 offset:8456
    v_mfma_f32_16x16x32_bf16 v[168:171], a[136:139], a[164:167], v[168:171]
    ds_read_b64_tr_b16 a[186:187], v27 offset:8456
    v_mfma_f32_16x16x32_bf16 v[200:203], a[136:139], a[168:171], v[200:203]
    ds_read_b64_tr_b16 a[188:189], v26 offset:8704
    v_mfma_f32_16x16x32_bf16 v[140:143], a[140:143], a[160:163], v[140:143]
    v_mfma_f32_16x16x32_bf16 v[172:175], a[140:143], a[164:167], v[172:175]
    ds_read_b64_tr_b16 a[190:191], v27 offset:8704
    ds_read_b64_tr_b16 a[192:193], v26 offset:8712
    v_mfma_f32_16x16x32_bf16 v[204:207], a[140:143], a[168:171], v[204:207]
    ds_read_b64_tr_b16 a[194:195], v27 offset:8712
    v_mfma_f32_16x16x32_bf16 v[144:147], a[144:147], a[160:163], v[144:147]
    ds_read_b64_tr_b16 a[196:197], v26 offset:8960
    ds_read_b32 v9, v6
    v_mfma_f32_16x16x32_bf16 v[176:179], a[144:147], a[164:167], v[176:179]
    v_mfma_f32_16x16x32_bf16 v[208:211], a[144:147], a[168:171], v[208:211]
    ds_read_b64_tr_b16 a[198:199], v27 offset:8960
    ds_read_b64_tr_b16 a[200:201], v26 offset:8968
    v_mfma_f32_16x16x32_bf16 v[148:151], a[148:151], a[160:163], v[148:151]
    ds_read_b64_tr_b16 a[202:203], v27 offset:8968
    v_add_u32 v8, 1, v8
    v_mfma_f32_16x16x32_bf16 v[180:183], a[148:151], a[164:167], v[180:183]
    ds_write_b32 v7, v8
    v_mfma_f32_16x16x32_bf16 v[212:215], a[148:151], a[168:171], v[212:215]
    v_mfma_f32_16x16x32_bf16 v[152:155], a[152:155], a[160:163], v[152:155]
    v_mfma_f32_16x16x32_bf16 v[184:187], a[152:155], a[164:167], v[184:187]
    v_mfma_f32_16x16x32_bf16 v[216:219], a[152:155], a[168:171], v[216:219]
    s_waitcnt vmcnt(6) lgkmcnt(1)
    v_cmp_gt_u32 vcc, v9, v8
    v_mfma_f32_16x16x32_bf16 v[156:159], a[156:159], a[160:163], v[156:159]
    v_mfma_f32_16x16x32_bf16 v[188:191], a[156:159], a[164:167], v[188:191]
    s_cbranch_vccz L_sp246
L_sp246r:
    v_mfma_f32_16x16x32_bf16 v[220:223], a[156:159], a[168:171], v[220:223]
    v_mfma_f32_16x16x32_bf16 v[128:131], a[172:175], a[204:207], v[128:131]
    ds_read_b64_tr_b16 a[128:129], v26 offset:34816
    ds_read_b64_tr_b16 a[130:131], v27 offset:34816
    v_mfma_f32_16x16x32_bf16 v[160:163], a[172:175], a[208:211], v[160:163]
    ds_read_b128 a[160:163], v24 offset:34816
    ds_read_b128 a[164:167], v24 offset:36864
    v_mfma_f32_16x16x32_bf16 v[192:195], a[172:175], a[212:215], v[192:195]
    ds_read_b128 a[168:171], v24 offset:38912
    ds_read_b64_tr_b16 a[132:133], v26 offset:34824
    v_mfma_f32_16x16x32_bf16 v[132:135], a[176:179], a[204:207], v[132:135]
    ds_read_b64_tr_b16 a[134:135], v27 offset:34824
    v_mfma_f32_16x16x32_bf16 v[164:167], a[176:179], a[208:211], v[164:167]
    ds_read_b64_tr_b16 a[136:137], v26 offset:35072
    v_mfma_f32_16x16x32_bf16 v[196:199], a[176:179], a[212:215], v[196:199]
    ds_read_b64_tr_b16 a[138:139], v27 offset:35072
    v_mfma_f32_16x16x32_bf16 v[136:139], a[180:183], a[204:207], v[136:139]
    ds_read_b64_tr_b16 a[140:141], v26 offset:35080
    v_mfma_f32_16x16x32_bf16 v[168:171], a[180:183], a[208:211], v[168:171]
    ds_read_b64_tr_b16 a[142:143], v27 offset:35080
    v_mfma_f32_16x16x32_bf16 v[200:203], a[180:183], a[212:215], v[200:203]
    ds_read_b64_tr_b16 a[144:145], v26 offset:35328
    v_mfma_f32_16x16x32_bf16 v[140:143], a[184:187], a[204:207], v[140:143]
    v_mfma_f32_16x16x32_bf16 v[172:175], a[184:187], a[208:211], v[172:175]
    ds_read_b64_tr_b16 a[146:147], v27 offset:35328
    ds_read_b64_tr_b16 a[148:149], v26 offset:35336
    v_mfma_f32_16x16x32_bf16 v[204:207], a[184:187], a[212:215], v[204:207]
    ds_read_b64_tr_b16 a[150:151], v27 offset:35336
    v_mfma_f32_16x16x32_bf16 v[144:147], a[188:191], a[204:207], v[144:147]
    ds_read_b64_tr_b16 a[152:153], v26 offset:35584
    ds_read_b32 v9, v6
    v_mfma_f32_16x16x32_bf16 v[176:179], a[188:191], a[208:211], v[176:179]
    v_mfma_f32_16x16x32_bf16 v[208:211], a[188:191], a[212:215], v[208:211]
    ds_read_b64_tr_b16 a[154:155], v27 offset:35584
    ds_read_b64_tr_b16 a[156:157], v26 offset:35592
    v_mfma_f32_16x16x32_bf16 v[148:151], a[192:195], a[204:207], v[148:151]
    ds_read_b64_tr_b16 a[158:159], v27 offset:35592
    v_add_u32 v8, 1, v8
    v_mfma_f32_16x16x32_bf16 v[180:183], a[192:195], a[208:211], v[180:183]
    ds_write_b32 v7, v8
    v_mfma_f32_16x16x32_bf16 v[212:215], a[192:195], a[212:215], v[212:215]
    v_mfma_f32_16x16x32_bf16 v[152:155], a[196:199], a[204:207], v[152:155]
    v_mfma_f32_16x16x32_bf16 v[184:187], a[196:199], a[208:211], v[184:187]
    v_mfma_f32_16x16x32_bf16 v[216:219], a[196:199], a[212:215], v[216:219]
    s_waitcnt lgkmcnt(1)
    v_cmp_gt_u32 vcc, v9, v8
    v_mfma_f32_16x16x32_bf16 v[156:159], a[200:203], a[204:207], v[156:159]
    v_mfma_f32_16x16x32_bf16 v[188:191], a[200:203], a[208:211], v[188:191]
    s_cbranch_vccz L_sp247
L_sp247r:
    v_mfma_f32_16x16x32_bf16 v[220:223], a[200:203], a[212:215], v[220:223]
    v_mfma_f32_16x16x32_bf16 v[128:131], a[128:131], a[160:163], v[128:131]
    ds_read_b64_tr_b16 a[172:173], v26 offset:43008
    ds_read_b64_tr_b16 a[174:175], v27 offset:43008
    v_mfma_f32_16x16x32_bf16 v[160:163], a[128:131], a[164:167], v[160:163]
    ds_read_b128 a[204:207], v25 offset:34816
    ds_read_b128 a[208:211], v25 offset:36864
    v_mfma_f32_16x16x32_bf16 v[192:195], a[128:131], a[168:171], v[192:195]
    ds_read_b128 a[212:215], v25 offset:38912
    ds_read_b64_tr_b16 a[176:177], v26 offset:43016
    v_mfma_f32_16x16x32_bf16 v[132:135], a[132:135], a[160:163], v[132:135]
    ds_read_b64_tr_b16 a[178:179], v27 offset:43016
    v_mfma_f32_16x16x32_bf16 v[164:167], a[132:135], a[164:167], v[164:167]
    ds_read_b64_tr_b16 a[180:181], v26 offset:43264
    v_mfma_f32_16x16x32_bf16 v[196:199], a[132:135], a[168:171], v[196:199]
    ds_read_b64_tr_b16 a[182:183], v27 offset:43264
    v_mfma_f32_16x16x32_bf16 v[136:139], a[136:139], a[160:163], v[136:139]
    ds_read_b64_tr_b16 a[184:185], v26 offset:43272
    v_mfma_f32_16x16x32_bf16 v[168:171], a[136:139], a[164:167], v[168:171]
    ds_read_b64_tr_b16 a[186:187], v27 offset:43272
    v_mfma_f32_16x16x32_bf16 v[200:203], a[136:139], a[168:171], v[200:203]
    ds_read_b64_tr_b16 a[188:189], v26 offset:43520
    v_mfma_f32_16x16x32_bf16 v[140:143], a[140:143], a[160:163], v[140:143]
    v_mfma_f32_16x16x32_bf16 v[172:175], a[140:143], a[164:167], v[172:175]
    ds_read_b64_tr_b16 a[190:191], v27 offset:43520
    ds_read_b64_tr_b16 a[192:193], v26 offset:43528
    v_mfma_f32_16x16x32_bf16 v[204:207], a[140:143], a[168:171], v[204:207]
    ds_read_b64_tr_b16 a[194:195], v27 offset:43528
    v_mfma_f32_16x16x32_bf16 v[144:147], a[144:147], a[160:163], v[144:147]
    ds_read_b64_tr_b16 a[196:197], v26 offset:43776
    ds_read_b32 v9, v6
    v_mfma_f32_16x16x32_bf16 v[176:179], a[144:147], a[164:167], v[176:179]
    v_mfma_f32_16x16x32_bf16 v[208:211], a[144:147], a[168:171], v[208:211]
    ds_read_b64_tr_b16 a[198:199], v27 offset:43776
    ds_read_b64_tr_b16 a[200:201], v26 offset:43784
    v_mfma_f32_16x16x32_bf16 v[148:151], a[148:151], a[160:163], v[148:151]
    ds_read_b64_tr_b16 a[202:203], v27 offset:43784
    v_add_u32 v8, 1, v8
    v_mfma_f32_16x16x32_bf16 v[180:183], a[148:151], a[164:167], v[180:183]
    ds_write_b32 v7, v8
    v_mfma_f32_16x16x32_bf16 v[212:215], a[148:151], a[168:171], v[212:215]
    v_mfma_f32_16x16x32_bf16 v[152:155], a[152:155], a[160:163], v[152:155]
    v_mfma_f32_16x16x32_bf16 v[184:187], a[152:155], a[164:167], v[184:187]
    v_mfma_f32_16x16x32_bf16 v[216:219], a[152:155], a[168:171], v[216:219]
    s_waitcnt vmcnt(0) lgkmcnt(1)
    v_cmp_gt_u32 vcc, v9, v8
    v_mfma_f32_16x16x32_bf16 v[156:159], a[156:159], a[160:163], v[156:159]
    v_mfma_f32_16x16x32_bf16 v[188:191], a[156:159], a[164:167], v[188:191]
    s_cbranch_vccz L_sp248
L_sp248r:
    v_mfma_f32_16x16x32_bf16 v[220:223], a[156:159], a[168:171], v[220:223]
    v_mfma_f32_16x16x32_bf16 v[128:131], a[172:175], a[204:207], v[128:131]
    ds_read_b64_tr_b16 a[128:129], v30 offset:0
    ds_read_b64_tr_b16 a[130:131], v31 offset:0
    v_mfma_f32_16x16x32_bf16 v[160:163], a[172:175], a[208:211], v[160:163]
    ds_read_b128 a[160:163], v28 offset:0
    ds_read_b128 a[164:167], v28 offset:2048
    v_mfma_f32_16x16x32_bf16 v[192:195], a[172:175], a[212:215], v[192:195]
    ds_read_b128 a[168:171], v28 offset:4096
    ds_read_b64_tr_b16 a[132:133], v30 offset:8
    v_mfma_f32_16x16x32_bf16 v[132:135], a[176:179], a[204:207], v[132:135]
    ds_read_b64_tr_b16 a[134:135], v31 offset:8
    v_mfma_f32_16x16x32_bf16 v[164:167], a[176:179], a[208:211], v[164:167]
    ds_read_b64_tr_b16 a[136:137], v30 offset:256
    v_mfma_f32_16x16x32_bf16 v[196:199], a[176:179], a[212:215], v[196:199]
    ds_read_b64_tr_b16 a[138:139], v31 offset:256
    v_mfma_f32_16x16x32_bf16 v[136:139], a[180:183], a[204:207], v[136:139]
    ds_read_b64_tr_b16 a[140:141], v30 offset:264
    v_mfma_f32_16x16x32_bf16 v[168:171], a[180:183], a[208:211], v[168:171]
    ds_read_b64_tr_b16 a[142:143], v31 offset:264
    v_mfma_f32_16x16x32_bf16 v[200:203], a[180:183], a[212:215], v[200:203]
    ds_read_b64_tr_b16 a[144:145], v30 offset:512
    v_mfma_f32_16x16x32_bf16 v[140:143], a[184:187], a[204:207], v[140:143]
    v_mfma_f32_16x16x32_bf16 v[172:175], a[184:187], a[208:211], v[172:175]
    ds_read_b64_tr_b16 a[146:147], v31 offset:512
    ds_read_b64_tr_b16 a[148:149], v30 offset:520
    v_mfma_f32_16x16x32_bf16 v[204:207], a[184:187], a[212:215], v[204:207]
    ds_read_b64_tr_b16 a[150:151], v31 offset:520
    v_mfma_f32_16x16x32_bf16 v[144:147], a[188:191], a[204:207], v[144:147]
    ds_read_b64_tr_b16 a[152:153], v30 offset:768
    ds_read_b32 v9, v6
    v_mfma_f32_16x16x32_bf16 v[176:179], a[188:191], a[208:211], v[176:179]
    v_mfma_f32_16x16x32_bf16 v[208:211], a[188:191], a[212:215], v[208:211]
    ds_read_b64_tr_b16 a[154:155], v31 offset:768
    ds_read_b64_tr_b16 a[156:157], v30 offset:776
    v_mfma_f32_16x16x32_bf16 v[148:151], a[192:195], a[204:207], v[148:151]
    ds_read_b64_tr_b16 a[158:159], v31 offset:776
    v_add_u32 v8, 1, v8
    v_mfma_f32_16x16x32_bf16 v[180:183], a[192:195], a[208:211], v[180:183]
    ds_write_b32 v7, v8
    v_mfma_f32_16x16x32_bf16 v[212:215], a[192:195], a[212:215], v[212:215]
    v_mfma_f32_16x16x32_bf16 v[152:155], a[196:199], a[204:207], v[152:155]
    v_mfma_f32_16x16x32_bf16 v[184:187], a[196:199], a[208:211], v[184:187]
    v_mfma_f32_16x16x32_bf16 v[216:219], a[196:199], a[212:215], v[216:219]
    s_waitcnt lgkmcnt(1)
    v_cmp_gt_u32 vcc, v9, v8
    v_mfma_f32_16x16x32_bf16 v[156:159], a[200:203], a[204:207], v[156:159]
    v_mfma_f32_16x16x32_bf16 v[188:191], a[200:203], a[208:211], v[188:191]
    s_cbranch_vccz L_sp249
L_sp249r:
    v_mfma_f32_16x16x32_bf16 v[220:223], a[200:203], a[212:215], v[220:223]
    v_mfma_f32_16x16x32_bf16 v[128:131], a[128:131], a[160:163], v[128:131]
    ds_read_b64_tr_b16 a[172:173], v30 offset:8192
    ds_read_b64_tr_b16 a[174:175], v31 offset:8192
    v_mfma_f32_16x16x32_bf16 v[160:163], a[128:131], a[164:167], v[160:163]
    ds_read_b128 a[204:207], v29 offset:0
    ds_read_b128 a[208:211], v29 offset:2048
    v_mfma_f32_16x16x32_bf16 v[192:195], a[128:131], a[168:171], v[192:195]
    ds_read_b128 a[212:215], v29 offset:4096
    ds_read_b64_tr_b16 a[176:177], v30 offset:8200
    v_mfma_f32_16x16x32_bf16 v[132:135], a[132:135], a[160:163], v[132:135]
    ds_read_b64_tr_b16 a[178:179], v31 offset:8200
    v_mfma_f32_16x16x32_bf16 v[164:167], a[132:135], a[164:167], v[164:167]
    ds_read_b64_tr_b16 a[180:181], v30 offset:8448
    v_mfma_f32_16x16x32_bf16 v[196:199], a[132:135], a[168:171], v[196:199]
    ds_read_b64_tr_b16 a[182:183], v31 offset:8448
    v_mfma_f32_16x16x32_bf16 v[136:139], a[136:139], a[160:163], v[136:139]
    ds_read_b64_tr_b16 a[184:185], v30 offset:8456
    v_mfma_f32_16x16x32_bf16 v[168:171], a[136:139], a[164:167], v[168:171]
    ds_read_b64_tr_b16 a[186:187], v31 offset:8456
    v_mfma_f32_16x16x32_bf16 v[200:203], a[136:139], a[168:171], v[200:203]
    ds_read_b64_tr_b16 a[188:189], v30 offset:8704
    v_mfma_f32_16x16x32_bf16 v[140:143], a[140:143], a[160:163], v[140:143]
    v_mfma_f32_16x16x32_bf16 v[172:175], a[140:143], a[164:167], v[172:175]
    ds_read_b64_tr_b16 a[190:191], v31 offset:8704
    ds_read_b64_tr_b16 a[192:193], v30 offset:8712
    v_mfma_f32_16x16x32_bf16 v[204:207], a[140:143], a[168:171], v[204:207]
    ds_read_b64_tr_b16 a[194:195], v31 offset:8712
    v_mfma_f32_16x16x32_bf16 v[144:147], a[144:147], a[160:163], v[144:147]
    ds_read_b64_tr_b16 a[196:197], v30 offset:8960
    ds_read_b32 v9, v6
    v_mfma_f32_16x16x32_bf16 v[176:179], a[144:147], a[164:167], v[176:179]
    v_mfma_f32_16x16x32_bf16 v[208:211], a[144:147], a[168:171], v[208:211]
    ds_read_b64_tr_b16 a[198:199], v31 offset:8960
    ds_read_b64_tr_b16 a[200:201], v30 offset:8968
    v_mfma_f32_16x16x32_bf16 v[148:151], a[148:151], a[160:163], v[148:151]
    ds_read_b64_tr_b16 a[202:203], v31 offset:8968
    v_add_u32 v8, 1, v8
    v_mfma_f32_16x16x32_bf16 v[180:183], a[148:151], a[164:167], v[180:183]
    ds_write_b32 v7, v8
    v_mfma_f32_16x16x32_bf16 v[212:215], a[148:151], a[168:171], v[212:215]
    v_mfma_f32_16x16x32_bf16 v[152:155], a[152:155], a[160:163], v[152:155]
    v_mfma_f32_16x16x32_bf16 v[184:187], a[152:155], a[164:167], v[184:187]
    v_mfma_f32_16x16x32_bf16 v[216:219], a[152:155], a[168:171], v[216:219]
    s_waitcnt lgkmcnt(1)
    v_cmp_gt_u32 vcc, v9, v8
    v_mfma_f32_16x16x32_bf16 v[156:159], a[156:159], a[160:163], v[156:159]
    v_mfma_f32_16x16x32_bf16 v[188:191], a[156:159], a[164:167], v[188:191]
    s_cbranch_vccz L_sp250
L_sp250r:
    v_mfma_f32_16x16x32_bf16 v[220:223], a[156:159], a[168:171], v[220:223]
    v_mfma_f32_16x16x32_bf16 v[128:131], a[172:175], a[204:207], v[128:131]
    ds_read_b128 a[0:3], v10 offset:0
    ds_read_b128 a[4:7], v10 offset:256
    v_mfma_f32_16x16x32_bf16 v[160:163], a[172:175], a[208:211], v[160:163]
    ds_read_b128 a[8:11], v10 offset:512
    ds_read_b128 a[12:15], v10 offset:768
    v_mfma_f32_16x16x32_bf16 v[192:195], a[172:175], a[212:215], v[192:195]
    ds_read_b128 a[16:19], v10 offset:4096
    ds_read_b128 a[20:23], v10 offset:4352
    v_mfma_f32_16x16x32_bf16 v[132:135], a[176:179], a[204:207], v[132:135]
    ds_read_b128 a[24:27], v10 offset:4608
    ds_read_b128 a[28:31], v10 offset:4864
    v_mfma_f32_16x16x32_bf16 v[164:167], a[176:179], a[208:211], v[164:167]
    v_add_u32 v8, 1, v8
    ds_write_b32 v7, v8
    v_mfma_f32_16x16x32_bf16 v[196:199], a[176:179], a[212:215], v[196:199]
    s_add_u32 s66, s66, 16384
    s_cmp_eq_u32 s66, s100
    v_mfma_f32_16x16x32_bf16 v[136:139], a[180:183], a[204:207], v[136:139]
    s_cselect_b32 s66, 0, s66
    v_add_u32 v10, s66, v13
    v_mfma_f32_16x16x32_bf16 v[168:171], a[180:183], a[208:211], v[168:171]
    v_add_u32 v11, s66, v14
    v_add_u32 v12, s66, v15
    v_mfma_f32_16x16x32_bf16 v[200:203], a[180:183], a[212:215], v[200:203]
    ds_read_b32 v9, v6
    v_mfma_f32_16x16x32_bf16 v[140:143], a[184:187], a[204:207], v[140:143]
    v_mfma_f32_16x16x32_bf16 v[172:175], a[184:187], a[208:211], v[172:175]
    v_mfma_f32_16x16x32_bf16 v[204:207], a[184:187], a[212:215], v[204:207]
    v_mfma_f32_16x16x32_bf16 v[144:147], a[188:191], a[204:207], v[144:147]
    v_mfma_f32_16x16x32_bf16 v[176:179], a[188:191], a[208:211], v[176:179]
    v_mfma_f32_16x16x32_bf16 v[208:211], a[188:191], a[212:215], v[208:211]
    v_mfma_f32_16x16x32_bf16 v[148:151], a[192:195], a[204:207], v[148:151]
    v_mfma_f32_16x16x32_bf16 v[180:183], a[192:195], a[208:211], v[180:183]
    v_mfma_f32_16x16x32_bf16 v[212:215], a[192:195], a[212:215], v[212:215]
    v_mfma_f32_16x16x32_bf16 v[152:155], a[196:199], a[204:207], v[152:155]
    v_mfma_f32_16x16x32_bf16 v[184:187], a[196:199], a[208:211], v[184:187]
    v_mfma_f32_16x16x32_bf16 v[216:219], a[196:199], a[212:215], v[216:219]
    v_mfma_f32_16x16x32_bf16 v[156:159], a[200:203], a[204:207], v[156:159]
    v_mfma_f32_16x16x32_bf16 v[188:191], a[200:203], a[208:211], v[188:191]
    v_mfma_f32_16x16x32_bf16 v[220:223], a[200:203], a[212:215], v[220:223]
    v_pk_mul_f32 v[128:129], v[128:129], v[62:63]
    v_pk_mul_f32 v[130:131], v[130:131], v[62:63]
    v_pk_mul_f32 v[132:133], v[132:133], v[62:63]
    v_pk_mul_f32 v[134:135], v[134:135], v[62:63]
    v_cvt_pk_bf16_f32 v80, v128, v129
    v_cvt_pk_bf16_f32 v81, v130, v131
    v_cvt_pk_bf16_f32 v82, v132, v133
    v_cvt_pk_bf16_f32 v83, v134, v135
    v_pk_mul_f32 v[160:161], v[160:161], v[62:63]
    v_pk_mul_f32 v[162:163], v[162:163], v[62:63]
    v_pk_mul_f32 v[164:165], v[164:165], v[62:63]
    v_pk_mul_f32 v[166:167], v[166:167], v[62:63]
    v_cvt_pk_bf16_f32 v96, v160, v161
    v_cvt_pk_bf16_f32 v97, v162, v163
    v_cvt_pk_bf16_f32 v98, v164, v165
    v_cvt_pk_bf16_f32 v99, v166, v167
    v_pk_mul_f32 v[192:193], v[192:193], v[62:63]
    v_pk_mul_f32 v[194:195], v[194:195], v[62:63]
    v_pk_mul_f32 v[196:197], v[196:197], v[62:63]
    v_pk_mul_f32 v[198:199], v[198:199], v[62:63]
    v_cvt_pk_bf16_f32 v112, v192, v193
    v_cvt_pk_bf16_f32 v113, v194, v195
    v_cvt_pk_bf16_f32 v114, v196, v197
    v_cvt_pk_bf16_f32 v115, v198, v199
    v_pk_mul_f32 v[136:137], v[136:137], v[62:63]
    v_pk_mul_f32 v[138:139], v[138:139], v[62:63]
    v_pk_mul_f32 v[140:141], v[140:141], v[62:63]
    v_pk_mul_f32 v[142:143], v[142:143], v[62:63]
    v_cvt_pk_bf16_f32 v84, v136, v137
    v_cvt_pk_bf16_f32 v85, v138, v139
    v_cvt_pk_bf16_f32 v86, v140, v141
    v_cvt_pk_bf16_f32 v87, v142, v143
    v_pk_mul_f32 v[168:169], v[168:169], v[62:63]
    v_pk_mul_f32 v[170:171], v[170:171], v[62:63]
    v_pk_mul_f32 v[172:173], v[172:173], v[62:63]
    v_pk_mul_f32 v[174:175], v[174:175], v[62:63]
    v_cvt_pk_bf16_f32 v100, v168, v169
    v_cvt_pk_bf16_f32 v101, v170, v171
    v_cvt_pk_bf16_f32 v102, v172, v173
    v_cvt_pk_bf16_f32 v103, v174, v175
    v_pk_mul_f32 v[200:201], v[200:201], v[62:63]
    v_pk_mul_f32 v[202:203], v[202:203], v[62:63]
    v_pk_mul_f32 v[204:205], v[204:205], v[62:63]
    v_pk_mul_f32 v[206:207], v[206:207], v[62:63]
    v_cvt_pk_bf16_f32 v116, v200, v201
    v_cvt_pk_bf16_f32 v117, v202, v203
    v_cvt_pk_bf16_f32 v118, v204, v205
    v_cvt_pk_bf16_f32 v119, v206, v207
    v_pk_mul_f32 v[144:145], v[144:145], v[62:63]
    v_pk_mul_f32 v[146:147], v[146:147], v[62:63]
    v_pk_mul_f32 v[148:149], v[148:149], v[62:63]
    v_pk_mul_f32 v[150:151], v[150:151], v[62:63]
    v_cvt_pk_bf16_f32 v88, v144, v145
    v_cvt_pk_bf16_f32 v89, v146, v147
    v_cvt_pk_bf16_f32 v90, v148, v149
    v_cvt_pk_bf16_f32 v91, v150, v151
    v_pk_mul_f32 v[176:177], v[176:177], v[62:63]
    v_pk_mul_f32 v[178:179], v[178:179], v[62:63]
    v_pk_mul_f32 v[180:181], v[180:181], v[62:63]
    v_pk_mul_f32 v[182:183], v[182:183], v[62:63]
    v_cvt_pk_bf16_f32 v104, v176, v177
    v_cvt_pk_bf16_f32 v105, v178, v179
    v_cvt_pk_bf16_f32 v106, v180, v181
    v_cvt_pk_bf16_f32 v107, v182, v183
    v_pk_mul_f32 v[208:209], v[208:209], v[62:63]
    v_pk_mul_f32 v[210:211], v[210:211], v[62:63]
    v_pk_mul_f32 v[212:213], v[212:213], v[62:63]
    v_pk_mul_f32 v[214:215], v[214:215], v[62:63]
    v_cvt_pk_bf16_f32 v120, v208, v209
    v_cvt_pk_bf16_f32 v121, v210, v211
    v_cvt_pk_bf16_f32 v122, v212, v213
    v_cvt_pk_bf16_f32 v123, v214, v215
    v_pk_mul_f32 v[152:153], v[152:153], v[62:63]
    v_pk_mul_f32 v[154:155], v[154:155], v[62:63]
    v_pk_mul_f32 v[156:157], v[156:157], v[62:63]
    v_pk_mul_f32 v[158:159], v[158:159], v[62:63]
    v_cvt_pk_bf16_f32 v92, v152, v153
    v_cvt_pk_bf16_f32 v93, v154, v155
    v_cvt_pk_bf16_f32 v94, v156, v157
    v_cvt_pk_bf16_f32 v95, v158, v159
    v_pk_mul_f32 v[184:185], v[184:185], v[62:63]
    v_pk_mul_f32 v[186:187], v[186:187], v[62:63]
    v_pk_mul_f32 v[188:189], v[188:189], v[62:63]
    v_pk_mul_f32 v[190:191], v[190:191], v[62:63]
    v_cvt_pk_bf16_f32 v108, v184, v185
    v_cvt_pk_bf16_f32 v109, v186, v187
    v_cvt_pk_bf16_f32 v110, v188, v189
    v_cvt_pk_bf16_f32 v111, v190, v191
    v_pk_mul_f32 v[216:217], v[216:217], v[62:63]
    v_pk_mul_f32 v[218:219], v[218:219], v[62:63]
    v_pk_mul_f32 v[220:221], v[220:221], v[62:63]
    v_pk_mul_f32 v[222:223], v[222:223], v[62:63]
    v_cvt_pk_bf16_f32 v124, v216, v217
    v_cvt_pk_bf16_f32 v125, v218, v219
    v_cvt_pk_bf16_f32 v126, v220, v221
    v_cvt_pk_bf16_f32 v127, v222, v223
    s_waitcnt lgkmcnt(0)
    v_cmp_gt_u32 vcc, v9, v8
    s_cbranch_vccz L_sp251
L_sp251r:
L_item:
    v_mfma_f32_16x16x32_bf16 v[16:19], a[0:3], v[80:83], 0
    ds_read_b128 a[32:35], v10 offset:0
    v_mfma_f32_16x16x32_bf16 v[16:19], a[4:7], v[84:87], v[16:19]
    ds_read_b128 a[36:39], v10 offset:256
    v_mfma_f32_16x16x32_bf16 v[16:19], a[8:11], v[88:91], v[16:19]
    ds_read_b128 a[40:43], v10 offset:512
    v_mfma_f32_16x16x32_bf16 v[16:19], a[12:15], v[92:95], v[16:19]
    ds_read_b128 a[44:47], v10 offset:768
    v_mfma_f32_16x16x32_bf16 v[20:23], a[16:19], v[80:83], 0
    ds_read_b128 a[48:51], v10 offset:4096
    v_mfma_f32_16x16x32_bf16 v[20:23], a[20:23], v[84:87], v[20:23]
    ds_read_b128 a[52:55], v10 offset:4352
    v_mfma_f32_16x16x32_bf16 v[20:23], a[24:27], v[88:91], v[20:23]
    ds_read_b128 a[56:59], v10 offset:4608
    v_mfma_f32_16x16x32_bf16 v[20:23], a[28:31], v[92:95], v[20:23]
    ds_read_b128 a[60:63], v10 offset:4864
    v_mfma_f32_16x16x32_bf16 v[24:27], a[0:3], v[96:99], 0
    ds_read_b64_tr_b16 a[96:97], v11 offset:0
    v_mfma_f32_16x16x32_bf16 v[24:27], a[4:7], v[100:103], v[24:27]
    ds_read_b64_tr_b16 a[98:99], v11 offset:4096
    v_mfma_f32_16x16x32_bf16 v[24:27], a[8:11], v[104:107], v[24:27]
    ds_read_b64_tr_b16 a[100:101], v12 offset:0
    v_mfma_f32_16x16x32_bf16 v[24:27], a[12:15], v[108:111], v[24:27]
    ds_read_b64_tr_b16 a[102:103], v12 offset:4096
    v_mfma_f32_16x16x32_bf16 v[28:31], a[16:19], v[96:99], 0
    ds_read_b64_tr_b16 a[104:105], v11 offset:256
    v_mfma_f32_16x16x32_bf16 v[28:31], a[20:23], v[100:103], v[28:31]
    ds_read_b64_tr_b16 a[106:107], v11 offset:4352
    v_mfma_f32_16x16x32_bf16 v[28:31], a[24:27], v[104:107], v[28:31]
    ds_read_b64_tr_b16 a[108:109], v12 offset:256
    v_mfma_f32_16x16x32_bf16 v[28:31], a[28:31], v[108:111], v[28:31]
    ds_read_b64_tr_b16 a[110:111], v12 offset:4352
    v_mfma_f32_16x16x32_bf16 v[32:35], a[0:3], v[112:115], 0
    ds_read_b64_tr_b16 a[112:113], v11 offset:512
    v_mfma_f32_16x16x32_bf16 v[32:35], a[4:7], v[116:119], v[32:35]
    ds_read_b64_tr_b16 a[114:115], v11 offset:4608
    v_mfma_f32_16x16x32_bf16 v[32:35], a[8:11], v[120:123], v[32:35]
    ds_read_b64_tr_b16 a[116:117], v12 offset:512
    v_mfma_f32_16x16x32_bf16 v[32:35], a[12:15], v[124:127], v[32:35]
    ds_read_b64_tr_b16 a[118:119], v12 offset:4608
    v_mfma_f32_16x16x32_bf16 v[36:39], a[16:19], v[112:115], 0
    ds_read_b64_tr_b16 a[120:121], v11 offset:768
    v_mfma_f32_16x16x32_bf16 v[36:39], a[20:23], v[116:119], v[36:39]
    ds_read_b64_tr_b16 a[122:123], v11 offset:4864
    v_mfma_f32_16x16x32_bf16 v[36:39], a[24:27], v[120:123], v[36:39]
    ds_read_b64_tr_b16 a[124:125], v12 offset:768
    v_mfma_f32_16x16x32_bf16 v[36:39], a[28:31], v[124:127], v[36:39]
    ds_read_b64_tr_b16 a[126:127], v12 offset:4864
    v_add_u32 v8, 1, v8
    ds_write_b32 v7, v8
    s_add_u32 s66, s66, 16384
    s_cmp_eq_u32 s66, s100
    s_cselect_b32 s66, 0, s66
    v_add_u32 v10, s66, v13
    v_add_u32 v11, s66, v14
    v_add_u32 v12, s66, v15
    v_max3_f32 v59, v16, v17, v56
    v_max3_f32 v59, v18, v19, v59
    v_max3_f32 v59, v20, v21, v59
    v_max3_f32 v59, v22, v23, v59
    v_mov_b32 v62, v59
    s_nop 1
    v_permlane16_swap_b32 v59, v62
    v_max_f32 v59, v59, v62
    v_mov_b32 v62, v59
    s_nop 1
    v_permlane32_swap_b32 v59, v62
    v_max_f32 v59, v59, v62
    v_sub_f32 v40, 0, v59
    v_sub_f32 v41, 0, v59
    v_sub_f32 v42, 0, v59
    v_sub_f32 v43, 0, v59
    v_sub_f32 v16, v16, v59
    v_sub_f32 v17, v17, v59
    v_sub_f32 v18, v18, v59
    v_sub_f32 v19, v19, v59
    v_sub_f32 v20, v20, v59
    v_sub_f32 v21, v21, v59
    v_sub_f32 v22, v22, v59
    v_sub_f32 v23, v23, v59
    v_max3_f32 v60, v24, v25, v57
    v_max3_f32 v60, v26, v27, v60
    v_max3_f32 v60, v28, v29, v60
    v_max3_f32 v60, v30, v31, v60
    v_mov_b32 v62, v60
    s_nop 1
    v_permlane16_swap_b32 v60, v62
    v_max_f32 v60, v60, v62
    v_mov_b32 v62, v60
    s_nop 1
    v_permlane32_swap_b32 v60, v62
    v_max_f32 v60, v60, v62
    v_sub_f32 v44, 0, v60
    v_sub_f32 v45, 0, v60
    v_sub_f32 v46, 0, v60
    v_sub_f32 v47, 0, v60
    v_sub_f32 v24, v24, v60
    v_sub_f32 v25, v25, v60
    v_sub_f32 v26, v26, v60
    v_sub_f32 v27, v27, v60
    v_sub_f32 v28, v28, v60
    v_sub_f32 v29, v29, v60
    v_sub_f32 v30, v30, v60
    v_sub_f32 v31, v31, v60
    v_max3_f32 v61, v32, v33, v58
    v_max3_f32 v61, v34, v35, v61
    v_max3_f32 v61, v36, v37, v61
    v_max3_f32 v61, v38, v39, v61
    v_mov_b32 v62, v61
    s_nop 1
    v_permlane16_swap_b32 v61, v62
    v_max_f32 v61, v61, v62
    v_mov_b32 v62, v61
    s_nop 1
    v_permlane32_swap_b32 v61, v62
    v_max_f32 v61, v61, v62
    v_sub_f32 v48, 0, v61
    v_sub_f32 v49, 0, v61
    v_sub_f32 v50, 0, v61
    v_sub_f32 v51, 0, v61
    v_sub_f32 v32, v32, v61
    v_sub_f32 v33, v33, v61
    v_sub_f32 v34, v34, v61
    v_sub_f32 v35, v35, v61
    v_sub_f32 v36, v36, v61
    v_sub_f32 v37, v37, v61
    v_sub_f32 v38, v38, v61
    v_sub_f32 v39, v39, v61
    v_exp_f32 v16, v16
    v_exp_f32 v17, v17
    v_exp_f32 v18, v18
    v_exp_f32 v19, v19
    v_exp_f32 v20, v20
    v_exp_f32 v21, v21
    v_exp_f32 v22, v22
    v_exp_f32 v23, v23
    s_nop 0
    v_cvt_pk_bf16_f32 v16, v16, v17
    v_cvt_pk_bf16_f32 v17, v18, v19
    v_cvt_pk_bf16_f32 v18, v20, v21
    v_cvt_pk_bf16_f32 v19, v22, v23
    v_exp_f32 v24, v24
    v_exp_f32 v25, v25
    v_exp_f32 v26, v26
    v_exp_f32 v27, v27
    v_exp_f32 v28, v28
    v_exp_f32 v29, v29
    v_exp_f32 v30, v30
    v_exp_f32 v31, v31
    ds_read_b32 v9, v6
    v_cvt_pk_bf16_f32 v24, v24, v25
    v_cvt_pk_bf16_f32 v25, v26, v27
    v_cvt_pk_bf16_f32 v26, v28, v29
    v_cvt_pk_bf16_f32 v27, v30, v31
    s_waitcnt lgkmcnt(0)
    v_cmp_gt_u32 vcc, v9, v8
    s_cbranch_vccz L_sp252
L_sp252r:
    v_mfma_f32_16x16x32_bf16 v[128:131], a[96:99], v[16:19], 0
    v_exp_f32 v32, v32
    v_mfma_f32_16x16x32_bf16 v[132:135], a[100:103], v[16:19], 0
    ds_read_b64_tr_b16 a[64:65], v11 offset:0
    ds_read_b64_tr_b16 a[66:67], v11 offset:4096
    v_mfma_f32_16x16x32_bf16 v[136:139], a[104:107], v[16:19], 0
    v_exp_f32 v33, v33
    v_mfma_f32_16x16x32_bf16 v[140:143], a[108:111], v[16:19], 0
    ds_read_b128 a[0:3], v10 offset:0
    v_cvt_pk_bf16_f32 v32, v32, v33
    v_mfma_f32_16x16x32_bf16 v[144:147], a[112:115], v[16:19], 0
    v_exp_f32 v34, v34
    v_mfma_f32_16x16x32_bf16 v[148:151], a[116:119], v[16:19], 0
    ds_read_b64_tr_b16 a[68:69], v12 offset:0
    ds_read_b64_tr_b16 a[70:71], v12 offset:4096
    v_mfma_f32_16x16x32_bf16 v[152:155], a[120:123], v[16:19], 0
    v_exp_f32 v35, v35
    v_mfma_f32_16x16x32_bf16 v[156:159], a[124:127], v[16:19], 0
    ds_read_b128 a[4:7], v10 offset:256
    v_cvt_pk_bf16_f32 v33, v34, v35
    v_mfma_f32_16x16x32_bf16 v[224:227], v[52:55], v[16:19], 0
    v_exp_f32 v36, v36
    v_mfma_f32_16x16x32_bf16 v[16:19], a[32:35], v[80:83], v[40:43]
    ds_read_b64_tr_b16 a[72:73], v11 offset:256
    ds_read_b64_tr_b16 a[74:75], v11 offset:4352
    v_mfma_f32_16x16x32_bf16 v[16:19], a[36:39], v[84:87], v[16:19]
    v_exp_f32 v37, v37
    v_mfma_f32_16x16x32_bf16 v[16:19], a[40:43], v[88:91], v[16:19]
    ds_read_b128 a[8:11], v10 offset:512
    v_cvt_pk_bf16_f32 v34, v36, v37
    v_mfma_f32_16x16x32_bf16 v[16:19], a[44:47], v[92:95], v[16:19]
    v_exp_f32 v38, v38
    v_mfma_f32_16x16x32_bf16 v[20:23], a[48:51], v[80:83], v[40:43]
    ds_read_b64_tr_b16 a[76:77], v12 offset:256
    ds_read_b64_tr_b16 a[78:79], v12 offset:4352
    v_mfma_f32_16x16x32_bf16 v[20:23], a[52:55], v[84:87], v[20:23]
    v_exp_f32 v39, v39
    v_mfma_f32_16x16x32_bf16 v[20:23], a[56:59], v[88:91], v[20:23]
    ds_read_b128 a[12:15], v10 offset:768
    v_cvt_pk_bf16_f32 v35, v38, v39
    v_mfma_f32_16x16x32_bf16 v[20:23], a[60:63], v[92:95], v[20:23]
    v_add_u32 v8, 1, v8
    v_mfma_f32_16x16x32_bf16 v[160:163], a[96:99], v[24:27], 0
    v_exp_f32 v16, v16
    v_mfma_f32_16x16x32_bf16 v[164:167], a[100:103], v[24:27], 0
    ds_read_b64_tr_b16 a[80:81], v11 offset:512
    ds_read_b64_tr_b16 a[82:83], v11 offset:4608
    v_mfma_f32_16x16x32_bf16 v[168:171], a[104:107], v[24:27], 0
    v_exp_f32 v17, v17
    v_mfma_f32_16x16x32_bf16 v[172:175], a[108:111], v[24:27], 0
    ds_read_b128 a[16:19], v10 offset:4096
    v_cvt_pk_bf16_f32 v16, v16, v17
    v_mfma_f32_16x16x32_bf16 v[176:179], a[112:115], v[24:27], 0
    v_exp_f32 v18, v18
    v_mfma_f32_16x16x32_bf16 v[180:183], a[116:119], v[24:27], 0
    ds_read_b64_tr_b16 a[84:85], v12 offset:512
    ds_read_b64_tr_b16 a[86:87], v12 offset:4608
    v_mfma_f32_16x16x32_bf16 v[184:187], a[120:123], v[24:27], 0
    v_exp_f32 v19, v19
    v_mfma_f32_16x16x32_bf16 v[188:191], a[124:127], v[24:27], 0
    ds_read_b128 a[20:23], v10 offset:4352
    v_cvt_pk_bf16_f32 v17, v18, v19
    v_mfma_f32_16x16x32_bf16 v[228:231], v[52:55], v[24:27], 0
    v_exp_f32 v20, v20
    v_mfma_f32_16x16x32_bf16 v[24:27], a[32:35], v[96:99], v[44:47]
    ds_read_b64_tr_b16 a[88:89], v11 offset:768
    ds_read_b64_tr_b16 a[90:91], v11 offset:4864
    v_mfma_f32_16x16x32_bf16 v[24:27], a[36:39], v[100:103], v[24:27]
    v_exp_f32 v21, v21
    v_mfma_f32_16x16x32_bf16 v[24:27], a[40:43], v[104:107], v[24:27]
    ds_read_b128 a[24:27], v10 offset:4608
    v_cvt_pk_bf16_f32 v18, v20, v21
    v_mfma_f32_16x16x32_bf16 v[24:27], a[44:47], v[108:111], v[24:27]
    v_exp_f32 v22, v22
    v_mfma_f32_16x16x32_bf16 v[28:31], a[48:51], v[96:99], v[44:47]
    ds_read_b64_tr_b16 a[92:93], v12 offset:768
    ds_read_b64_tr_b16 a[94:95], v12 offset:4864
    v_mfma_f32_16x16x32_bf16 v[28:31], a[52:55], v[100:103], v[28:31]
    v_exp_f32 v23, v23
    v_mfma_f32_16x16x32_bf16 v[28:31], a[56:59], v[104:107], v[28:31]
    ds_read_b128 a[28:31], v10 offset:4864
    v_cvt_pk_bf16_f32 v19, v22, v23
    v_mfma_f32_16x16x32_bf16 v[28:31], a[60:63], v[108:111], v[28:31]
    ds_write_b32 v7, v8
    v_mfma_f32_16x16x32_bf16 v[192:195], a[96:99], v[32:35], 0
    v_exp_f32 v24, v24
    v_mfma_f32_16x16x32_bf16 v[196:199], a[100:103], v[32:35], 0
    s_add_u32 s66, s66, 16384
    s_cmp_eq_u32 s66, s100
    v_mfma_f32_16x16x32_bf16 v[200:203], a[104:107], v[32:35], 0
    v_exp_f32 v25, v25
    v_mfma_f32_16x16x32_bf16 v[204:207], a[108:111], v[32:35], 0
    v_cvt_pk_bf16_f32 v24, v24, v25
    v_mfma_f32_16x16x32_bf16 v[208:211], a[112:115], v[32:35], 0
    v_exp_f32 v26, v26
    v_mfma_f32_16x16x32_bf16 v[212:215], a[116:119], v[32:35], 0
    s_cselect_b32 s66, 0, s66
    v_add_u32 v10, s66, v13
    v_mfma_f32_16x16x32_bf16 v[216:219], a[120:123], v[32:35], 0
    v_exp_f32 v27, v27
    v_mfma_f32_16x16x32_bf16 v[220:223], a[124:127], v[32:35], 0
    v_cvt_pk_bf16_f32 v25, v26, v27
    v_add_u32 v11, s66, v14
    v_mfma_f32_16x16x32_bf16 v[232:235], v[52:55], v[32:35], 0
    v_exp_f32 v28, v28
    v_mfma_f32_16x16x32_bf16 v[32:35], a[32:35], v[112:115], v[48:51]
    ds_read_b32 v9, v6
    v_add_u32 v12, s66, v15
    v_mfma_f32_16x16x32_bf16 v[32:35], a[36:39], v[116:119], v[32:35]
    v_exp_f32 v29, v29
    v_mfma_f32_16x16x32_bf16 v[32:35], a[40:43], v[120:123], v[32:35]
    v_cvt_pk_bf16_f32 v26, v28, v29
    v_mfma_f32_16x16x32_bf16 v[32:35], a[44:47], v[124:127], v[32:35]
    v_exp_f32 v30, v30
    v_mfma_f32_16x16x32_bf16 v[36:39], a[48:51], v[112:115], v[48:51]
    s_mov_b32 s69, 0
    s_mov_b32 s100, s101
    v_mfma_f32_16x16x32_bf16 v[36:39], a[52:55], v[116:119], v[36:39]
    v_exp_f32 v31, v31
    v_mfma_f32_16x16x32_bf16 v[36:39], a[56:59], v[120:123], v[36:39]
    v_cvt_pk_bf16_f32 v27, v30, v31
    v_mfma_f32_16x16x32_bf16 v[36:39], a[60:63], v[124:127], v[36:39]
    s_waitcnt lgkmcnt(0)
    v_cmp_gt_u32 vcc, v9, v8
.p2align 3
L_loop:
    s_cbranch_vccz L_sp253
L_sp253r:
    v_mfma_f32_16x16x32_bf16 v[128:131], a[64:67], v[16:19], v[128:131]
    v_exp_f32 v32, v32
    v_mfma_f32_16x16x32_bf16 v[132:135], a[68:71], v[16:19], v[132:135]
    ds_read_b64_tr_b16 a[96:97], v11 offset:0
    ds_read_b64_tr_b16 a[98:99], v11 offset:4096
    v_mfma_f32_16x16x32_bf16 v[136:139], a[72:75], v[16:19], v[136:139]
    v_exp_f32 v33, v33
    v_mfma_f32_16x16x32_bf16 v[140:143], a[76:79], v[16:19], v[140:143]
    ds_read_b128 a[32:35], v10 offset:0
    v_cvt_pk_bf16_f32 v32, v32, v33
    v_mfma_f32_16x16x32_bf16 v[144:147], a[80:83], v[16:19], v[144:147]
    v_exp_f32 v34, v34
    v_mfma_f32_16x16x32_bf16 v[148:151], a[84:87], v[16:19], v[148:151]
    ds_read_b64_tr_b16 a[100:101], v12 offset:0
    ds_read_b64_tr_b16 a[102:103], v12 offset:4096
    v_mfma_f32_16x16x32_bf16 v[152:155], a[88:91], v[16:19], v[152:155]
    v_exp_f32 v35, v35
    v_mfma_f32_16x16x32_bf16 v[156:159], a[92:95], v[16:19], v[156:159]
    ds_read_b128 a[36:39], v10 offset:256
    v_cvt_pk_bf16_f32 v33, v34, v35
    v_mfma_f32_16x16x32_bf16 v[224:227], v[52:55], v[16:19], v[224:227]
    v_exp_f32 v36, v36
    v_mfma_f32_16x16x32_bf16 v[16:19], a[0:3], v[80:83], v[40:43]
    ds_read_b64_tr_b16 a[104:105], v11 offset:256
    ds_read_b64_tr_b16 a[106:107], v11 offset:4352
    v_mfma_f32_16x16x32_bf16 v[16:19], a[4:7], v[84:87], v[16:19]
    v_exp_f32 v37, v37
    v_mfma_f32_16x16x32_bf16 v[16:19], a[8:11], v[88:91], v[16:19]
    ds_read_b128 a[40:43], v10 offset:512
    v_cvt_pk_bf16_f32 v34, v36, v37
    v_mfma_f32_16x16x32_bf16 v[16:19], a[12:15], v[92:95], v[16:19]
    v_exp_f32 v38, v38
    v_mfma_f32_16x16x32_bf16 v[20:23], a[16:19], v[80:83], v[40:43]
    ds_read_b64_tr_b16 a[108:109], v12 offset:256
    ds_read_b64_tr_b16 a[110:111], v12 offset:4352
    v_mfma_f32_16x16x32_bf16 v[20:23], a[20:23], v[84:87], v[20:23]
    v_exp_f32 v39, v39
    v_mfma_f32_16x16x32_bf16 v[20:23], a[24:27], v[88:91], v[20:23]
    ds_read_b128 a[44:47], v10 offset:768
    v_cvt_pk_bf16_f32 v35, v38, v39
    v_mfma_f32_16x16x32_bf16 v[20:23], a[28:31], v[92:95], v[20:23]
    v_add_u32 v8, 1, v8
    v_mfma_f32_16x16x32_bf16 v[160:163], a[64:67], v[24:27], v[160:163]
    v_exp_f32 v16, v16
    v_mfma_f32_16x16x32_bf16 v[164:167], a[68:71], v[24:27], v[164:167]
    ds_read_b64_tr_b16 a[112:113], v11 offset:512
    ds_read_b64_tr_b16 a[114:115], v11 offset:4608
    v_mfma_f32_16x16x32_bf16 v[168:171], a[72:75], v[24:27], v[168:171]
    v_exp_f32 v17, v17
    v_mfma_f32_16x16x32_bf16 v[172:175], a[76:79], v[24:27], v[172:175]
    ds_read_b128 a[48:51], v10 offset:4096
    v_cvt_pk_bf16_f32 v16, v16, v17
    v_mfma_f32_16x16x32_bf16 v[176:179], a[80:83], v[24:27], v[176:179]
    v_exp_f32 v18, v18
    v_mfma_f32_16x16x32_bf16 v[180:183], a[84:87], v[24:27], v[180:183]
    ds_read_b64_tr_b16 a[116:117], v12 offset:512
    ds_read_b64_tr_b16 a[118:119], v12 offset:4608
    v_mfma_f32_16x16x32_bf16 v[184:187], a[88:91], v[24:27], v[184:187]
    v_exp_f32 v19, v19
    v_mfma_f32_16x16x32_bf16 v[188:191], a[92:95], v[24:27], v[188:191]
    ds_read_b128 a[52:55], v10 offset:4352
    v_cvt_pk_bf16_f32 v17, v18, v19
    v_mfma_f32_16x16x32_bf16 v[228:231], v[52:55], v[24:27], v[228:231]
    v_exp_f32 v20, v20
    v_mfma_f32_16x16x32_bf16 v[24:27], a[0:3], v[96:99], v[44:47]
    ds_read_b64_tr_b16 a[120:121], v11 offset:768
    ds_read_b64_tr_b16 a[122:123], v11 offset:4864
    v_mfma_f32_16x16x32_bf16 v[24:27], a[4:7], v[100:103], v[24:27]
    v_exp_f32 v21, v21
    v_mfma_f32_16x16x32_bf16 v[24:27], a[8:11], v[104:107], v[24:27]
    ds_read_b128 a[56:59], v10 offset:4608
    v_cvt_pk_bf16_f32 v18, v20, v21
    v_mfma_f32_16x16x32_bf16 v[24:27], a[12:15], v[108:111], v[24:27]
    v_exp_f32 v22, v22
    v_mfma_f32_16x16x32_bf16 v[28:31], a[16:19], v[96:99], v[44:47]
    ds_read_b64_tr_b16 a[124:125], v12 offset:768
    ds_read_b64_tr_b16 a[126:127], v12 offset:4864
    v_mfma_f32_16x16x32_bf16 v[28:31], a[20:23], v[100:103], v[28:31]
    v_exp_f32 v23, v23
    v_mfma_f32_16x16x32_bf16 v[28:31], a[24:27], v[104:107], v[28:31]
    ds_read_b128 a[60:63], v10 offset:4864
    v_cvt_pk_bf16_f32 v19, v22, v23
    v_mfma_f32_16x16x32_bf16 v[28:31], a[28:31], v[108:111], v[28:31]
    ds_write_b32 v7, v8
    v_mfma_f32_16x16x32_bf16 v[192:195], a[64:67], v[32:35], v[192:195]
    v_exp_f32 v24, v24
    v_mfma_f32_16x16x32_bf16 v[196:199], a[68:71], v[32:35], v[196:199]
    s_add_u32 s66, s66, 16384
    s_cmp_eq_u32 s66, s100
    v_mfma_f32_16x16x32_bf16 v[200:203], a[72:75], v[32:35], v[200:203]
    v_exp_f32 v25, v25
    v_mfma_f32_16x16x32_bf16 v[204:207], a[76:79], v[32:35], v[204:207]
    v_cvt_pk_bf16_f32 v24, v24, v25
    v_mfma_f32_16x16x32_bf16 v[208:211], a[80:83], v[32:35], v[208:211]
    v_exp_f32 v26, v26
    v_mfma_f32_16x16x32_bf16 v[212:215], a[84:87], v[32:35], v[212:215]
    s_cselect_b32 s66, 0, s66
    v_add_u32 v10, s66, v13
    v_mfma_f32_16x16x32_bf16 v[216:219], a[88:91], v[32:35], v[216:219]
    v_exp_f32 v27, v27
    v_mfma_f32_16x16x32_bf16 v[220:223], a[92:95], v[32:35], v[220:223]
    v_cvt_pk_bf16_f32 v25, v26, v27
    v_add_u32 v11, s66, v14
    v_mfma_f32_16x16x32_bf16 v[232:235], v[52:55], v[32:35], v[232:235]
    v_exp_f32 v28, v28
    v_mfma_f32_16x16x32_bf16 v[32:35], a[0:3], v[112:115], v[48:51]
    ds_read_b32 v9, v6
    v_add_u32 v12, s66, v15
    v_mfma_f32_16x16x32_bf16 v[32:35], a[4:7], v[116:119], v[32:35]
    v_exp_f32 v29, v29
    v_mfma_f32_16x16x32_bf16 v[32:35], a[8:11], v[120:123], v[32:35]
    v_cvt_pk_bf16_f32 v26, v28, v29
    v_mfma_f32_16x16x32_bf16 v[32:35], a[12:15], v[124:127], v[32:35]
    v_exp_f32 v30, v30
    v_mfma_f32_16x16x32_bf16 v[36:39], a[16:19], v[112:115], v[48:51]
    s_xor_b32 s60, s69, s74
    s_and_b32 s60, s60, 0x5f
    v_mfma_f32_16x16x32_bf16 v[36:39], a[20:23], v[116:119], v[36:39]
    v_exp_f32 v31, v31
    v_mfma_f32_16x16x32_bf16 v[36:39], a[24:27], v[120:123], v[36:39]
    v_cvt_pk_bf16_f32 v27, v30, v31
    s_cbranch_scc0 L_init
L_initr:
    v_mfma_f32_16x16x32_bf16 v[36:39], a[28:31], v[124:127], v[36:39]
    s_waitcnt lgkmcnt(0)
    v_cmp_gt_u32 vcc, v9, v8
    s_cbranch_vccz L_sp254
L_sp254r:
    v_mfma_f32_16x16x32_bf16 v[128:131], a[96:99], v[16:19], v[128:131]
    v_exp_f32 v32, v32
    v_mfma_f32_16x16x32_bf16 v[132:135], a[100:103], v[16:19], v[132:135]
    ds_read_b64_tr_b16 a[64:65], v11 offset:0
    ds_read_b64_tr_b16 a[66:67], v11 offset:4096
    v_mfma_f32_16x16x32_bf16 v[136:139], a[104:107], v[16:19], v[136:139]
    v_exp_f32 v33, v33
    v_mfma_f32_16x16x32_bf16 v[140:143], a[108:111], v[16:19], v[140:143]
    ds_read_b128 a[0:3], v10 offset:0
    v_cvt_pk_bf16_f32 v32, v32, v33
    v_mfma_f32_16x16x32_bf16 v[144:147], a[112:115], v[16:19], v[144:147]
    v_exp_f32 v34, v34
    v_mfma_f32_16x16x32_bf16 v[148:151], a[116:119], v[16:19], v[148:151]
    ds_read_b64_tr_b16 a[68:69], v12 offset:0
    ds_read_b64_tr_b16 a[70:71], v12 offset:4096
    v_mfma_f32_16x16x32_bf16 v[152:155], a[120:123], v[16:19], v[152:155]
    v_exp_f32 v35, v35
    v_mfma_f32_16x16x32_bf16 v[156:159], a[124:127], v[16:19], v[156:159]
    ds_read_b128 a[4:7], v10 offset:256
    v_cvt_pk_bf16_f32 v33, v34, v35
    v_mfma_f32_16x16x32_bf16 v[224:227], v[52:55], v[16:19], v[224:227]
    v_exp_f32 v36, v36
    v_mfma_f32_16x16x32_bf16 v[16:19], a[32:35], v[80:83], v[40:43]
    ds_read_b64_tr_b16 a[72:73], v11 offset:256
    ds_read_b64_tr_b16 a[74:75], v11 offset:4352
    v_mfma_f32_16x16x32_bf16 v[16:19], a[36:39], v[84:87], v[16:19]
    v_exp_f32 v37, v37
    v_mfma_f32_16x16x32_bf16 v[16:19], a[40:43], v[88:91], v[16:19]
    ds_read_b128 a[8:11], v10 offset:512
    v_cvt_pk_bf16_f32 v34, v36, v37
    v_mfma_f32_16x16x32_bf16 v[16:19], a[44:47], v[92:95], v[16:19]
    v_exp_f32 v38, v38
    v_mfma_f32_16x16x32_bf16 v[20:23], a[48:51], v[80:83], v[40:43]
    ds_read_b64_tr_b16 a[76:77], v12 offset:256
    ds_read_b64_tr_b16 a[78:79], v12 offset:4352
    v_mfma_f32_16x16x32_bf16 v[20:23], a[52:55], v[84:87], v[20:23]
    v_exp_f32 v39, v39
    v_mfma_f32_16x16x32_bf16 v[20:23], a[56:59], v[88:91], v[20:23]
    ds_read_b128 a[12:15], v10 offset:768
    v_cvt_pk_bf16_f32 v35, v38, v39
    v_mfma_f32_16x16x32_bf16 v[20:23], a[60:63], v[92:95], v[20:23]
    v_add_u32 v8, 1, v8
    v_mfma_f32_16x16x32_bf16 v[160:163], a[96:99], v[24:27], v[160:163]
    v_exp_f32 v16, v16
    v_mfma_f32_16x16x32_bf16 v[164:167], a[100:103], v[24:27], v[164:167]
    ds_read_b64_tr_b16 a[80:81], v11 offset:512
    ds_read_b64_tr_b16 a[82:83], v11 offset:4608
    v_mfma_f32_16x16x32_bf16 v[168:171], a[104:107], v[24:27], v[168:171]
    v_exp_f32 v17, v17
    v_mfma_f32_16x16x32_bf16 v[172:175], a[108:111], v[24:27], v[172:175]
    ds_read_b128 a[16:19], v10 offset:4096
    v_cvt_pk_bf16_f32 v16, v16, v17
    v_mfma_f32_16x16x32_bf16 v[176:179], a[112:115], v[24:27], v[176:179]
    v_exp_f32 v18, v18
    v_mfma_f32_16x16x32_bf16 v[180:183], a[116:119], v[24:27], v[180:183]
    ds_read_b64_tr_b16 a[84:85], v12 offset:512
    ds_read_b64_tr_b16 a[86:87], v12 offset:4608
    v_mfma_f32_16x16x32_bf16 v[184:187], a[120:123], v[24:27], v[184:187]
    v_exp_f32 v19, v19
    v_mfma_f32_16x16x32_bf16 v[188:191], a[124:127], v[24:27], v[188:191]
    ds_read_b128 a[20:23], v10 offset:4352
    v_cvt_pk_bf16_f32 v17, v18, v19
    v_mfma_f32_16x16x32_bf16 v[228:231], v[52:55], v[24:27], v[228:231]
    v_exp_f32 v20, v20
    v_mfma_f32_16x16x32_bf16 v[24:27], a[32:35], v[96:99], v[44:47]
    ds_read_b64_tr_b16 a[88:89], v11 offset:768
    ds_read_b64_tr_b16 a[90:91], v11 offset:4864
    v_mfma_f32_16x16x32_bf16 v[24:27], a[36:39], v[100:103], v[24:27]
    v_exp_f32 v21, v21
    v_mfma_f32_16x16x32_bf16 v[24:27], a[40:43], v[104:107], v[24:27]
    ds_read_b128 a[24:27], v10 offset:4608
    v_cvt_pk_bf16_f32 v18, v20, v21
    v_mfma_f32_16x16x32_bf16 v[24:27], a[44:47], v[108:111], v[24:27]
    v_exp_f32 v22, v22
    v_mfma_f32_16x16x32_bf16 v[28:31], a[48:51], v[96:99], v[44:47]
    ds_read_b64_tr_b16 a[92:93], v12 offset:768
    ds_read_b64_tr_b16 a[94:95], v12 offset:4864
    v_mfma_f32_16x16x32_bf16 v[28:31], a[52:55], v[100:103], v[28:31]
    v_exp_f32 v23, v23
    v_mfma_f32_16x16x32_bf16 v[28:31], a[56:59], v[104:107], v[28:31]
    ds_read_b128 a[28:31], v10 offset:4864
    v_cvt_pk_bf16_f32 v19, v22, v23
    v_mfma_f32_16x16x32_bf16 v[28:31], a[60:63], v[108:111], v[28:31]
    ds_write_b32 v7, v8
    v_mfma_f32_16x16x32_bf16 v[192:195], a[96:99], v[32:35], v[192:195]
    v_exp_f32 v24, v24
    v_mfma_f32_16x16x32_bf16 v[196:199], a[100:103], v[32:35], v[196:199]
    s_add_u32 s66, s66, 16384
    s_cmp_eq_u32 s66, s100
    v_mfma_f32_16x16x32_bf16 v[200:203], a[104:107], v[32:35], v[200:203]
    v_exp_f32 v25, v25
    v_mfma_f32_16x16x32_bf16 v[204:207], a[108:111], v[32:35], v[204:207]
    v_cvt_pk_bf16_f32 v24, v24, v25
    v_mfma_f32_16x16x32_bf16 v[208:211], a[112:115], v[32:35], v[208:211]
    v_exp_f32 v26, v26
    v_mfma_f32_16x16x32_bf16 v[212:215], a[116:119], v[32:35], v[212:215]
    s_cselect_b32 s66, 0, s66
    v_add_u32 v10, s66, v13
    v_mfma_f32_16x16x32_bf16 v[216:219], a[120:123], v[32:35], v[216:219]
    v_exp_f32 v27, v27
    v_mfma_f32_16x16x32_bf16 v[220:223], a[124:127], v[32:35], v[220:223]
    v_cvt_pk_bf16_f32 v25, v26, v27
    v_add_u32 v11, s66, v14
    v_mfma_f32_16x16x32_bf16 v[232:235], v[52:55], v[32:35], v[232:235]
    v_exp_f32 v28, v28
    v_mfma_f32_16x16x32_bf16 v[32:35], a[32:35], v[112:115], v[48:51]
    ds_read_b32 v9, v6
    v_add_u32 v12, s66, v15
    v_mfma_f32_16x16x32_bf16 v[32:35], a[36:39], v[116:119], v[32:35]
    v_exp_f32 v29, v29
    v_mfma_f32_16x16x32_bf16 v[32:35], a[40:43], v[120:123], v[32:35]
    v_cvt_pk_bf16_f32 v26, v28, v29
    v_mfma_f32_16x16x32_bf16 v[32:35], a[44:47], v[124:127], v[32:35]
    v_exp_f32 v30, v30
    v_mfma_f32_16x16x32_bf16 v[36:39], a[48:51], v[112:115], v[48:51]
    s_add_u32 s69, s69, 1
    s_cmp_lt_u32 s69, 15
    v_mfma_f32_16x16x32_bf16 v[36:39], a[52:55], v[116:119], v[36:39]
    v_exp_f32 v31, v31
    v_mfma_f32_16x16x32_bf16 v[36:39], a[56:59], v[120:123], v[36:39]
    v_cvt_pk_bf16_f32 v27, v30, v31
    v_mfma_f32_16x16x32_bf16 v[36:39], a[60:63], v[124:127], v[36:39]
    s_waitcnt lgkmcnt(0)
    v_cmp_gt_u32 vcc, v9, v8
    s_cbranch_scc1 L_loop
    s_cmp_lg_u32 s68, 0
    s_cbranch_scc1 L_last
    v_mfma_f32_16x16x32_bf16 v[128:131], a[64:67], v[16:19], v[128:131]
    v_exp_f32 v32, v32
    v_mfma_f32_16x16x32_bf16 v[132:135], a[68:71], v[16:19], v[132:135]
    v_exp_f32 v33, v33
    v_mfma_f32_16x16x32_bf16 v[136:139], a[72:75], v[16:19], v[136:139]
    v_exp_f32 v34, v34
    v_mfma_f32_16x16x32_bf16 v[140:143], a[76:79], v[16:19], v[140:143]
    v_exp_f32 v35, v35
    v_mfma_f32_16x16x32_bf16 v[144:147], a[80:83], v[16:19], v[144:147]
    v_exp_f32 v36, v36
    v_mfma_f32_16x16x32_bf16 v[148:151], a[84:87], v[16:19], v[148:151]
    v_exp_f32 v37, v37
    v_mfma_f32_16x16x32_bf16 v[152:155], a[88:91], v[16:19], v[152:155]
    v_exp_f32 v38, v38
    v_mfma_f32_16x16x32_bf16 v[156:159], a[92:95], v[16:19], v[156:159]
    v_exp_f32 v39, v39
    v_mfma_f32_16x16x32_bf16 v[224:227], v[52:55], v[16:19], v[224:227]
    s_mul_i32 s62, s3, 12288
    s_mov_b32 s60, 0x4b800000
    v_mfma_f32_16x16x32_bf16 v[160:163], a[64:67], v[24:27], v[160:163]
    v_cvt_pk_bf16_f32 v32, v32, v33
    s_lshl_b32 s61, s3, 2
    v_mfma_f32_16x16x32_bf16 v[164:167], a[68:71], v[24:27], v[164:167]
    v_cvt_pk_bf16_f32 v33, v34, v35
    s_add_u32 s61, s61, 163584
    v_mfma_f32_16x16x32_bf16 v[168:171], a[72:75], v[24:27], v[168:171]
    v_cvt_pk_bf16_f32 v34, v36, v37
    v_mov_b32 v4, s61
    v_mfma_f32_16x16x32_bf16 v[172:175], a[76:79], v[24:27], v[172:175]
    v_cvt_pk_bf16_f32 v35, v38, v39
    v_and_b32 v3, 3, v1
    v_mfma_f32_16x16x32_bf16 v[176:179], a[80:83], v[24:27], v[176:179]
    v_min_u32 v3, 2, v3
    v_lshlrev_b32 v3, 2, v3
    v_mfma_f32_16x16x32_bf16 v[180:183], a[84:87], v[24:27], v[180:183]
    v_add_u32 v3, 163584, v3
    v_mfma_f32_16x16x32_bf16 v[184:187], a[88:91], v[24:27], v[184:187]
    v_mfma_f32_16x16x32_bf16 v[188:191], a[92:95], v[24:27], v[188:191]
    v_mfma_f32_16x16x32_bf16 v[228:231], v[52:55], v[24:27], v[228:231]
    v_mfma_f32_16x16x32_bf16 v[192:195], a[64:67], v[32:35], v[192:195]
    v_mfma_f32_16x16x32_bf16 v[196:199], a[68:71], v[32:35], v[196:199]
    v_rcp_f32 v60, v224
    v_mfma_f32_16x16x32_bf16 v[200:203], a[72:75], v[32:35], v[200:203]
    v_mfma_f32_16x16x32_bf16 v[204:207], a[76:79], v[32:35], v[204:207]
    v_mov_b32 v61, v60
    v_mfma_f32_16x16x32_bf16 v[208:211], a[80:83], v[32:35], v[208:211]
    v_mfma_f32_16x16x32_bf16 v[212:215], a[84:87], v[32:35], v[212:215]
    v_rcp_f32 v62, v228
    v_mfma_f32_16x16x32_bf16 v[216:219], a[88:91], v[32:35], v[216:219]
    v_mfma_f32_16x16x32_bf16 v[220:223], a[92:95], v[32:35], v[220:223]
    v_mov_b32 v63, v62
    v_mfma_f32_16x16x32_bf16 v[232:235], v[52:55], v[32:35], v[232:235]
    v_add_f32 v59, v224, v228
    s_mov_b32 s64, 1
    v_pk_mul_f32 v[128:129], v[128:129], v[60:61]
    v_pk_mul_f32 v[130:131], v[130:131], v[60:61]
    v_pk_mul_f32 v[132:133], v[132:133], v[60:61]
    v_pk_mul_f32 v[134:135], v[134:135], v[60:61]
    v_cvt_pk_bf16_f32 v64, v128, v129
    v_cvt_pk_bf16_f32 v65, v130, v131
    v_cvt_pk_bf16_f32 v66, v132, v133
    v_cvt_pk_bf16_f32 v67, v134, v135
    v_pk_mul_f32 v[136:137], v[136:137], v[60:61]
    v_pk_mul_f32 v[138:139], v[138:139], v[60:61]
    v_pk_mul_f32 v[140:141], v[140:141], v[60:61]
    v_pk_mul_f32 v[142:143], v[142:143], v[60:61]
    v_cvt_pk_bf16_f32 v68, v136, v137
    v_cvt_pk_bf16_f32 v69, v138, v139
    v_cvt_pk_bf16_f32 v70, v140, v141
    v_cvt_pk_bf16_f32 v71, v142, v143
    v_pk_mul_f32 v[144:145], v[144:145], v[60:61]
    v_pk_mul_f32 v[146:147], v[146:147], v[60:61]
    v_pk_mul_f32 v[148:149], v[148:149], v[60:61]
    v_pk_mul_f32 v[150:151], v[150:151], v[60:61]
    v_cvt_pk_bf16_f32 v72, v144, v145
    v_cvt_pk_bf16_f32 v73, v146, v147
    v_cvt_pk_bf16_f32 v74, v148, v149
    v_cvt_pk_bf16_f32 v75, v150, v151
    v_pk_mul_f32 v[152:153], v[152:153], v[60:61]
    v_pk_mul_f32 v[154:155], v[154:155], v[60:61]
    v_pk_mul_f32 v[156:157], v[156:157], v[60:61]
    v_pk_mul_f32 v[158:159], v[158:159], v[60:61]
    v_cvt_pk_bf16_f32 v76, v152, v153
    v_cvt_pk_bf16_f32 v77, v154, v155
    v_cvt_pk_bf16_f32 v78, v156, v157
    v_cvt_pk_bf16_f32 v79, v158, v159
    v_add_f32 v59, v59, v232
    v_cmp_nge_f32 vcc, s60, v59
    s_cmp_lg_u32 s70, 0
    s_cbranch_scc1 L_noflag0
    s_cmp_eq_u64 vcc, 0
    s_cselect_b32 s64, 1, 2
L_noflag0:
    v_mov_b32 v2, s64
    ds_write_b32 v4, v2
    v_pk_mul_f32 v[160:161], v[160:161], v[62:63]
    v_pk_mul_f32 v[162:163], v[162:163], v[62:63]
    v_pk_mul_f32 v[164:165], v[164:165], v[62:63]
    v_pk_mul_f32 v[166:167], v[166:167], v[62:63]
    v_cvt_pk_bf16_f32 v128, v160, v161
    v_cvt_pk_bf16_f32 v129, v162, v163
    v_cvt_pk_bf16_f32 v130, v164, v165
    v_cvt_pk_bf16_f32 v131, v166, v167
    v_pk_mul_f32 v[168:169], v[168:169], v[62:63]
    v_pk_mul_f32 v[170:171], v[170:171], v[62:63]
    v_pk_mul_f32 v[172:173], v[172:173], v[62:63]
    v_pk_mul_f32 v[174:175], v[174:175], v[62:63]
    v_cvt_pk_bf16_f32 v132, v168, v169
    v_cvt_pk_bf16_f32 v133, v170, v171
    v_cvt_pk_bf16_f32 v134, v172, v173
    v_cvt_pk_bf16_f32 v135, v174, v175
    v_pk_mul_f32 v[176:177], v[176:177], v[62:63]
    v_pk_mul_f32 v[178:179], v[178:179], v[62:63]
    v_pk_mul_f32 v[180:181], v[180:181], v[62:63]
    v_pk_mul_f32 v[182:183], v[182:183], v[62:63]
    v_cvt_pk_bf16_f32 v136, v176, v177
    v_cvt_pk_bf16_f32 v137, v178, v179
    v_cvt_pk_bf16_f32 v138, v180, v181
    v_cvt_pk_bf16_f32 v139, v182, v183
    v_pk_mul_f32 v[184:185], v[184:185], v[62:63]
    v_pk_mul_f32 v[186:187], v[186:187], v[62:63]
    v_pk_mul_f32 v[188:189], v[188:189], v[62:63]
    v_pk_mul_f32 v[190:191], v[190:191], v[62:63]
    v_cvt_pk_bf16_f32 v140, v184, v185
    v_cvt_pk_bf16_f32 v141, v186, v187
    v_cvt_pk_bf16_f32 v142, v188, v189
    v_cvt_pk_bf16_f32 v143, v190, v191
    ds_read_b32 v9, v6
    ds_read_b32 v2, v3
    v_rcp_f32 v60, v232
    s_nop 0
    v_mov_b32 v61, v60
    v_pk_mul_f32 v[192:193], v[192:193], v[60:61]
    v_pk_mul_f32 v[194:195], v[194:195], v[60:61]
    v_pk_mul_f32 v[196:197], v[196:197], v[60:61]
    v_pk_mul_f32 v[198:199], v[198:199], v[60:61]
    v_cvt_pk_bf16_f32 v144, v192, v193
    v_cvt_pk_bf16_f32 v145, v194, v195
    v_cvt_pk_bf16_f32 v146, v196, v197
    v_cvt_pk_bf16_f32 v147, v198, v199
    v_pk_mul_f32 v[200:201], v[200:201], v[60:61]
    v_pk_mul_f32 v[202:203], v[202:203], v[60:61]
    v_pk_mul_f32 v[204:205], v[204:205], v[60:61]
    v_pk_mul_f32 v[206:207], v[206:207], v[60:61]
    v_cvt_pk_bf16_f32 v148, v200, v201
    v_cvt_pk_bf16_f32 v149, v202, v203
    v_cvt_pk_bf16_f32 v150, v204, v205
    v_cvt_pk_bf16_f32 v151, v206, v207
    v_pk_mul_f32 v[208:209], v[208:209], v[60:61]
    v_pk_mul_f32 v[210:211], v[210:211], v[60:61]
    v_pk_mul_f32 v[212:213], v[212:213], v[60:61]
    v_pk_mul_f32 v[214:215], v[214:215], v[60:61]
    v_cvt_pk_bf16_f32 v152, v208, v209
    v_cvt_pk_bf16_f32 v153, v210, v211
    v_cvt_pk_bf16_f32 v154, v212, v213
    v_cvt_pk_bf16_f32 v155, v214, v215
    v_pk_mul_f32 v[216:217], v[216:217], v[60:61]
    v_pk_mul_f32 v[218:219], v[218:219], v[60:61]
    v_pk_mul_f32 v[220:221], v[220:221], v[60:61]
    v_pk_mul_f32 v[222:223], v[222:223], v[60:61]
    v_cvt_pk_bf16_f32 v156, v216, v217
    v_cvt_pk_bf16_f32 v157, v218, v219
    v_cvt_pk_bf16_f32 v158, v220, v221
    v_cvt_pk_bf16_f32 v159, v222, v223
    s_add_u32 s60, s62, 122880
    v_add_u32 v4, s60, v5
    s_waitcnt lgkmcnt(0)
    v_cmp_gt_u32 vcc, v9, v8
    s_cbranch_vccz L_sp255
L_sp255r:
    s_branch L_done1
L_done:
    s_sub_i32 s75, s75, 1
    s_cmp_lt_i32 s75, 0
    s_cbranch_scc1 L_doneok
    ds_read_b32 v2, v3
    s_waitcnt lgkmcnt(0)
L_done1:
    v_cmp_eq_u32 vcc, 0, v2
    s_cbranch_vccnz L_done
L_doneok:
    v_cmp_eq_u32 vcc, 2, v2
    s_cbranch_vccnz L_redo
    ds_read_b128 v[80:83], v4 offset:0
    ds_read_b128 v[84:87], v4 offset:1024
    ds_read_b128 v[88:91], v4 offset:2048
    ds_read_b128 v[92:95], v4 offset:3072
    ds_read_b128 v[96:99], v4 offset:4096
    ds_read_b128 v[100:103], v4 offset:5120
    ds_read_b128 v[104:107], v4 offset:6144
    ds_read_b128 v[108:111], v4 offset:7168
    ds_read_b128 v[112:115], v4 offset:8192
    ds_read_b128 v[116:119], v4 offset:9216
    ds_read_b128 v[120:123], v4 offset:10240
    ds_read_b128 v[124:127], v4 offset:11264
    ds_write_b128 v4, v[64:67] offset:0
    s_mov_b32 s68, 1
    s_mov_b32 s70, 0
    ds_write_b128 v4, v[68:71] offset:1024
    s_mov_b32 s74, 4
    ds_write_b128 v4, v[72:75] offset:2048
    s_mov_b32 s101, 147456
    ds_write_b128 v4, v[76:79] offset:3072
    v_mov_b32 v56, 0xff800000
    v_mov_b32 v57, 0xff800000
    ds_write_b128 v4, v[128:131] offset:4096
    v_mov_b32 v58, 0xff800000
    ds_write_b128 v4, v[132:135] offset:5120
    s_lshl_b32 s62, s76, 20
    ds_write_b128 v4, v[136:139] offset:6144
    s_lshl_b32 s63, s77, 8
    s_add_u32 s62, s62, s63
    ds_write_b128 v4, v[140:143] offset:7168
    s_add_u32 s32, s12, s62
    ds_write_b128 v4, v[144:147] offset:8192
    s_addc_u32 s33, s13, 0
    ds_write_b128 v4, v[148:151] offset:9216
    s_and_b32 s33, s33, 0xffff
    s_mov_b32 s34, 1048576
    ds_write_b128 v4, v[152:155] offset:10240
    s_mov_b32 s35, 0x00020000
    ds_write_b128 v4, v[156:159] offset:11264
    s_sub_u32 s34, s34, s63
    s_waitcnt lgkmcnt(0)
    s_branch L_item
L_last:
    v_mfma_f32_16x16x32_bf16 v[128:131], a[64:67], v[16:19], v[128:131]
    v_exp_f32 v32, v32
    ds_read_b32 v9, v6
    v_mfma_f32_16x16x32_bf16 v[132:135], a[68:71], v[16:19], v[132:135]
    v_exp_f32 v33, v33
    v_mfma_f32_16x16x32_bf16 v[136:139], a[72:75], v[16:19], v[136:139]
    v_exp_f32 v34, v34
    v_mfma_f32_16x16x32_bf16 v[140:143], a[76:79], v[16:19], v[140:143]
    v_exp_f32 v35, v35
    v_mfma_f32_16x16x32_bf16 v[144:147], a[80:83], v[16:19], v[144:147]
    v_exp_f32 v36, v36
    s_mul_i32 s62, s3, 12288
    v_mfma_f32_16x16x32_bf16 v[148:151], a[84:87], v[16:19], v[148:151]
    v_exp_f32 v37, v37
    s_mov_b32 s60, 0x4b800000
    v_mfma_f32_16x16x32_bf16 v[152:155], a[88:91], v[16:19], v[152:155]
    v_exp_f32 v38, v38
    s_add_u32 s62, s62, 36864
    v_mfma_f32_16x16x32_bf16 v[156:159], a[92:95], v[16:19], v[156:159]
    v_exp_f32 v39, v39
    s_waitcnt lgkmcnt(0)
    v_cmp_gt_u32 vcc, v9, v8
    v_mfma_f32_16x16x32_bf16 v[224:227], v[52:55], v[16:19], v[224:227]
    s_cbranch_vccz L_sp256
L_sp256r:
    v_mfma_f32_16x16x32_bf16 v[160:163], a[64:67], v[24:27], v[160:163]
    v_cvt_pk_bf16_f32 v32, v32, v33
    ds_read_b64_tr_b16 a[0:1], v254 offset:0
    v_mfma_f32_16x16x32_bf16 v[164:167], a[68:71], v[24:27], v[164:167]
    v_cvt_pk_bf16_f32 v33, v34, v35
    ds_read_b64_tr_b16 a[2:3], v255 offset:0
    v_mfma_f32_16x16x32_bf16 v[168:171], a[72:75], v[24:27], v[168:171]
    v_cvt_pk_bf16_f32 v34, v36, v37
    ds_read_b64_tr_b16 a[4:5], v254 offset:8
    v_mfma_f32_16x16x32_bf16 v[172:175], a[76:79], v[24:27], v[172:175]
    v_cvt_pk_bf16_f32 v35, v38, v39
    ds_read_b64_tr_b16 a[6:7], v255 offset:8
    v_mfma_f32_16x16x32_bf16 v[176:179], a[80:83], v[24:27], v[176:179]
    ds_read_b64_tr_b16 a[8:9], v254 offset:8192
    ds_read_b64_tr_b16 a[10:11], v255 offset:8192
    v_mfma_f32_16x16x32_bf16 v[180:183], a[84:87], v[24:27], v[180:183]
    ds_read_b64_tr_b16 a[12:13], v254 offset:8200
    ds_read_b64_tr_b16 a[14:15], v255 offset:8200
    v_mfma_f32_16x16x32_bf16 v[184:187], a[88:91], v[24:27], v[184:187]
    ds_read_b64_tr_b16 a[16:17], v254 offset:16384
    ds_read_b64_tr_b16 a[18:19], v255 offset:16384
    v_mfma_f32_16x16x32_bf16 v[188:191], a[92:95], v[24:27], v[188:191]
    ds_read_b64_tr_b16 a[20:21], v254 offset:16392
    ds_read_b64_tr_b16 a[22:23], v255 offset:16392
    v_mfma_f32_16x16x32_bf16 v[228:231], v[52:55], v[24:27], v[228:231]
    ds_read_b64_tr_b16 a[24:25], v254 offset:24576
    ds_read_b64_tr_b16 a[26:27], v255 offset:24576
    v_mfma_f32_16x16x32_bf16 v[192:195], a[64:67], v[32:35], v[192:195]
    ds_read_b64_tr_b16 a[28:29], v254 offset:24584
    ds_read_b64_tr_b16 a[30:31], v255 offset:24584
    v_mfma_f32_16x16x32_bf16 v[196:199], a[68:71], v[32:35], v[196:199]
    v_rcp_f32 v60, v224
    v_mfma_f32_16x16x32_bf16 v[200:203], a[72:75], v[32:35], v[200:203]
    v_add_u32 v8, 1, v8
    ds_write_b32 v7, v8
    v_mfma_f32_16x16x32_bf16 v[204:207], a[76:79], v[32:35], v[204:207]
    v_mov_b32 v61, v60
    v_mfma_f32_16x16x32_bf16 v[208:211], a[80:83], v[32:35], v[208:211]
    v_mfma_f32_16x16x32_bf16 v[212:215], a[84:87], v[32:35], v[212:215]
    v_rcp_f32 v62, v228
    v_mfma_f32_16x16x32_bf16 v[216:219], a[88:91], v[32:35], v[216:219]
    v_mfma_f32_16x16x32_bf16 v[220:223], a[92:95], v[32:35], v[220:223]
    v_mov_b32 v63, v62
    v_mfma_f32_16x16x32_bf16 v[232:235], v[52:55], v[32:35], v[232:235]
    v_add_f32 v59, v224, v228
    s_mov_b32 s64, 1
    ds_read_b32 v9, v6
    v_pk_mul_f32 v[128:129], v[128:129], v[60:61]
    v_pk_mul_f32 v[130:131], v[130:131], v[60:61]
    v_pk_mul_f32 v[132:133], v[132:133], v[60:61]
    v_pk_mul_f32 v[134:135], v[134:135], v[60:61]
    v_cvt_pk_bf16_f32 v64, v128, v129
    v_cvt_pk_bf16_f32 v65, v130, v131
    v_cvt_pk_bf16_f32 v66, v132, v133
    v_cvt_pk_bf16_f32 v67, v134, v135
    buffer_store_dwordx4 v[64:67], v5, s[36:39], s62 offen offset:0 sc1
    v_pk_mul_f32 v[136:137], v[136:137], v[60:61]
    v_pk_mul_f32 v[138:139], v[138:139], v[60:61]
    v_pk_mul_f32 v[140:141], v[140:141], v[60:61]
    v_pk_mul_f32 v[142:143], v[142:143], v[60:61]
    v_cvt_pk_bf16_f32 v68, v136, v137
    v_cvt_pk_bf16_f32 v69, v138, v139
    v_cvt_pk_bf16_f32 v70, v140, v141
    v_cvt_pk_bf16_f32 v71, v142, v143
    buffer_store_dwordx4 v[68:71], v5, s[36:39], s62 offen offset:1024 sc1
    v_pk_mul_f32 v[144:145], v[144:145], v[60:61]
    v_pk_mul_f32 v[146:147], v[146:147], v[60:61]
    v_pk_mul_f32 v[148:149], v[148:149], v[60:61]
    v_pk_mul_f32 v[150:151], v[150:151], v[60:61]
    v_cvt_pk_bf16_f32 v72, v144, v145
    v_cvt_pk_bf16_f32 v73, v146, v147
    v_cvt_pk_bf16_f32 v74, v148, v149
    v_cvt_pk_bf16_f32 v75, v150, v151
    buffer_store_dwordx4 v[72:75], v5, s[36:39], s62 offen offset:2048 sc1
    v_pk_mul_f32 v[152:153], v[152:153], v[60:61]
    v_pk_mul_f32 v[154:155], v[154:155], v[60:61]
    v_pk_mul_f32 v[156:157], v[156:157], v[60:61]
    v_pk_mul_f32 v[158:159], v[158:159], v[60:61]
    v_cvt_pk_bf16_f32 v76, v152, v153
    v_cvt_pk_bf16_f32 v77, v154, v155
    v_cvt_pk_bf16_f32 v78, v156, v157
    v_cvt_pk_bf16_f32 v79, v158, v159
    buffer_store_dwordx4 v[76:79], v5, s[36:39], s62 offen offset:3072 sc1
    s_add_u32 s62, s62, 4096
    v_add_f32 v59, v59, v232
    v_cmp_nge_f32 vcc, s60, v59
    s_cmp_lg_u32 s70, 0
    s_cbranch_scc1 L_noflag1
    s_cmp_eq_u64 vcc, 0
    s_cselect_b32 s64, 1, 2
L_noflag1:
    v_mov_b32 v2, s64
    s_waitcnt lgkmcnt(0)
    v_cmp_gt_u32 vcc, v9, v8
    s_cbranch_vccz L_sp257
L_sp257r:
    v_pk_mul_f32 v[160:161], v[160:161], v[62:63]
    ds_read_b64_tr_b16 a[32:33], v254 offset:32768
    v_pk_mul_f32 v[162:163], v[162:163], v[62:63]
    ds_read_b64_tr_b16 a[34:35], v255 offset:32768
    v_pk_mul_f32 v[164:165], v[164:165], v[62:63]
    v_pk_mul_f32 v[166:167], v[166:167], v[62:63]
    ds_read_b64_tr_b16 a[36:37], v254 offset:32776
    v_cvt_pk_bf16_f32 v128, v160, v161
    v_cvt_pk_bf16_f32 v129, v162, v163
    ds_read_b64_tr_b16 a[38:39], v255 offset:32776
    v_cvt_pk_bf16_f32 v130, v164, v165
    v_cvt_pk_bf16_f32 v131, v166, v167
    ds_read_b64_tr_b16 a[40:41], v254 offset:40960
    buffer_store_dwordx4 v[128:131], v5, s[36:39], s62 offen offset:0 sc1
    ds_read_b64_tr_b16 a[42:43], v255 offset:40960
    ds_write_b128 v245, v[64:67] offset:49152
    ds_write_b128 v245, v[68:71] offset:50176
    ds_read_b64_tr_b16 a[44:45], v254 offset:40968
    v_pk_mul_f32 v[168:169], v[168:169], v[62:63]
    v_pk_mul_f32 v[170:171], v[170:171], v[62:63]
    ds_read_b64_tr_b16 a[46:47], v255 offset:40968
    v_pk_mul_f32 v[172:173], v[172:173], v[62:63]
    v_pk_mul_f32 v[174:175], v[174:175], v[62:63]
    ds_read_b64_tr_b16 a[48:49], v252 offset:0
    v_cvt_pk_bf16_f32 v132, v168, v169
    ds_read_b64_tr_b16 a[50:51], v253 offset:0
    v_cvt_pk_bf16_f32 v133, v170, v171
    v_cvt_pk_bf16_f32 v134, v172, v173
    ds_read_b64_tr_b16 a[52:53], v252 offset:8
    v_cvt_pk_bf16_f32 v135, v174, v175
    buffer_store_dwordx4 v[132:135], v5, s[36:39], s62 offen offset:1024 sc1
    ds_read_b64_tr_b16 a[54:55], v253 offset:8
    ds_write_b128 v245, v[72:75] offset:51200
    ds_write_b128 v245, v[76:79] offset:52224
    ds_read_b64_tr_b16 a[56:57], v252 offset:8192
    v_pk_mul_f32 v[176:177], v[176:177], v[62:63]
    ds_read_b64_tr_b16 a[58:59], v253 offset:8192
    v_pk_mul_f32 v[178:179], v[178:179], v[62:63]
    v_pk_mul_f32 v[180:181], v[180:181], v[62:63]
    ds_read_b64_tr_b16 a[60:61], v252 offset:8200
    v_pk_mul_f32 v[182:183], v[182:183], v[62:63]
    v_cvt_pk_bf16_f32 v136, v176, v177
    ds_read_b64_tr_b16 a[62:63], v253 offset:8200
    v_cvt_pk_bf16_f32 v137, v178, v179
    v_cvt_pk_bf16_f32 v138, v180, v181
    v_add_u32 v8, 1, v8
    v_cvt_pk_bf16_f32 v139, v182, v183
    buffer_store_dwordx4 v[136:139], v5, s[36:39], s62 offen offset:2048 sc1
    ds_write_b128 v246, v[128:131] offset:49152
    ds_write_b128 v246, v[132:135] offset:50176
    v_pk_mul_f32 v[184:185], v[184:185], v[62:63]
    v_pk_mul_f32 v[186:187], v[186:187], v[62:63]
    v_pk_mul_f32 v[188:189], v[188:189], v[62:63]
    v_pk_mul_f32 v[190:191], v[190:191], v[62:63]
    v_cvt_pk_bf16_f32 v140, v184, v185
    v_cvt_pk_bf16_f32 v141, v186, v187
    v_cvt_pk_bf16_f32 v142, v188, v189
    v_cvt_pk_bf16_f32 v143, v190, v191
    buffer_store_dwordx4 v[140:143], v5, s[36:39], s62 offen offset:3072 sc1
    ds_write_b128 v246, v[136:139] offset:51200
    ds_write_b128 v246, v[140:143] offset:52224
    s_add_u32 s62, s62, 4096
    v_rcp_f32 v60, v232
    s_nop 0
    v_mov_b32 v61, v60
    v_pk_mul_f32 v[192:193], v[192:193], v[60:61]
    v_pk_mul_f32 v[194:195], v[194:195], v[60:61]
    v_pk_mul_f32 v[196:197], v[196:197], v[60:61]
    v_pk_mul_f32 v[198:199], v[198:199], v[60:61]
    v_cvt_pk_bf16_f32 v144, v192, v193
    v_cvt_pk_bf16_f32 v145, v194, v195
    v_cvt_pk_bf16_f32 v146, v196, v197
    v_cvt_pk_bf16_f32 v147, v198, v199
    buffer_store_dwordx4 v[144:147], v5, s[36:39], s62 offen offset:0 sc1
    ds_write_b128 v247, v[144:147] offset:49152
    v_pk_mul_f32 v[200:201], v[200:201], v[60:61]
    v_pk_mul_f32 v[202:203], v[202:203], v[60:61]
    v_pk_mul_f32 v[204:205], v[204:205], v[60:61]
    v_pk_mul_f32 v[206:207], v[206:207], v[60:61]
    v_cvt_pk_bf16_f32 v148, v200, v201
    v_cvt_pk_bf16_f32 v149, v202, v203
    v_cvt_pk_bf16_f32 v150, v204, v205
    v_cvt_pk_bf16_f32 v151, v206, v207
    buffer_store_dwordx4 v[148:151], v5, s[36:39], s62 offen offset:1024 sc1
    ds_write_b128 v247, v[148:151] offset:50176
    v_pk_mul_f32 v[208:209], v[208:209], v[60:61]
    v_pk_mul_f32 v[210:211], v[210:211], v[60:61]
    v_pk_mul_f32 v[212:213], v[212:213], v[60:61]
    v_pk_mul_f32 v[214:215], v[214:215], v[60:61]
    v_cvt_pk_bf16_f32 v152, v208, v209
    v_cvt_pk_bf16_f32 v153, v210, v211
    v_cvt_pk_bf16_f32 v154, v212, v213
    v_cvt_pk_bf16_f32 v155, v214, v215
    buffer_store_dwordx4 v[152:155], v5, s[36:39], s62 offen offset:2048 sc1
    ds_write_b128 v247, v[152:155] offset:51200
    v_pk_mul_f32 v[216:217], v[216:217], v[60:61]
    v_pk_mul_f32 v[218:219], v[218:219], v[60:61]
    v_pk_mul_f32 v[220:221], v[220:221], v[60:61]
    v_pk_mul_f32 v[222:223], v[222:223], v[60:61]
    v_cvt_pk_bf16_f32 v156, v216, v217
    v_cvt_pk_bf16_f32 v157, v218, v219
    v_cvt_pk_bf16_f32 v158, v220, v221
    v_cvt_pk_bf16_f32 v159, v222, v223
    buffer_store_dwordx4 v[156:159], v5, s[36:39], s62 offen offset:3072 sc1
    ds_write_b128 v247, v[156:159] offset:52224
    v_mov_b32 v3, 163600
    s_cmp_eq_u32 s64, 1
    s_cbranch_scc1 L_ok1
    ds_write_b32 v3, v2
L_ok1:
    ds_read_b64 v[2:3], v3 offset:16
    v_mov_b32 v232, 0x80000000
    ds_read_b128 v[16:19], v238 offset:0
    ds_read_b128 v[20:23], v238 offset:1024
    ds_read_b128 v[24:27], v238 offset:2048
    ds_read_b128 v[28:31], v238 offset:3072
    ds_read_b128 v[32:35], v238 offset:4096
    ds_read_b128 v[36:39], v238 offset:5120
    ds_read_b128 v[40:43], v238 offset:6144
    ds_read_b128 v[44:47], v238 offset:7168
    s_waitcnt lgkmcnt(0)
    s_barrier
    v_mov_b32 v4, 163600
    ds_read_b32 v4, v4
    s_waitcnt lgkmcnt(0)
    v_cmp_ne_u32 vcc, 0, v4
    s_cbranch_vccnz L_redo
    v_readfirstlane_b32 s4, v2
    v_readfirstlane_b32 s5, v3
    s_branch L_tail
L_redo:
    s_waitcnt vmcnt(0)
    s_barrier
    v_mov_b32 v2, 0
    v_lshlrev_b32 v3, 2, v1
    v_add_u32 v3, 163584, v3
    ds_write_b32 v3, v2
    s_mul_i32 s60, s68, 40
    s_add_u32 s60, s60, 16
    v_mov_b32 v8, s60
    v_mov_b32 v10, v13
    ds_write_b32 v7, v8
    s_mov_b32 s69, 0
    s_mov_b32 s70, 1
    s_mov_b32 s100, 114688
    s_mov_b32 s101, 114688
    v_mov_b32 v56, 0xff800000
    v_mov_b32 v57, 0xff800000
    v_mov_b32 v58, 0xff800000
L_mloop:
    s_barrier
    ds_read_b128 a[0:3], v10 offset:0
    ds_read_b128 a[4:7], v10 offset:256
    ds_read_b128 a[8:11], v10 offset:512
    ds_read_b128 a[12:15], v10 offset:768
    ds_read_b128 a[16:19], v10 offset:4096
    ds_read_b128 a[20:23], v10 offset:4352
    ds_read_b128 a[24:27], v10 offset:4608
    ds_read_b128 a[28:31], v10 offset:4864
    s_waitcnt lgkmcnt(0)
    s_barrier
    v_mfma_f32_16x16x32_bf16 v[16:19], a[0:3], v[80:83], 0
    v_mfma_f32_16x16x32_bf16 v[16:19], a[4:7], v[84:87], v[16:19]
    v_mfma_f32_16x16x32_bf16 v[16:19], a[8:11], v[88:91], v[16:19]
    v_mfma_f32_16x16x32_bf16 v[16:19], a[12:15], v[92:95], v[16:19]
    v_mfma_f32_16x16x32_bf16 v[20:23], a[16:19], v[80:83], 0
    v_mfma_f32_16x16x32_bf16 v[20:23], a[20:23], v[84:87], v[20:23]
    v_mfma_f32_16x16x32_bf16 v[20:23], a[24:27], v[88:91], v[20:23]
    v_mfma_f32_16x16x32_bf16 v[20:23], a[28:31], v[92:95], v[20:23]
    v_mfma_f32_16x16x32_bf16 v[24:27], a[0:3], v[96:99], 0
    v_mfma_f32_16x16x32_bf16 v[24:27], a[4:7], v[100:103], v[24:27]
    v_mfma_f32_16x16x32_bf16 v[24:27], a[8:11], v[104:107], v[24:27]
    v_mfma_f32_16x16x32_bf16 v[24:27], a[12:15], v[108:111], v[24:27]
    v_mfma_f32_16x16x32_bf16 v[28:31], a[16:19], v[96:99], 0
    v_mfma_f32_16x16x32_bf16 v[28:31], a[20:23], v[100:103], v[28:31]
    v_mfma_f32_16x16x32_bf16 v[28:31], a[24:27], v[104:107], v[28:31]
    v_mfma_f32_16x16x32_bf16 v[28:31], a[28:31], v[108:111], v[28:31]
    v_mfma_f32_16x16x32_bf16 v[32:35], a[0:3], v[112:115], 0
    v_mfma_f32_16x16x32_bf16 v[32:35], a[4:7], v[116:119], v[32:35]
    v_mfma_f32_16x16x32_bf16 v[32:35], a[8:11], v[120:123], v[32:35]
    v_mfma_f32_16x16x32_bf16 v[32:35], a[12:15], v[124:127], v[32:35]
    v_mfma_f32_16x16x32_bf16 v[36:39], a[16:19], v[112:115], 0
    v_mfma_f32_16x16x32_bf16 v[36:39], a[20:23], v[116:119], v[36:39]
    v_mfma_f32_16x16x32_bf16 v[36:39], a[24:27], v[120:123], v[36:39]
    v_mfma_f32_16x16x32_bf16 v[36:39], a[28:31], v[124:127], v[36:39]
    s_nop 7
    v_max3_f32 v56, v16, v17, v56
    v_max3_f32 v56, v18, v19, v56
    v_max3_f32 v56, v20, v21, v56
    v_max3_f32 v56, v22, v23, v56
    v_max3_f32 v57, v24, v25, v57
    v_max3_f32 v57, v26, v27, v57
    v_max3_f32 v57, v28, v29, v57
    v_max3_f32 v57, v30, v31, v57
    v_max3_f32 v58, v32, v33, v58
    v_max3_f32 v58, v34, v35, v58
    v_max3_f32 v58, v36, v37, v58
    v_max3_f32 v58, v38, v39, v58
    s_add_u32 s69, s69, 1
    s_cmp_lt_u32 s69, 32
    s_cbranch_scc1 L_mloop
    s_mul_i32 s66, s68, 98304
    v_add_u32 v10, s66, v13
    v_add_u32 v11, s66, v14
    v_add_u32 v12, s66, v15
    ds_read_b32 v9, v6
    s_waitcnt lgkmcnt(0)
    v_cmp_gt_u32 vcc, v9, v8
    s_cbranch_vccz L_sp258
L_sp258r:
    ds_read_b128 a[0:3], v10 offset:0
    ds_read_b128 a[4:7], v10 offset:256
    ds_read_b128 a[8:11], v10 offset:512
    ds_read_b128 a[12:15], v10 offset:768
    ds_read_b128 a[16:19], v10 offset:4096
    ds_read_b128 a[20:23], v10 offset:4352
    ds_read_b128 a[24:27], v10 offset:4608
    ds_read_b128 a[28:31], v10 offset:4864
    v_add_u32 v8, 1, v8
    ds_write_b32 v7, v8
    s_add_u32 s66, s66, 16384
    s_cmp_eq_u32 s66, s100
    s_cselect_b32 s66, 0, s66
    v_add_u32 v10, s66, v13
    v_add_u32 v11, s66, v14
    v_add_u32 v12, s66, v15
    ds_read_b32 v9, v6
    s_waitcnt lgkmcnt(0)
    v_cmp_gt_u32 vcc, v9, v8
    s_cbranch_vccz L_sp259
L_sp259r:
    s_branch L_item
L_tail:
    s_mul_i32 s64, s3, 3072
    s_lshl_b32 s65, s76, 13
    s_add_u32 s65, s65, 4096
    s_mov_b32 s63, 32768
    s_waitcnt lgkmcnt(4)
    v_mfma_f32_16x16x32_bf16 v[160:163], a[128:131], v[16:19], 0
    ds_read_b128 v[80:83], v239 offset:0
    s_lshl_b32 s69, s3, 11
    v_mfma_f32_16x16x32_bf16 v[196:199], a[132:135], v[16:19], 0
    ds_read_b128 v[84:87], v239 offset:1024
    s_add_u32 m0, s64, 110592
    v_mfma_f32_16x16x32_bf16 v[160:163], a[136:139], v[20:23], v[160:163]
    buffer_load_dwordx4 v242, s[40:43], s63 offen offset:0 sc1 lds
    v_mfma_f32_16x16x32_bf16 v[196:199], a[140:143], v[20:23], v[196:199]
    ds_read_b128 v[88:91], v239 offset:2048
    s_add_u32 s60, s77, 2
    v_mfma_f32_16x16x32_bf16 v[160:163], a[144:147], v[24:27], v[160:163]
    ds_read_b128 v[92:95], v239 offset:3072
    s_and_b32 s60, s60, 3
    v_mfma_f32_16x16x32_bf16 v[196:199], a[148:151], v[24:27], v[196:199]
    s_lshl_b32 s66, s60, 18
    s_add_u32 s60, s77, 3
    v_mfma_f32_16x16x32_bf16 v[160:163], a[152:155], v[28:31], v[160:163]
    buffer_load_dwordx4 v243, s[40:43], s63 offen offset:1024 sc1 lds
    v_mfma_f32_16x16x32_bf16 v[196:199], a[156:159], v[28:31], v[196:199]
    s_and_b32 s60, s60, 3
    s_lshl_b32 s67, s60, 18
    s_waitcnt lgkmcnt(4)
    v_mfma_f32_16x16x32_bf16 v[164:167], a[128:131], v[32:35], 0
    ds_read_b128 v[16:19], v239 offset:4096
    s_lshl_b32 s68, s79, 13
    v_mfma_f32_16x16x32_bf16 v[200:203], a[132:135], v[32:35], 0
    ds_read_b128 v[20:23], v239 offset:5120
    s_add_u32 s60, s79, 4
    v_mfma_f32_16x16x32_bf16 v[164:167], a[136:139], v[36:39], v[164:167]
    buffer_load_dwordx4 v244, s[40:43], s63 offen offset:2048 sc1 lds
    v_mfma_f32_16x16x32_bf16 v[200:203], a[140:143], v[36:39], v[200:203]
    ds_read_b128 v[24:27], v239 offset:6144
    s_and_b32 s60, s60, 15
    v_mfma_f32_16x16x32_bf16 v[164:167], a[144:147], v[40:43], v[164:167]
    ds_read_b128 v[28:31], v239 offset:7168
    s_and_b32 s61, s79, 0xf0
    v_mfma_f32_16x16x32_bf16 v[200:203], a[148:151], v[40:43], v[200:203]
    s_add_u32 m0, s69, 16384
    s_add_u32 s63, s66, 0
    v_mfma_f32_16x16x32_bf16 v[164:167], a[152:155], v[44:47], v[164:167]
    buffer_load_dwordx4 v248, s[32:35], s63 offen offset:0 lds
    v_mfma_f32_16x16x32_bf16 v[200:203], a[156:159], v[44:47], v[200:203]
    s_add_u32 s60, s60, s61
    s_mul_i32 s60, s60, 49152
    s_waitcnt lgkmcnt(4)
    v_mfma_f32_16x16x32_bf16 v[168:171], a[128:131], v[80:83], 0
    ds_read_b128 v[32:35], v240 offset:0
    s_add_u32 s61, s3, 0
    v_mfma_f32_16x16x32_bf16 v[204:207], a[132:135], v[80:83], 0
    ds_read_b128 v[36:39], v240 offset:1024
    s_lshl_b32 s61, s61, 12
    v_mfma_f32_16x16x32_bf16 v[168:171], a[136:139], v[84:87], v[168:171]
    buffer_load_dwordx4 v249, s[32:35], s63 offen offset:1024 lds
    v_mfma_f32_16x16x32_bf16 v[204:207], a[140:143], v[84:87], v[204:207]
    ds_read_b128 v[40:43], v240 offset:2048
    s_add_u32 s80, s60, s61
    v_mfma_f32_16x16x32_bf16 v[168:171], a[144:147], v[88:91], v[168:171]
    ds_read_b128 v[44:47], v240 offset:3072
    s_add_u32 s60, s79, 8
    v_mfma_f32_16x16x32_bf16 v[204:207], a[148:151], v[88:91], v[204:207]
    s_add_u32 m0, s69, 24576
    s_add_u32 s63, s66, 32768
    v_mfma_f32_16x16x32_bf16 v[168:171], a[152:155], v[92:95], v[168:171]
    buffer_load_dwordx4 v248, s[32:35], s63 offen offset:0 lds
    v_mfma_f32_16x16x32_bf16 v[204:207], a[156:159], v[92:95], v[204:207]
    s_and_b32 s60, s60, 15
    s_and_b32 s61, s79, 0xf0
    s_waitcnt lgkmcnt(4)
    v_mfma_f32_16x16x32_bf16 v[172:175], a[128:131], v[16:19], 0
    ds_read_b128 v[80:83], v240 offset:4096
    s_and_b32 s70, s79, 0xfc
    s_lshl_b32 s70, s70, 13
    v_mfma_f32_16x16x32_bf16 v[208:211], a[132:135], v[16:19], 0
    ds_read_b128 v[84:87], v240 offset:5120
    s_lshl_b32 s71, s77, 2
    s_add_u32 s71, s71, s3
    v_mfma_f32_16x16x32_bf16 v[172:175], a[136:139], v[20:23], v[172:175]
    buffer_load_dwordx4 v249, s[32:35], s63 offen offset:1024 lds
    v_mfma_f32_16x16x32_bf16 v[208:211], a[140:143], v[20:23], v[208:211]
    ds_read_b128 v[88:91], v240 offset:6144
    s_lshl_b32 s71, s71, 7
    s_add_u32 s70, s70, s71
    s_add_u32 s70, s70, 2048
    v_mfma_f32_16x16x32_bf16 v[172:175], a[144:147], v[24:27], v[172:175]
    ds_read_b128 v[92:95], v240 offset:7168
    s_add_u32 m0, s69, 32768
    s_add_u32 s63, s66, 65536
    s_cmp_eq_u32 s3, 3
    s_cselect_b32 s70, 0x80000000, s70
    v_mfma_f32_16x16x32_bf16 v[208:211], a[148:151], v[24:27], v[208:211]
    buffer_load_dwordx4 v248, s[32:35], s63 offen offset:0 lds
    v_lshlrev_b32 v4, 13, v1
    v_mov_b32 v60, s4
    v_mov_b32 v61, s5
    v_mfma_f32_16x16x32_bf16 v[172:175], a[152:155], v[28:31], v[172:175]
    v_mfma_f32_16x16x32_bf16 v[208:211], a[156:159], v[28:31], v[208:211]
    s_cmp_eq_u32 s3, 3
    s_cbranch_scc1 L_nw
    s_waitcnt vmcnt(8)
L_nw:
    s_mov_b64 exec, 15
    buffer_store_dwordx2 v[60:61], v4, s[52:55], s70 offen sc1
    s_mov_b64 exec, -1
    s_waitcnt lgkmcnt(4)
    v_mfma_f32_16x16x32_bf16 v[176:179], a[128:131], v[32:35], 0
    ds_read_b128 v[16:19], v241 offset:0
    s_add_u32 s60, s60, s61
    v_mfma_f32_16x16x32_bf16 v[212:215], a[132:135], v[32:35], 0
    ds_read_b128 v[20:23], v241 offset:1024
    s_mul_i32 s60, s60, 49152
    v_mfma_f32_16x16x32_bf16 v[176:179], a[136:139], v[36:39], v[176:179]
    buffer_load_dwordx4 v249, s[32:35], s63 offen offset:1024 lds
    v_mfma_f32_16x16x32_bf16 v[212:215], a[140:143], v[36:39], v[212:215]
    ds_read_b128 v[24:27], v241 offset:2048
    s_add_u32 s61, s3, 4
    v_mfma_f32_16x16x32_bf16 v[176:179], a[144:147], v[40:43], v[176:179]
    ds_read_b128 v[28:31], v241 offset:3072
    s_lshl_b32 s61, s61, 12
    v_mfma_f32_16x16x32_bf16 v[212:215], a[148:151], v[40:43], v[212:215]
    s_add_u32 m0, s69, 40960
    s_add_u32 s63, s66, 98304
    v_mfma_f32_16x16x32_bf16 v[176:179], a[152:155], v[44:47], v[176:179]
    buffer_load_dwordx4 v248, s[32:35], s63 offen offset:0 lds
    v_mfma_f32_16x16x32_bf16 v[212:215], a[156:159], v[44:47], v[212:215]
    s_add_u32 s81, s60, s61
    s_add_u32 s60, s79, 12
    s_waitcnt lgkmcnt(4)
    v_mfma_f32_16x16x32_bf16 v[180:183], a[128:131], v[80:83], 0
    ds_read_b128 v[32:35], v241 offset:4096
    s_and_b32 s60, s60, 15
    v_mfma_f32_16x16x32_bf16 v[216:219], a[132:135], v[80:83], 0
    ds_read_b128 v[36:39], v241 offset:5120
    s_and_b32 s61, s79, 0xf0
    v_mfma_f32_16x16x32_bf16 v[180:183], a[136:139], v[84:87], v[180:183]
    buffer_load_dwordx4 v249, s[32:35], s63 offen offset:1024 lds
    v_mfma_f32_16x16x32_bf16 v[216:219], a[140:143], v[84:87], v[216:219]
    ds_read_b128 v[40:43], v241 offset:6144
    s_add_u32 s60, s60, s61
    v_mfma_f32_16x16x32_bf16 v[180:183], a[144:147], v[88:91], v[180:183]
    ds_read_b128 v[44:47], v241 offset:7168
    s_mul_i32 s60, s60, 49152
    v_mfma_f32_16x16x32_bf16 v[216:219], a[148:151], v[88:91], v[216:219]
    s_add_u32 m0, s69, 0
    s_add_u32 s63, s67, 0
    v_mfma_f32_16x16x32_bf16 v[180:183], a[152:155], v[92:95], v[180:183]
    buffer_load_dwordx4 v248, s[32:35], s63 offen offset:0 lds
    v_mfma_f32_16x16x32_bf16 v[216:219], a[156:159], v[92:95], v[216:219]
    s_add_u32 s61, s3, 8
    s_lshl_b32 s61, s61, 12
    s_waitcnt lgkmcnt(4)
    v_mfma_f32_16x16x32_bf16 v[184:187], a[128:131], v[16:19], 0
    ds_read_b128 v[80:83], v237 offset:24576
    s_add_u32 s82, s60, s61
    v_mfma_f32_16x16x32_bf16 v[220:223], a[132:135], v[16:19], 0
    ds_read_b128 v[84:87], v237 offset:25600
    s_sub_u32 s60, s3, s76
    v_mfma_f32_16x16x32_bf16 v[184:187], a[136:139], v[20:23], v[184:187]
    buffer_load_dwordx4 v249, s[32:35], s63 offen offset:1024 lds
    v_mfma_f32_16x16x32_bf16 v[220:223], a[140:143], v[20:23], v[220:223]
    ds_read_b128 v[88:91], v237 offset:26624
    s_and_b32 s60, s60, 3
    v_mfma_f32_16x16x32_bf16 v[184:187], a[144:147], v[24:27], v[184:187]
    ds_read_b128 v[92:95], v237 offset:27648
    s_cmp_eq_u32 s60, 1
    s_cselect_b32 s83, s80, s81
    v_mfma_f32_16x16x32_bf16 v[220:223], a[148:151], v[24:27], v[220:223]
    s_add_u32 m0, s69, 8192
    s_add_u32 s63, s67, 32768
    v_mfma_f32_16x16x32_bf16 v[184:187], a[152:155], v[28:31], v[184:187]
    buffer_load_dwordx4 v248, s[32:35], s63 offen offset:0 lds
    v_mfma_f32_16x16x32_bf16 v[220:223], a[156:159], v[28:31], v[220:223]
    s_cmp_eq_u32 s60, 3
    s_cselect_b32 s83, s82, s83
    s_waitcnt lgkmcnt(4)
    v_mfma_f32_16x16x32_bf16 v[188:191], a[128:131], v[32:35], 0
    ds_read_b128 v[16:19], v5 offset:49152
    s_add_u32 s83, s83, 3072
    v_mfma_f32_16x16x32_bf16 v[224:227], a[132:135], v[32:35], 0
    ds_read_b128 v[20:23], v5 offset:50176
    s_cmp_eq_u32 s60, 0
    s_cselect_b32 s83, 0x80000000, s83
    v_mfma_f32_16x16x32_bf16 v[188:191], a[136:139], v[36:39], v[188:191]
    buffer_load_dwordx4 v249, s[32:35], s63 offen offset:1024 lds
    v_mfma_f32_16x16x32_bf16 v[224:227], a[140:143], v[36:39], v[224:227]
    ds_read_b128 v[24:27], v5 offset:51200
    v_bfe_u32 v13, v1, 2, 2
    v_mfma_f32_16x16x32_bf16 v[188:191], a[144:147], v[40:43], v[188:191]
    ds_read_b128 v[28:31], v5 offset:52224
    v_lshrrev_b32 v14, 4, v1
    v_mfma_f32_16x16x32_bf16 v[224:227], a[148:151], v[40:43], v[224:227]
    s_add_u32 m0, s69, 86016
    s_add_u32 s63, s67, 65536
    v_mfma_f32_16x16x32_bf16 v[188:191], a[152:155], v[44:47], v[188:191]
    buffer_load_dwordx4 v248, s[32:35], s63 offen offset:0 lds
    v_mfma_f32_16x16x32_bf16 v[224:227], a[156:159], v[44:47], v[224:227]
    v_cmp_eq_u32 vcc, v13, v14
    v_and_b32 v13, 1, v1
    s_waitcnt lgkmcnt(4)
    v_mfma_f32_16x16x32_bf16 v[192:195], a[128:131], v[80:83], 0
    ds_read_b128 v[32:35], v5 offset:53248
    v_lshlrev_b32 v13, 4, v13
    v_mfma_f32_16x16x32_bf16 v[228:231], a[132:135], v[80:83], 0
    ds_read_b128 v[36:39], v5 offset:54272
    v_mov_b32 v14, 0x3f80
    v_mfma_f32_16x16x32_bf16 v[192:195], a[136:139], v[84:87], v[192:195]
    buffer_load_dwordx4 v249, s[32:35], s63 offen offset:1024 lds
    v_mfma_f32_16x16x32_bf16 v[228:231], a[140:143], v[84:87], v[228:231]
    ds_read_b128 v[40:43], v5 offset:55296
    v_lshlrev_b32 v13, v13, v14
    v_mfma_f32_16x16x32_bf16 v[192:195], a[144:147], v[88:91], v[192:195]
    ds_read_b128 v[44:47], v5 offset:56320
    v_cndmask_b32 v13, 0, v13, vcc
    v_mfma_f32_16x16x32_bf16 v[228:231], a[148:151], v[88:91], v[228:231]
    s_add_u32 m0, s69, 94208
    s_add_u32 s63, s67, 98304
    v_mfma_f32_16x16x32_bf16 v[192:195], a[152:155], v[92:95], v[192:195]
    buffer_load_dwordx4 v248, s[32:35], s63 offen offset:0 lds
    v_mfma_f32_16x16x32_bf16 v[228:231], a[156:159], v[92:95], v[228:231]
    v_and_b32 v14, 2, v1
    v_cmp_eq_u32 vcc, 0, v14
    s_waitcnt lgkmcnt(4)
    v_mfma_f32_16x16x32_bf16 v[160:163], a[0:3], v[16:19], v[160:163]
    ds_read_b128 v[80:83], v5 offset:57344
    v_mov_b32 v98, 0
    v_mfma_f32_16x16x32_bf16 v[196:199], a[4:7], v[16:19], v[196:199]
    ds_read_b128 v[84:87], v5 offset:58368
    v_mov_b32 v99, 0
    v_mfma_f32_16x16x32_bf16 v[160:163], a[8:11], v[20:23], v[160:163]
    buffer_load_dwordx4 v249, s[32:35], s63 offen offset:1024 lds
    v_mfma_f32_16x16x32_bf16 v[196:199], a[12:15], v[20:23], v[196:199]
    ds_read_b128 v[88:91], v5 offset:59392
    v_cndmask_b32 v96, 0, v13, vcc
    v_mfma_f32_16x16x32_bf16 v[160:163], a[16:19], v[24:27], v[160:163]
    ds_read_b128 v[92:95], v5 offset:60416
    v_sub_u32 v97, v13, v96
    v_mfma_f32_16x16x32_bf16 v[196:199], a[20:23], v[24:27], v[196:199]
    v_mov_b32 v100, 0
    v_mov_b32 v101, 0
    v_mfma_f32_16x16x32_bf16 v[160:163], a[24:27], v[28:31], v[160:163]
    v_mov_b32 v102, v96
    v_mov_b32 v103, v97
    v_mfma_f32_16x16x32_bf16 v[196:199], a[28:31], v[28:31], v[196:199]
    v_mov_b32 v115, s4
    v_mov_b32 v119, s4
    s_barrier
    s_waitcnt lgkmcnt(4)
    v_mfma_f32_16x16x32_bf16 v[164:167], a[0:3], v[32:35], v[164:167]
    ds_read_b128 v[16:19], v5 offset:61440
    s_add_u32 s62, s65, 4096
    v_mfma_f32_16x16x32_bf16 v[200:203], a[4:7], v[32:35], v[200:203]
    ds_read_b128 v[20:23], v5 offset:62464
    s_and_b32 s62, s62, 0x7fff
    s_add_u32 m0, s64, 122880
    v_mfma_f32_16x16x32_bf16 v[164:167], a[8:11], v[36:39], v[164:167]
    buffer_load_dwordx4 v242, s[40:43], s62 offen offset:0 sc1 lds
    v_mfma_f32_16x16x32_bf16 v[200:203], a[12:15], v[36:39], v[200:203]
    ds_read_b128 v[24:27], v5 offset:63488
    v_mov_b32 v123, s4
    v_mfma_f32_16x16x32_bf16 v[164:167], a[16:19], v[40:43], v[164:167]
    ds_read_b128 v[28:31], v5 offset:64512
    v_and_b32 v13, 3, v1
    v_mfma_f32_16x16x32_bf16 v[200:203], a[20:23], v[40:43], v[200:203]
    v_min_u32 v13, 2, v13
    v_lshlrev_b32 v13, 14, v13
    v_mfma_f32_16x16x32_bf16 v[164:167], a[24:27], v[44:47], v[164:167]
    buffer_load_dwordx4 v243, s[40:43], s62 offen offset:1024 sc1 lds
    v_mfma_f32_16x16x32_bf16 v[200:203], a[28:31], v[44:47], v[200:203]
    v_add_u32 v10, 3068, v13
    v_and_b32 v13, 15, v1
    s_waitcnt lgkmcnt(4)
    v_mfma_f32_16x16x32_bf16 v[168:171], a[0:3], v[80:83], v[168:171]
    ds_read_b128 v[32:35], v236 offset:0
    v_lshlrev_b32 v13, 10, v13
    v_mfma_f32_16x16x32_bf16 v[204:207], a[4:7], v[80:83], v[204:207]
    ds_read_b128 v[36:39], v236 offset:1024
    v_lshrrev_b32 v14, 4, v1
    v_mfma_f32_16x16x32_bf16 v[168:171], a[8:11], v[84:87], v[168:171]
    buffer_load_dwordx4 v244, s[40:43], s62 offen offset:2048 sc1 lds
    v_mfma_f32_16x16x32_bf16 v[204:207], a[12:15], v[84:87], v[204:207]
    ds_read_b128 v[40:43], v236 offset:2048
    v_lshl_add_u32 v13, v14, 4, v13
    v_mfma_f32_16x16x32_bf16 v[168:171], a[16:19], v[88:91], v[168:171]
    ds_read_b128 v[44:47], v236 offset:3072
    s_add_u32 s62, s65, 8192
    v_mfma_f32_16x16x32_bf16 v[204:207], a[20:23], v[88:91], v[204:207]
    s_and_b32 s62, s62, 0x7fff
    s_add_u32 m0, s64, 135168
    v_mfma_f32_16x16x32_bf16 v[168:171], a[24:27], v[92:95], v[168:171]
    buffer_load_dwordx4 v242, s[40:43], s62 offen offset:0 sc1 lds
    v_mfma_f32_16x16x32_bf16 v[204:207], a[28:31], v[92:95], v[204:207]
    s_lshl_b32 s60, s3, 6
    v_add_u32 v12, s60, v13
    s_waitcnt lgkmcnt(4)
    v_mfma_f32_16x16x32_bf16 v[172:175], a[0:3], v[16:19], v[172:175]
    ds_read_b128 v[80:83], v236 offset:4096
    v_mfma_f32_16x16x32_bf16 v[208:211], a[4:7], v[16:19], v[208:211]
    ds_read_b128 v[84:87], v236 offset:5120
    v_mfma_f32_16x16x32_bf16 v[172:175], a[8:11], v[20:23], v[172:175]
    buffer_load_dwordx4 v243, s[40:43], s62 offen offset:1024 sc1 lds
    v_mfma_f32_16x16x32_bf16 v[208:211], a[12:15], v[20:23], v[208:211]
    ds_read_b128 v[88:91], v236 offset:6144
    v_mfma_f32_16x16x32_bf16 v[172:175], a[16:19], v[24:27], v[172:175]
    ds_read_b128 v[92:95], v236 offset:7168
    v_mfma_f32_16x16x32_bf16 v[208:211], a[20:23], v[24:27], v[208:211]
    v_mfma_f32_16x16x32_bf16 v[172:175], a[24:27], v[28:31], v[172:175]
    buffer_load_dwordx4 v244, s[40:43], s62 offen offset:2048 sc1 lds
    v_mfma_f32_16x16x32_bf16 v[208:211], a[28:31], v[28:31], v[208:211]
    s_waitcnt lgkmcnt(4)
    v_mfma_f32_16x16x32_bf16 v[176:179], a[0:3], v[32:35], v[176:179]
    ds_read_b128 v[16:19], v236 offset:8192
    s_add_u32 s62, s65, 12288
    v_mfma_f32_16x16x32_bf16 v[212:215], a[4:7], v[32:35], v[212:215]
    ds_read_b128 v[20:23], v236 offset:9216
    s_and_b32 s62, s62, 0x7fff
    s_add_u32 m0, s64, 147456
    v_mfma_f32_16x16x32_bf16 v[176:179], a[8:11], v[36:39], v[176:179]
    buffer_load_dwordx4 v242, s[40:43], s62 offen offset:0 sc1 lds
    v_mfma_f32_16x16x32_bf16 v[212:215], a[12:15], v[36:39], v[212:215]
    ds_read_b128 v[24:27], v236 offset:10240
    v_mfma_f32_16x16x32_bf16 v[176:179], a[16:19], v[40:43], v[176:179]
    ds_read_b128 v[28:31], v236 offset:11264
    v_mfma_f32_16x16x32_bf16 v[212:215], a[20:23], v[40:43], v[212:215]
    v_mfma_f32_16x16x32_bf16 v[176:179], a[24:27], v[44:47], v[176:179]
    buffer_load_dwordx4 v243, s[40:43], s62 offen offset:1024 sc1 lds
    v_mfma_f32_16x16x32_bf16 v[212:215], a[28:31], v[44:47], v[212:215]
    s_waitcnt lgkmcnt(4)
    v_mfma_f32_16x16x32_bf16 v[180:183], a[0:3], v[80:83], v[180:183]
    ds_read_b128 v[32:35], v236 offset:12288
    v_mfma_f32_16x16x32_bf16 v[216:219], a[4:7], v[80:83], v[216:219]
    ds_read_b128 v[36:39], v236 offset:13312
    v_mfma_f32_16x16x32_bf16 v[180:183], a[8:11], v[84:87], v[180:183]
    v_mfma_f32_16x16x32_bf16 v[216:219], a[12:15], v[84:87], v[216:219]
    ds_read_b128 v[40:43], v236 offset:14336
    v_mfma_f32_16x16x32_bf16 v[180:183], a[16:19], v[88:91], v[180:183]
    ds_read_b128 v[44:47], v236 offset:15360
    v_mfma_f32_16x16x32_bf16 v[216:219], a[20:23], v[88:91], v[216:219]
    buffer_load_dwordx4 v244, s[40:43], s62 offen offset:2048 sc1 lds
    v_mfma_f32_16x16x32_bf16 v[180:183], a[24:27], v[92:95], v[180:183]
    v_mfma_f32_16x16x32_bf16 v[216:219], a[28:31], v[92:95], v[216:219]
    s_waitcnt lgkmcnt(4)
    v_mfma_f32_16x16x32_bf16 v[184:187], a[0:3], v[16:19], v[184:187]
    ds_read_b128 v[80:83], v236 offset:16384
    v_mfma_f32_16x16x32_bf16 v[220:223], a[4:7], v[16:19], v[220:223]
    ds_read_b128 v[84:87], v236 offset:17408
    v_mfma_f32_16x16x32_bf16 v[184:187], a[8:11], v[20:23], v[184:187]
    v_mfma_f32_16x16x32_bf16 v[220:223], a[12:15], v[20:23], v[220:223]
    ds_read_b128 v[88:91], v236 offset:18432
    v_mfma_f32_16x16x32_bf16 v[184:187], a[16:19], v[24:27], v[184:187]
    ds_read_b128 v[92:95], v236 offset:19456
    v_mfma_f32_16x16x32_bf16 v[220:223], a[20:23], v[24:27], v[220:223]
    v_mfma_f32_16x16x32_bf16 v[184:187], a[24:27], v[28:31], v[184:187]
    v_mfma_f32_16x16x32_bf16 v[220:223], a[28:31], v[28:31], v[220:223]
    s_waitcnt vmcnt(17)
    s_barrier
    s_waitcnt lgkmcnt(4)
    v_mfma_f32_16x16x32_bf16 v[188:191], a[0:3], v[32:35], v[188:191]
    ds_read_b128 v[16:19], v236 offset:45056
    ds_read_b64_tr_b16 a[64:65], v252 offset:16384
    v_mfma_f32_16x16x32_bf16 v[224:227], a[4:7], v[32:35], v[224:227]
    ds_read_b128 v[20:23], v236 offset:46080
    ds_read_b64_tr_b16 a[66:67], v253 offset:16384
    v_mfma_f32_16x16x32_bf16 v[188:191], a[8:11], v[36:39], v[188:191]
    ds_read_b64_tr_b16 a[68:69], v252 offset:16392
    ds_read_b64_tr_b16 a[70:71], v253 offset:16392
    v_mfma_f32_16x16x32_bf16 v[224:227], a[12:15], v[36:39], v[224:227]
    ds_read_b128 v[24:27], v236 offset:47104
    s_add_u32 s62, s65, 16384
    v_mfma_f32_16x16x32_bf16 v[188:191], a[16:19], v[40:43], v[188:191]
    ds_read_b128 v[28:31], v236 offset:48128
    s_and_b32 s62, s62, 0x7fff
    s_add_u32 m0, s64, 49152
    v_mfma_f32_16x16x32_bf16 v[224:227], a[20:23], v[40:43], v[224:227]
    buffer_load_dwordx4 v242, s[40:43], s62 offen offset:0 sc1 lds
    v_mfma_f32_16x16x32_bf16 v[188:191], a[24:27], v[44:47], v[188:191]
    ds_read_b64_tr_b16 a[72:73], v252 offset:24576
    ds_read_b64_tr_b16 a[74:75], v253 offset:24576
    v_mfma_f32_16x16x32_bf16 v[224:227], a[28:31], v[44:47], v[224:227]
    ds_read_b64_tr_b16 a[76:77], v252 offset:24584
    ds_read_b64_tr_b16 a[78:79], v253 offset:24584
    s_waitcnt lgkmcnt(12)
    v_mfma_f32_16x16x32_bf16 v[192:195], a[0:3], v[80:83], v[192:195]
    ds_read_b128 v[32:35], v236 offset:49152
    ds_read_b64_tr_b16 a[80:81], v252 offset:32768
    v_mfma_f32_16x16x32_bf16 v[228:231], a[4:7], v[80:83], v[228:231]
    ds_read_b128 v[36:39], v236 offset:50176
    ds_read_b64_tr_b16 a[82:83], v253 offset:32768
    v_mfma_f32_16x16x32_bf16 v[192:195], a[8:11], v[84:87], v[192:195]
    ds_read_b64_tr_b16 a[84:85], v252 offset:32776
    ds_read_b64_tr_b16 a[86:87], v253 offset:32776
    v_mfma_f32_16x16x32_bf16 v[228:231], a[12:15], v[84:87], v[228:231]
    ds_read_b128 v[40:43], v236 offset:51200
    ds_read_b64_tr_b16 a[88:89], v252 offset:40960
    v_mfma_f32_16x16x32_bf16 v[192:195], a[16:19], v[88:91], v[192:195]
    ds_read_b128 v[44:47], v236 offset:52224
    ds_read_b64_tr_b16 a[90:91], v253 offset:40960
    v_mfma_f32_16x16x32_bf16 v[228:231], a[20:23], v[88:91], v[228:231]
    buffer_load_dwordx4 v243, s[40:43], s62 offen offset:1024 sc1 lds
    v_mfma_f32_16x16x32_bf16 v[192:195], a[24:27], v[92:95], v[192:195]
    ds_read_b64_tr_b16 a[92:93], v252 offset:40968
    ds_read_b64_tr_b16 a[94:95], v253 offset:40968
    v_mfma_f32_16x16x32_bf16 v[228:231], a[28:31], v[92:95], v[228:231]
    s_waitcnt lgkmcnt(15)
    v_mfma_f32_16x16x32_bf16 v[192:195], a[160:163], v[16:19], v[192:195]
    ds_read_b128 v[80:83], v236 offset:53248
    v_mfma_f32_16x16x32_bf16 v[228:231], a[164:167], v[16:19], v[228:231]
    ds_read_b128 v[84:87], v236 offset:54272
    v_mfma_f32_16x16x32_bf16 v[192:195], a[168:171], v[20:23], v[192:195]
    v_mfma_f32_16x16x32_bf16 v[228:231], a[172:175], v[20:23], v[228:231]
    ds_read_b128 v[88:91], v236 offset:55296
    v_mfma_f32_16x16x32_bf16 v[192:195], a[176:179], v[24:27], v[192:195]
    ds_read_b128 v[92:95], v236 offset:56320
    v_mfma_f32_16x16x32_bf16 v[228:231], a[180:183], v[24:27], v[228:231]
    buffer_load_dwordx4 v244, s[40:43], s62 offen offset:2048 sc1 lds
    v_mfma_f32_16x16x32_bf16 v[192:195], a[184:187], v[28:31], v[192:195]
    v_mfma_f32_16x16x32_bf16 v[228:231], a[188:191], v[28:31], v[228:231]
    s_waitcnt vmcnt(9)
    s_barrier
    s_waitcnt lgkmcnt(7)
    v_mfma_f32_16x16x32_bf16 v[192:195], a[192:195], v[32:35], v[192:195]
    ds_read_b128 v[16:19], v236 offset:57344
    s_add_u32 s62, s65, 20480
    v_mfma_f32_16x16x32_bf16 v[228:231], a[196:199], v[32:35], v[228:231]
    ds_read_b128 v[20:23], v236 offset:58368
    s_and_b32 s62, s62, 0x7fff
    s_add_u32 m0, s64, 61440
    v_mfma_f32_16x16x32_bf16 v[192:195], a[200:203], v[36:39], v[192:195]
    buffer_load_dwordx4 v242, s[40:43], s62 offen offset:0 sc1 lds
    v_mfma_f32_16x16x32_bf16 v[228:231], a[204:207], v[36:39], v[228:231]
    ds_read_b128 v[24:27], v236 offset:59392
    v_mfma_f32_16x16x32_bf16 v[192:195], a[208:211], v[40:43], v[192:195]
    ds_read_b128 v[28:31], v236 offset:60416
    v_mfma_f32_16x16x32_bf16 v[228:231], a[212:215], v[40:43], v[228:231]
    v_mfma_f32_16x16x32_bf16 v[192:195], a[216:219], v[44:47], v[192:195]
    v_mfma_f32_16x16x32_bf16 v[228:231], a[220:223], v[44:47], v[228:231]
    buffer_load_dwordx2 v[2:3], v232, s[52:55], s68 offen offset:2048 sc1
    s_waitcnt lgkmcnt(4)
    v_mfma_f32_16x16x32_bf16 v[192:195], a[224:227], v[80:83], v[192:195]
    ds_read_b128 v[32:35], v236 offset:61440
    v_mfma_f32_16x16x32_bf16 v[228:231], a[228:231], v[80:83], v[228:231]
    ds_read_b128 v[36:39], v236 offset:62464
    v_mfma_f32_16x16x32_bf16 v[192:195], a[232:235], v[84:87], v[192:195]
    v_mfma_f32_16x16x32_bf16 v[228:231], a[236:239], v[84:87], v[228:231]
    ds_read_b128 v[40:43], v236 offset:63488
    v_mfma_f32_16x16x32_bf16 v[192:195], a[240:243], v[88:91], v[192:195]
    ds_read_b128 v[44:47], v236 offset:64512
    v_mfma_f32_16x16x32_bf16 v[228:231], a[244:247], v[88:91], v[228:231]
    buffer_load_dwordx4 v243, s[40:43], s62 offen offset:1024 sc1 lds
    v_mfma_f32_16x16x32_bf16 v[192:195], a[248:251], v[92:95], v[192:195]
    v_mfma_f32_16x16x32_bf16 v[228:231], a[252:255], v[92:95], v[228:231]
    s_waitcnt lgkmcnt(4)
    v_mfma_f32_16x16x32_bf16 v[160:163], a[160:163], v[16:19], v[160:163]
    ds_read_b128 v[80:83], v237 offset:0
    v_mfma_f32_16x16x32_bf16 v[196:199], a[164:167], v[16:19], v[196:199]
    ds_read_b128 v[84:87], v237 offset:1024
    v_mfma_f32_16x16x32_bf16 v[160:163], a[168:171], v[20:23], v[160:163]
    v_mfma_f32_16x16x32_bf16 v[196:199], a[172:175], v[20:23], v[196:199]
    ds_read_b128 v[88:91], v237 offset:2048
    v_mfma_f32_16x16x32_bf16 v[160:163], a[176:179], v[24:27], v[160:163]
    ds_read_b128 v[92:95], v237 offset:3072
    v_mfma_f32_16x16x32_bf16 v[196:199], a[180:183], v[24:27], v[196:199]
    buffer_load_dwordx4 v244, s[40:43], s62 offen offset:2048 sc1 lds
    v_mfma_f32_16x16x32_bf16 v[160:163], a[184:187], v[28:31], v[160:163]
    v_mfma_f32_16x16x32_bf16 v[196:199], a[188:191], v[28:31], v[196:199]
    s_waitcnt vmcnt(7)
    s_barrier
    s_waitcnt lgkmcnt(4)
    v_mfma_f32_16x16x32_bf16 v[160:163], a[192:195], v[32:35], v[160:163]
    ds_read_b128 v[16:19], v237 offset:4096
    ds_read_b64_tr_b16 a[96:97], v252 offset:0
    v_mfma_f32_16x16x32_bf16 v[196:199], a[196:199], v[32:35], v[196:199]
    ds_read_b128 v[20:23], v237 offset:5120
    ds_read_b64_tr_b16 a[98:99], v253 offset:0
    v_mfma_f32_16x16x32_bf16 v[160:163], a[200:203], v[36:39], v[160:163]
    ds_read_b64_tr_b16 a[100:101], v252 offset:8
    ds_read_b64_tr_b16 a[102:103], v253 offset:8
    v_mfma_f32_16x16x32_bf16 v[196:199], a[204:207], v[36:39], v[196:199]
    ds_read_b128 v[24:27], v237 offset:6144
    s_add_u32 s62, s65, 24576
    v_mfma_f32_16x16x32_bf16 v[160:163], a[208:211], v[40:43], v[160:163]
    ds_read_b128 v[28:31], v237 offset:7168
    s_and_b32 s62, s62, 0x7fff
    s_add_u32 m0, s64, 73728
    v_mfma_f32_16x16x32_bf16 v[196:199], a[212:215], v[40:43], v[196:199]
    buffer_load_dwordx4 v242, s[40:43], s62 offen offset:0 sc1 lds
    v_mfma_f32_16x16x32_bf16 v[160:163], a[216:219], v[44:47], v[160:163]
    ds_read_b64_tr_b16 a[104:105], v252 offset:8192
    ds_read_b64_tr_b16 a[106:107], v253 offset:8192
    v_mfma_f32_16x16x32_bf16 v[196:199], a[220:223], v[44:47], v[196:199]
    ds_read_b64_tr_b16 a[108:109], v252 offset:8200
    ds_read_b64_tr_b16 a[110:111], v253 offset:8200
    s_waitcnt lgkmcnt(12)
    v_mfma_f32_16x16x32_bf16 v[160:163], a[224:227], v[80:83], v[160:163]
    ds_read_b128 v[32:35], v237 offset:8192
    ds_read_b64_tr_b16 a[112:113], v254 offset:20480
    v_mfma_f32_16x16x32_bf16 v[196:199], a[228:231], v[80:83], v[196:199]
    ds_read_b128 v[36:39], v237 offset:9216
    ds_read_b64_tr_b16 a[114:115], v255 offset:20480
    v_mfma_f32_16x16x32_bf16 v[160:163], a[232:235], v[84:87], v[160:163]
    ds_read_b64_tr_b16 a[116:117], v254 offset:20488
    ds_read_b64_tr_b16 a[118:119], v255 offset:20488
    v_mfma_f32_16x16x32_bf16 v[196:199], a[236:239], v[84:87], v[196:199]
    ds_read_b128 v[40:43], v237 offset:10240
    ds_read_b64_tr_b16 a[120:121], v254 offset:28672
    v_mfma_f32_16x16x32_bf16 v[160:163], a[240:243], v[88:91], v[160:163]
    ds_read_b128 v[44:47], v237 offset:11264
    ds_read_b64_tr_b16 a[122:123], v255 offset:28672
    v_mfma_f32_16x16x32_bf16 v[196:199], a[244:247], v[88:91], v[196:199]
    buffer_load_dwordx4 v243, s[40:43], s62 offen offset:1024 sc1 lds
    v_mfma_f32_16x16x32_bf16 v[160:163], a[248:251], v[92:95], v[160:163]
    ds_read_b64_tr_b16 a[124:125], v254 offset:28680
    ds_read_b64_tr_b16 a[126:127], v255 offset:28680
    v_mfma_f32_16x16x32_bf16 v[196:199], a[252:255], v[92:95], v[196:199]
    s_waitcnt lgkmcnt(15)
    v_mfma_f32_16x16x32_bf16 v[164:167], a[160:163], v[16:19], v[164:167]
    ds_read_b128 v[80:83], v237 offset:12288
    v_mfma_f32_16x16x32_bf16 v[200:203], a[164:167], v[16:19], v[200:203]
    ds_read_b128 v[84:87], v237 offset:13312
    v_mfma_f32_16x16x32_bf16 v[164:167], a[168:171], v[20:23], v[164:167]
    v_mfma_f32_16x16x32_bf16 v[200:203], a[172:175], v[20:23], v[200:203]
    ds_read_b128 v[88:91], v237 offset:14336
    v_mfma_f32_16x16x32_bf16 v[164:167], a[176:179], v[24:27], v[164:167]
    ds_read_b128 v[92:95], v237 offset:15360
    v_mfma_f32_16x16x32_bf16 v[200:203], a[180:183], v[24:27], v[200:203]
    buffer_load_dwordx4 v244, s[40:43], s62 offen offset:2048 sc1 lds
    v_mfma_f32_16x16x32_bf16 v[164:167], a[184:187], v[28:31], v[164:167]
    v_mfma_f32_16x16x32_bf16 v[200:203], a[188:191], v[28:31], v[200:203]
    s_waitcnt lgkmcnt(7)
    v_mfma_f32_16x16x32_bf16 v[164:167], a[192:195], v[32:35], v[164:167]
    ds_read_b128 v[16:19], v237 offset:16384
    v_mfma_f32_16x16x32_bf16 v[200:203], a[196:199], v[32:35], v[200:203]
    ds_read_b128 v[20:23], v237 offset:17408
    v_mfma_f32_16x16x32_bf16 v[164:167], a[200:203], v[36:39], v[164:167]
    v_mfma_f32_16x16x32_bf16 v[200:203], a[204:207], v[36:39], v[200:203]
    ds_read_b128 v[24:27], v237 offset:18432
    v_mfma_f32_16x16x32_bf16 v[164:167], a[208:211], v[40:43], v[164:167]
    ds_read_b128 v[28:31], v237 offset:19456
    v_mfma_f32_16x16x32_bf16 v[200:203], a[212:215], v[40:43], v[200:203]
    v_mfma_f32_16x16x32_bf16 v[164:167], a[216:219], v[44:47], v[164:167]
    v_mfma_f32_16x16x32_bf16 v[200:203], a[220:223], v[44:47], v[200:203]
    s_waitcnt lgkmcnt(4)
    v_mfma_f32_16x16x32_bf16 v[164:167], a[224:227], v[80:83], v[164:167]
    ds_read_b128 v[32:35], v237 offset:20480
    v_mfma_f32_16x16x32_bf16 v[200:203], a[228:231], v[80:83], v[200:203]
    ds_read_b128 v[36:39], v237 offset:21504
    v_mfma_f32_16x16x32_bf16 v[164:167], a[232:235], v[84:87], v[164:167]
    v_mfma_f32_16x16x32_bf16 v[200:203], a[236:239], v[84:87], v[200:203]
    ds_read_b128 v[40:43], v237 offset:22528
    v_mfma_f32_16x16x32_bf16 v[164:167], a[240:243], v[88:91], v[164:167]
    ds_read_b128 v[44:47], v237 offset:23552
    v_mfma_f32_16x16x32_bf16 v[200:203], a[244:247], v[88:91], v[200:203]
    v_mfma_f32_16x16x32_bf16 v[164:167], a[248:251], v[92:95], v[164:167]
    v_mfma_f32_16x16x32_bf16 v[200:203], a[252:255], v[92:95], v[200:203]
    s_waitcnt lgkmcnt(4)
    v_mfma_f32_16x16x32_bf16 v[168:171], a[160:163], v[16:19], v[168:171]
    ds_read_b128 v[80:83], v237 offset:24576
    v_mfma_f32_16x16x32_bf16 v[204:207], a[164:167], v[16:19], v[204:207]
    ds_read_b128 v[84:87], v237 offset:25600
    v_mfma_f32_16x16x32_bf16 v[168:171], a[168:171], v[20:23], v[168:171]
    v_mfma_f32_16x16x32_bf16 v[204:207], a[172:175], v[20:23], v[204:207]
    ds_read_b128 v[88:91], v237 offset:26624
    v_mfma_f32_16x16x32_bf16 v[168:171], a[176:179], v[24:27], v[168:171]
    ds_read_b128 v[92:95], v237 offset:27648
    v_mfma_f32_16x16x32_bf16 v[204:207], a[180:183], v[24:27], v[204:207]
    v_mfma_f32_16x16x32_bf16 v[168:171], a[184:187], v[28:31], v[168:171]
    v_mfma_f32_16x16x32_bf16 v[204:207], a[188:191], v[28:31], v[204:207]
    s_cmp_lg_u32 s3, 3
    s_cbranch_scc1 L_p1ok
    s_waitcnt vmcnt(5)
L_p1:
    v_cmp_ne_u64 vcc, s[4:5], v[2:3]
    s_cbranch_vccnz L_p1b
L_p1ok:
    s_waitcnt vmcnt(7)
    s_barrier
    s_waitcnt lgkmcnt(4)
    v_mfma_f32_16x16x32_bf16 v[168:171], a[192:195], v[32:35], v[168:171]
    ds_read_b128 v[16:19], v5 offset:49152
    v_mfma_f32_16x16x32_bf16 v[204:207], a[196:199], v[32:35], v[204:207]
    ds_read_b128 v[20:23], v5 offset:50176
    s_mov_b32 s63, 69632
    s_add_u32 m0, s64, 24576
    v_mfma_f32_16x16x32_bf16 v[168:171], a[200:203], v[36:39], v[168:171]
    buffer_load_dwordx4 v242, s[40:43], s63 offen offset:0 sc1 lds
    v_mfma_f32_16x16x32_bf16 v[204:207], a[204:207], v[36:39], v[204:207]
    ds_read_b128 v[24:27], v5 offset:51200
    v_mfma_f32_16x16x32_bf16 v[168:171], a[208:211], v[40:43], v[168:171]
    ds_read_b128 v[28:31], v5 offset:52224
    v_mfma_f32_16x16x32_bf16 v[204:207], a[212:215], v[40:43], v[204:207]
    v_mfma_f32_16x16x32_bf16 v[168:171], a[216:219], v[44:47], v[168:171]
    buffer_load_dwordx4 v243, s[40:43], s63 offen offset:1024 sc1 lds
    v_mfma_f32_16x16x32_bf16 v[204:207], a[220:223], v[44:47], v[204:207]
    s_waitcnt lgkmcnt(4)
    v_mfma_f32_16x16x32_bf16 v[168:171], a[224:227], v[80:83], v[168:171]
    ds_read_b128 v[32:35], v5 offset:53248
    v_mfma_f32_16x16x32_bf16 v[204:207], a[228:231], v[80:83], v[204:207]
    ds_read_b128 v[36:39], v5 offset:54272
    v_mfma_f32_16x16x32_bf16 v[168:171], a[232:235], v[84:87], v[168:171]
    buffer_load_dwordx4 v244, s[40:43], s63 offen offset:2048 sc1 lds
    v_mfma_f32_16x16x32_bf16 v[204:207], a[236:239], v[84:87], v[204:207]
    ds_read_b128 v[40:43], v5 offset:55296
    v_mfma_f32_16x16x32_bf16 v[168:171], a[240:243], v[88:91], v[168:171]
    ds_read_b128 v[44:47], v5 offset:56320
    s_add_u32 s62, s65, 4096
    s_and_b32 s62, s62, 0x7fff
    v_mfma_f32_16x16x32_bf16 v[204:207], a[244:247], v[88:91], v[204:207]
    s_add_u32 s63, s62, 36864
    s_add_u32 m0, s64, 36864
    v_mfma_f32_16x16x32_bf16 v[168:171], a[248:251], v[92:95], v[168:171]
    buffer_load_dwordx4 v242, s[40:43], s63 offen offset:0 sc1 lds
    v_mfma_f32_16x16x32_bf16 v[204:207], a[252:255], v[92:95], v[204:207]
    s_waitcnt lgkmcnt(4)
    v_mfma_f32_16x16x32_bf16 v[172:175], a[160:163], v[16:19], v[172:175]
    ds_read_b128 v[80:83], v5 offset:57344
    v_mfma_f32_16x16x32_bf16 v[208:211], a[164:167], v[16:19], v[208:211]
    ds_read_b128 v[84:87], v5 offset:58368
    v_mfma_f32_16x16x32_bf16 v[172:175], a[168:171], v[20:23], v[172:175]
    buffer_load_dwordx4 v243, s[40:43], s63 offen offset:1024 sc1 lds
    v_mfma_f32_16x16x32_bf16 v[208:211], a[172:175], v[20:23], v[208:211]
    ds_read_b128 v[88:91], v5 offset:59392
    v_mfma_f32_16x16x32_bf16 v[172:175], a[176:179], v[24:27], v[172:175]
    ds_read_b128 v[92:95], v5 offset:60416
    v_mfma_f32_16x16x32_bf16 v[208:211], a[180:183], v[24:27], v[208:211]
    v_mfma_f32_16x16x32_bf16 v[172:175], a[184:187], v[28:31], v[172:175]
    buffer_load_dwordx4 v244, s[40:43], s63 offen offset:2048 sc1 lds
    v_mfma_f32_16x16x32_bf16 v[208:211], a[188:191], v[28:31], v[208:211]
    s_waitcnt vmcnt(6)
    s_barrier
    s_waitcnt lgkmcnt(4)
    v_mfma_f32_16x16x32_bf16 v[172:175], a[192:195], v[32:35], v[172:175]
    ds_read_b128 v[16:19], v5 offset:61440
    s_add_u32 s62, s65, 8192
    s_and_b32 s62, s62, 0x7fff
    v_mfma_f32_16x16x32_bf16 v[208:211], a[196:199], v[32:35], v[208:211]
    ds_read_b128 v[20:23], v5 offset:62464
    s_add_u32 s63, s62, 36864
    s_add_u32 m0, s64, 110592
    v_mfma_f32_16x16x32_bf16 v[172:175], a[200:203], v[36:39], v[172:175]
    buffer_load_dwordx4 v242, s[40:43], s63 offen offset:0 sc1 lds
    v_mfma_f32_16x16x32_bf16 v[208:211], a[204:207], v[36:39], v[208:211]
    ds_read_b128 v[24:27], v5 offset:63488
    v_mfma_f32_16x16x32_bf16 v[172:175], a[208:211], v[40:43], v[172:175]
    ds_read_b128 v[28:31], v5 offset:64512
    v_mfma_f32_16x16x32_bf16 v[208:211], a[212:215], v[40:43], v[208:211]
    v_mfma_f32_16x16x32_bf16 v[172:175], a[216:219], v[44:47], v[172:175]
    buffer_load_dwordx4 v243, s[40:43], s63 offen offset:1024 sc1 lds
    v_mfma_f32_16x16x32_bf16 v[208:211], a[220:223], v[44:47], v[208:211]
    s_waitcnt lgkmcnt(4)
    v_mfma_f32_16x16x32_bf16 v[172:175], a[224:227], v[80:83], v[172:175]
    ds_read_b128 v[32:35], v236 offset:0
    v_mfma_f32_16x16x32_bf16 v[208:211], a[228:231], v[80:83], v[208:211]
    ds_read_b128 v[36:39], v236 offset:1024
    v_mfma_f32_16x16x32_bf16 v[172:175], a[232:235], v[84:87], v[172:175]
    buffer_load_dwordx4 v244, s[40:43], s63 offen offset:2048 sc1 lds
    v_mfma_f32_16x16x32_bf16 v[208:211], a[236:239], v[84:87], v[208:211]
    ds_read_b128 v[40:43], v236 offset:2048
    v_mfma_f32_16x16x32_bf16 v[172:175], a[240:243], v[88:91], v[172:175]
    ds_read_b128 v[44:47], v236 offset:3072
    s_add_u32 s62, s65, 12288
    s_and_b32 s62, s62, 0x7fff
    v_mfma_f32_16x16x32_bf16 v[208:211], a[244:247], v[88:91], v[208:211]
    s_add_u32 s63, s62, 36864
    s_add_u32 m0, s64, 122880
    v_mfma_f32_16x16x32_bf16 v[172:175], a[248:251], v[92:95], v[172:175]
    buffer_load_dwordx4 v242, s[40:43], s63 offen offset:0 sc1 lds
    v_mfma_f32_16x16x32_bf16 v[208:211], a[252:255], v[92:95], v[208:211]
    s_waitcnt lgkmcnt(4)
    v_mfma_f32_16x16x32_bf16 v[176:179], a[160:163], v[16:19], v[176:179]
    ds_read_b128 v[80:83], v236 offset:4096
    v_mfma_f32_16x16x32_bf16 v[212:215], a[164:167], v[16:19], v[212:215]
    ds_read_b128 v[84:87], v236 offset:5120
    v_mfma_f32_16x16x32_bf16 v[176:179], a[168:171], v[20:23], v[176:179]
    buffer_load_dwordx4 v243, s[40:43], s63 offen offset:1024 sc1 lds
    v_mfma_f32_16x16x32_bf16 v[212:215], a[172:175], v[20:23], v[212:215]
    ds_read_b128 v[88:91], v236 offset:6144
    v_mfma_f32_16x16x32_bf16 v[176:179], a[176:179], v[24:27], v[176:179]
    ds_read_b128 v[92:95], v236 offset:7168
    v_mfma_f32_16x16x32_bf16 v[212:215], a[180:183], v[24:27], v[212:215]
    v_mfma_f32_16x16x32_bf16 v[176:179], a[184:187], v[28:31], v[176:179]
    buffer_load_dwordx4 v244, s[40:43], s63 offen offset:2048 sc1 lds
    v_mfma_f32_16x16x32_bf16 v[212:215], a[188:191], v[28:31], v[212:215]
    s_waitcnt lgkmcnt(4)
    v_mfma_f32_16x16x32_bf16 v[176:179], a[192:195], v[32:35], v[176:179]
    ds_read_b128 v[16:19], v236 offset:8192
    v_mfma_f32_16x16x32_bf16 v[212:215], a[196:199], v[32:35], v[212:215]
    ds_read_b128 v[20:23], v236 offset:9216
    v_mfma_f32_16x16x32_bf16 v[176:179], a[200:203], v[36:39], v[176:179]
    v_mfma_f32_16x16x32_bf16 v[212:215], a[204:207], v[36:39], v[212:215]
    ds_read_b128 v[24:27], v236 offset:10240
    s_add_u32 s62, s65, 16384
    s_and_b32 s62, s62, 0x7fff
    v_mfma_f32_16x16x32_bf16 v[176:179], a[208:211], v[40:43], v[176:179]
    ds_read_b128 v[28:31], v236 offset:11264
    s_add_u32 s63, s62, 36864
    s_add_u32 m0, s64, 0
    v_mfma_f32_16x16x32_bf16 v[212:215], a[212:215], v[40:43], v[212:215]
    buffer_load_dwordx4 v242, s[40:43], s63 offen offset:0 sc1 lds
    v_mfma_f32_16x16x32_bf16 v[176:179], a[216:219], v[44:47], v[176:179]
    v_mfma_f32_16x16x32_bf16 v[212:215], a[220:223], v[44:47], v[212:215]
    s_waitcnt lgkmcnt(4)
    v_mfma_f32_16x16x32_bf16 v[176:179], a[224:227], v[80:83], v[176:179]
    ds_read_b128 v[32:35], v236 offset:12288
    v_mfma_f32_16x16x32_bf16 v[212:215], a[228:231], v[80:83], v[212:215]
    ds_read_b128 v[36:39], v236 offset:13312
    v_mfma_f32_16x16x32_bf16 v[176:179], a[232:235], v[84:87], v[176:179]
    v_mfma_f32_16x16x32_bf16 v[212:215], a[236:239], v[84:87], v[212:215]
    ds_read_b128 v[40:43], v236 offset:14336
    v_mfma_f32_16x16x32_bf16 v[176:179], a[240:243], v[88:91], v[176:179]
    ds_read_b128 v[44:47], v236 offset:15360
    v_mfma_f32_16x16x32_bf16 v[212:215], a[244:247], v[88:91], v[212:215]
    buffer_load_dwordx4 v243, s[40:43], s63 offen offset:1024 sc1 lds
    v_mfma_f32_16x16x32_bf16 v[176:179], a[248:251], v[92:95], v[176:179]
    v_mfma_f32_16x16x32_bf16 v[212:215], a[252:255], v[92:95], v[212:215]
    s_waitcnt lgkmcnt(4)
    v_mfma_f32_16x16x32_bf16 v[180:183], a[160:163], v[16:19], v[180:183]
    ds_read_b128 v[80:83], v236 offset:16384
    v_mfma_f32_16x16x32_bf16 v[216:219], a[164:167], v[16:19], v[216:219]
    ds_read_b128 v[84:87], v236 offset:17408
    v_mfma_f32_16x16x32_bf16 v[180:183], a[168:171], v[20:23], v[180:183]
    v_mfma_f32_16x16x32_bf16 v[216:219], a[172:175], v[20:23], v[216:219]
    ds_read_b128 v[88:91], v236 offset:18432
    v_mfma_f32_16x16x32_bf16 v[180:183], a[176:179], v[24:27], v[180:183]
    ds_read_b128 v[92:95], v236 offset:19456
    v_mfma_f32_16x16x32_bf16 v[216:219], a[180:183], v[24:27], v[216:219]
    buffer_load_dwordx4 v244, s[40:43], s63 offen offset:2048 sc1 lds
    v_mfma_f32_16x16x32_bf16 v[180:183], a[184:187], v[28:31], v[180:183]
    v_mfma_f32_16x16x32_bf16 v[216:219], a[188:191], v[28:31], v[216:219]
    s_waitcnt vmcnt(12)
    s_barrier
    s_waitcnt lgkmcnt(4)
    v_mfma_f32_16x16x32_bf16 v[180:183], a[192:195], v[32:35], v[180:183]
    ds_read_b128 v[16:19], v5 offset:24576
    v_mfma_f32_16x16x32_bf16 v[216:219], a[196:199], v[32:35], v[216:219]
    ds_read_b128 v[20:23], v5 offset:25600
    v_mfma_f32_16x16x32_bf16 v[180:183], a[200:203], v[36:39], v[180:183]
    v_mfma_f32_16x16x32_bf16 v[216:219], a[204:207], v[36:39], v[216:219]
    ds_read_b128 v[24:27], v5 offset:26624
    s_add_u32 s62, s65, 20480
    s_and_b32 s62, s62, 0x7fff
    v_mfma_f32_16x16x32_bf16 v[180:183], a[208:211], v[40:43], v[180:183]
    ds_read_b128 v[28:31], v5 offset:27648
    s_add_u32 s63, s62, 36864
    s_add_u32 m0, s64, 12288
    v_mfma_f32_16x16x32_bf16 v[216:219], a[212:215], v[40:43], v[216:219]
    buffer_load_dwordx4 v242, s[40:43], s63 offen offset:0 sc1 lds
    v_mfma_f32_16x16x32_bf16 v[180:183], a[216:219], v[44:47], v[180:183]
    v_mfma_f32_16x16x32_bf16 v[216:219], a[220:223], v[44:47], v[216:219]
    s_waitcnt lgkmcnt(4)
    v_mfma_f32_16x16x32_bf16 v[180:183], a[224:227], v[80:83], v[180:183]
    ds_read_b128 v[32:35], v5 offset:28672
    v_mfma_f32_16x16x32_bf16 v[216:219], a[228:231], v[80:83], v[216:219]
    ds_read_b128 v[36:39], v5 offset:29696
    v_mfma_f32_16x16x32_bf16 v[180:183], a[232:235], v[84:87], v[180:183]
    v_mfma_f32_16x16x32_bf16 v[216:219], a[236:239], v[84:87], v[216:219]
    ds_read_b128 v[40:43], v5 offset:30720
    v_mfma_f32_16x16x32_bf16 v[180:183], a[240:243], v[88:91], v[180:183]
    ds_read_b128 v[44:47], v5 offset:31744
    v_mfma_f32_16x16x32_bf16 v[216:219], a[244:247], v[88:91], v[216:219]
    buffer_load_dwordx4 v243, s[40:43], s63 offen offset:1024 sc1 lds
    v_mfma_f32_16x16x32_bf16 v[180:183], a[248:251], v[92:95], v[180:183]
    v_mfma_f32_16x16x32_bf16 v[216:219], a[252:255], v[92:95], v[216:219]
    s_waitcnt lgkmcnt(4)
    v_mfma_f32_16x16x32_bf16 v[192:195], a[32:35], v[16:19], v[192:195]
    ds_read_b128 v[80:83], v5 offset:32768
    v_mfma_f32_16x16x32_bf16 v[228:231], a[36:39], v[16:19], v[228:231]
    ds_read_b128 v[84:87], v5 offset:33792
    v_mfma_f32_16x16x32_bf16 v[192:195], a[40:43], v[20:23], v[192:195]
    v_mfma_f32_16x16x32_bf16 v[228:231], a[44:47], v[20:23], v[228:231]
    ds_read_b128 v[88:91], v5 offset:34816
    v_mfma_f32_16x16x32_bf16 v[192:195], a[48:51], v[24:27], v[192:195]
    ds_read_b128 v[92:95], v5 offset:35840
    v_mfma_f32_16x16x32_bf16 v[228:231], a[52:55], v[24:27], v[228:231]
    buffer_load_dwordx4 v244, s[40:43], s63 offen offset:2048 sc1 lds
    v_mfma_f32_16x16x32_bf16 v[192:195], a[56:59], v[28:31], v[192:195]
    v_mfma_f32_16x16x32_bf16 v[228:231], a[60:63], v[28:31], v[228:231]
    s_waitcnt vmcnt(9)
    s_barrier
    s_waitcnt lgkmcnt(4)
    v_mfma_f32_16x16x32_bf16 v[192:195], a[64:67], v[32:35], v[192:195]
    ds_read_b128 v[16:19], v5 offset:36864
    v_mfma_f32_16x16x32_bf16 v[228:231], a[68:71], v[32:35], v[228:231]
    ds_read_b128 v[20:23], v5 offset:37888
    v_mfma_f32_16x16x32_bf16 v[192:195], a[72:75], v[36:39], v[192:195]
    v_mfma_f32_16x16x32_bf16 v[228:231], a[76:79], v[36:39], v[228:231]
    ds_read_b128 v[24:27], v5 offset:38912
    s_add_u32 s62, s65, 24576
    s_and_b32 s62, s62, 0x7fff
    v_mfma_f32_16x16x32_bf16 v[192:195], a[80:83], v[40:43], v[192:195]
    ds_read_b128 v[28:31], v5 offset:39936
    s_add_u32 s63, s62, 36864
    s_add_u32 m0, s64, 86016
    v_mfma_f32_16x16x32_bf16 v[228:231], a[84:87], v[40:43], v[228:231]
    buffer_load_dwordx4 v242, s[40:43], s63 offen offset:0 sc1 lds
    v_mfma_f32_16x16x32_bf16 v[192:195], a[88:91], v[44:47], v[192:195]
    v_mfma_f32_16x16x32_bf16 v[228:231], a[92:95], v[44:47], v[228:231]
    s_waitcnt lgkmcnt(4)
    v_mfma_f32_16x16x32_bf16 v[192:195], a[96:99], v[80:83], v[192:195]
    ds_read_b128 v[32:35], v5 offset:40960
    v_mfma_f32_16x16x32_bf16 v[228:231], a[100:103], v[80:83], v[228:231]
    ds_read_b128 v[36:39], v5 offset:41984
    v_mfma_f32_16x16x32_bf16 v[192:195], a[104:107], v[84:87], v[192:195]
    v_mfma_f32_16x16x32_bf16 v[228:231], a[108:111], v[84:87], v[228:231]
    ds_read_b128 v[40:43], v5 offset:43008
    v_mfma_f32_16x16x32_bf16 v[192:195], a[112:115], v[88:91], v[192:195]
    ds_read_b128 v[44:47], v5 offset:44032
    v_mfma_f32_16x16x32_bf16 v[228:231], a[116:119], v[88:91], v[228:231]
    buffer_load_dwordx4 v243, s[40:43], s63 offen offset:1024 sc1 lds
    v_mfma_f32_16x16x32_bf16 v[192:195], a[120:123], v[92:95], v[192:195]
    v_mfma_f32_16x16x32_bf16 v[228:231], a[124:127], v[92:95], v[228:231]
    s_waitcnt lgkmcnt(4)
    v_mfma_f32_16x16x32_bf16 v[160:163], a[32:35], v[16:19], v[160:163]
    ds_read_b128 v[80:83], v5 offset:45056
    v_mfma_f32_16x16x32_bf16 v[196:199], a[36:39], v[16:19], v[196:199]
    ds_read_b128 v[84:87], v5 offset:46080
    v_mfma_f32_16x16x32_bf16 v[160:163], a[40:43], v[20:23], v[160:163]
    buffer_load_dwordx4 v244, s[40:43], s63 offen offset:2048 sc1 lds
    v_mfma_f32_16x16x32_bf16 v[196:199], a[44:47], v[20:23], v[196:199]
    ds_read_b128 v[88:91], v5 offset:47104
    v_mfma_f32_16x16x32_bf16 v[160:163], a[48:51], v[24:27], v[160:163]
    ds_read_b128 v[92:95], v5 offset:48128
    v_cvt_pk_bf16_f32 v112, v192, v193
    v_mfma_f32_16x16x32_bf16 v[196:199], a[52:55], v[24:27], v[196:199]
    v_cvt_pk_bf16_f32 v113, v194, v195
    v_cvt_pk_bf16_f32 v114, v228, v229
    v_mfma_f32_16x16x32_bf16 v[160:163], a[56:59], v[28:31], v[160:163]
    v_cvt_pk_bf16_f32 v122, v230, v231
    buffer_store_dwordx4 v[112:115], v5, s[44:47], s83 offen offset:0 sc1
    v_mfma_f32_16x16x32_bf16 v[196:199], a[60:63], v[28:31], v[196:199]
    s_waitcnt lgkmcnt(4)
    v_mfma_f32_16x16x32_bf16 v[160:163], a[64:67], v[32:35], v[160:163]
    ds_read_b128 v[16:19], v236 offset:45056
    v_mfma_f32_16x16x32_bf16 v[196:199], a[68:71], v[32:35], v[196:199]
    ds_read_b128 v[20:23], v236 offset:46080
    v_mfma_f32_16x16x32_bf16 v[160:163], a[72:75], v[36:39], v[160:163]
    v_mfma_f32_16x16x32_bf16 v[196:199], a[76:79], v[36:39], v[196:199]
    ds_read_b128 v[24:27], v236 offset:47104
    s_add_u32 s62, s65, 28672
    v_mfma_f32_16x16x32_bf16 v[160:163], a[80:83], v[40:43], v[160:163]
    ds_read_b128 v[28:31], v236 offset:48128
    s_and_b32 s62, s62, 0x7fff
    s_add_u32 m0, s64, 135168
    v_mfma_f32_16x16x32_bf16 v[196:199], a[84:87], v[40:43], v[196:199]
    buffer_load_dwordx4 v242, s[40:43], s62 offen offset:0 sc1 lds
    v_mfma_f32_16x16x32_bf16 v[160:163], a[88:91], v[44:47], v[160:163]
    v_mfma_f32_16x16x32_bf16 v[196:199], a[92:95], v[44:47], v[196:199]
    s_waitcnt lgkmcnt(4)
    v_mfma_f32_16x16x32_bf16 v[160:163], a[96:99], v[80:83], v[160:163]
    ds_read_b128 v[32:35], v236 offset:49152
    v_mfma_f32_16x16x32_bf16 v[196:199], a[100:103], v[80:83], v[196:199]
    ds_read_b128 v[36:39], v236 offset:50176
    v_mfma_f32_16x16x32_bf16 v[160:163], a[104:107], v[84:87], v[160:163]
    v_mfma_f32_16x16x32_bf16 v[196:199], a[108:111], v[84:87], v[196:199]
    ds_read_b128 v[40:43], v236 offset:51200
    v_mfma_f32_16x16x32_bf16 v[160:163], a[112:115], v[88:91], v[160:163]
    ds_read_b128 v[44:47], v236 offset:52224
    v_mfma_f32_16x16x32_bf16 v[196:199], a[116:119], v[88:91], v[196:199]
    buffer_load_dwordx4 v243, s[40:43], s62 offen offset:1024 sc1 lds
    v_mfma_f32_16x16x32_bf16 v[160:163], a[120:123], v[92:95], v[160:163]
    v_mfma_f32_16x16x32_bf16 v[196:199], a[124:127], v[92:95], v[196:199]
    s_waitcnt lgkmcnt(4)
    v_mfma_f32_16x16x32_bf16 v[164:167], a[32:35], v[16:19], v[164:167]
    ds_read_b128 v[80:83], v236 offset:53248
    v_mfma_f32_16x16x32_bf16 v[200:203], a[36:39], v[16:19], v[200:203]
    ds_read_b128 v[84:87], v236 offset:54272
    v_mfma_f32_16x16x32_bf16 v[164:167], a[40:43], v[20:23], v[164:167]
    buffer_load_dwordx4 v244, s[40:43], s62 offen offset:2048 sc1 lds
    v_mfma_f32_16x16x32_bf16 v[200:203], a[44:47], v[20:23], v[200:203]
    ds_read_b128 v[88:91], v236 offset:55296
    v_mfma_f32_16x16x32_bf16 v[164:167], a[48:51], v[24:27], v[164:167]
    ds_read_b128 v[92:95], v236 offset:56320
    v_cvt_pk_bf16_f32 v116, v160, v161
    v_mfma_f32_16x16x32_bf16 v[200:203], a[52:55], v[24:27], v[200:203]
    v_cvt_pk_bf16_f32 v117, v162, v163
    v_cvt_pk_bf16_f32 v118, v196, v197
    v_mfma_f32_16x16x32_bf16 v[164:167], a[56:59], v[28:31], v[164:167]
    v_cvt_pk_bf16_f32 v120, v198, v199
    buffer_store_dwordx4 v[116:119], v5, s[44:47], s80 offen offset:0 sc1
    v_mfma_f32_16x16x32_bf16 v[200:203], a[60:63], v[28:31], v[200:203]
    s_waitcnt vmcnt(11)
    s_barrier
    s_waitcnt lgkmcnt(4)
    v_mfma_f32_16x16x32_bf16 v[164:167], a[64:67], v[32:35], v[164:167]
    ds_read_b128 v[16:19], v236 offset:57344
    v_mfma_f32_16x16x32_bf16 v[200:203], a[68:71], v[32:35], v[200:203]
    ds_read_b128 v[20:23], v236 offset:58368
    v_mfma_f32_16x16x32_bf16 v[164:167], a[72:75], v[36:39], v[164:167]
    v_mfma_f32_16x16x32_bf16 v[200:203], a[76:79], v[36:39], v[200:203]
    ds_read_b128 v[24:27], v236 offset:59392
    s_add_u32 s62, s65, 32768
    v_mfma_f32_16x16x32_bf16 v[164:167], a[80:83], v[40:43], v[164:167]
    ds_read_b128 v[28:31], v236 offset:60416
    s_and_b32 s62, s62, 0x7fff
    s_add_u32 m0, s64, 147456
    v_mfma_f32_16x16x32_bf16 v[200:203], a[84:87], v[40:43], v[200:203]
    buffer_load_dwordx4 v242, s[40:43], s62 offen offset:0 sc1 lds
    v_mfma_f32_16x16x32_bf16 v[164:167], a[88:91], v[44:47], v[164:167]
    v_mfma_f32_16x16x32_bf16 v[200:203], a[92:95], v[44:47], v[200:203]
    s_waitcnt lgkmcnt(4)
    v_mfma_f32_16x16x32_bf16 v[164:167], a[96:99], v[80:83], v[164:167]
    ds_read_b128 v[32:35], v236 offset:61440
    v_mfma_f32_16x16x32_bf16 v[200:203], a[100:103], v[80:83], v[200:203]
    ds_read_b128 v[36:39], v236 offset:62464
    v_mfma_f32_16x16x32_bf16 v[164:167], a[104:107], v[84:87], v[164:167]
    v_mfma_f32_16x16x32_bf16 v[200:203], a[108:111], v[84:87], v[200:203]
    ds_read_b128 v[40:43], v236 offset:63488
    v_mfma_f32_16x16x32_bf16 v[164:167], a[112:115], v[88:91], v[164:167]
    ds_read_b128 v[44:47], v236 offset:64512
    v_mfma_f32_16x16x32_bf16 v[200:203], a[116:119], v[88:91], v[200:203]
    buffer_load_dwordx4 v243, s[40:43], s62 offen offset:1024 sc1 lds
    v_mfma_f32_16x16x32_bf16 v[164:167], a[120:123], v[92:95], v[164:167]
    v_mfma_f32_16x16x32_bf16 v[200:203], a[124:127], v[92:95], v[200:203]
    s_waitcnt lgkmcnt(4)
    v_mfma_f32_16x16x32_bf16 v[168:171], a[32:35], v[16:19], v[168:171]
    ds_read_b128 v[80:83], v237 offset:0
    v_mfma_f32_16x16x32_bf16 v[204:207], a[36:39], v[16:19], v[204:207]
    ds_read_b128 v[84:87], v237 offset:1024
    v_mfma_f32_16x16x32_bf16 v[168:171], a[40:43], v[20:23], v[168:171]
    buffer_load_dwordx4 v244, s[40:43], s62 offen offset:2048 sc1 lds
    v_mfma_f32_16x16x32_bf16 v[204:207], a[44:47], v[20:23], v[204:207]
    ds_read_b128 v[88:91], v237 offset:2048
    v_mfma_f32_16x16x32_bf16 v[168:171], a[48:51], v[24:27], v[168:171]
    ds_read_b128 v[92:95], v237 offset:3072
    v_cvt_pk_bf16_f32 v112, v164, v165
    v_mfma_f32_16x16x32_bf16 v[204:207], a[52:55], v[24:27], v[204:207]
    v_cvt_pk_bf16_f32 v113, v166, v167
    v_cvt_pk_bf16_f32 v114, v200, v201
    v_mfma_f32_16x16x32_bf16 v[168:171], a[56:59], v[28:31], v[168:171]
    v_cvt_pk_bf16_f32 v121, v202, v203
    buffer_store_dwordx4 v[112:115], v5, s[44:47], s80 offen offset:1024 sc1
    v_mfma_f32_16x16x32_bf16 v[204:207], a[60:63], v[28:31], v[204:207]
    buffer_store_dwordx4 v[120:123], v5, s[44:47], s80 offen offset:2048 sc1
    s_waitcnt lgkmcnt(4)
    v_mfma_f32_16x16x32_bf16 v[168:171], a[64:67], v[32:35], v[168:171]
    ds_read_b128 v[16:19], v5 offset:0
    v_mfma_f32_16x16x32_bf16 v[204:207], a[68:71], v[32:35], v[204:207]
    ds_read_b128 v[20:23], v5 offset:1024
    v_mfma_f32_16x16x32_bf16 v[168:171], a[72:75], v[36:39], v[168:171]
    v_mfma_f32_16x16x32_bf16 v[204:207], a[76:79], v[36:39], v[204:207]
    ds_read_b128 v[24:27], v5 offset:2048
    s_add_u32 s62, s65, 28672
    s_and_b32 s62, s62, 0x7fff
    v_mfma_f32_16x16x32_bf16 v[168:171], a[80:83], v[40:43], v[168:171]
    ds_read_b128 v[28:31], v5 offset:3072
    s_add_u32 s63, s62, 36864
    s_add_u32 m0, s64, 98304
    v_mfma_f32_16x16x32_bf16 v[204:207], a[84:87], v[40:43], v[204:207]
    buffer_load_dwordx4 v242, s[40:43], s63 offen offset:0 sc1 lds
    v_mfma_f32_16x16x32_bf16 v[168:171], a[88:91], v[44:47], v[168:171]
    v_mfma_f32_16x16x32_bf16 v[204:207], a[92:95], v[44:47], v[204:207]
    s_waitcnt lgkmcnt(4)
    v_mfma_f32_16x16x32_bf16 v[168:171], a[96:99], v[80:83], v[168:171]
    ds_read_b128 v[32:35], v5 offset:4096
    v_mfma_f32_16x16x32_bf16 v[204:207], a[100:103], v[80:83], v[204:207]
    ds_read_b128 v[36:39], v5 offset:5120
    v_mfma_f32_16x16x32_bf16 v[168:171], a[104:107], v[84:87], v[168:171]
    v_mfma_f32_16x16x32_bf16 v[204:207], a[108:111], v[84:87], v[204:207]
    ds_read_b128 v[40:43], v5 offset:6144
    v_mfma_f32_16x16x32_bf16 v[168:171], a[112:115], v[88:91], v[168:171]
    ds_read_b128 v[44:47], v5 offset:7168
    v_mfma_f32_16x16x32_bf16 v[204:207], a[116:119], v[88:91], v[204:207]
    buffer_load_dwordx4 v243, s[40:43], s63 offen offset:1024 sc1 lds
    v_mfma_f32_16x16x32_bf16 v[168:171], a[120:123], v[92:95], v[168:171]
    v_mfma_f32_16x16x32_bf16 v[204:207], a[124:127], v[92:95], v[204:207]
    s_waitcnt lgkmcnt(4)
    v_mfma_f32_16x16x32_bf16 v[172:175], a[32:35], v[16:19], v[172:175]
    ds_read_b128 v[80:83], v5 offset:8192
    v_mfma_f32_16x16x32_bf16 v[208:211], a[36:39], v[16:19], v[208:211]
    ds_read_b128 v[84:87], v5 offset:9216
    v_mfma_f32_16x16x32_bf16 v[172:175], a[40:43], v[20:23], v[172:175]
    buffer_load_dwordx4 v244, s[40:43], s63 offen offset:2048 sc1 lds
    v_mfma_f32_16x16x32_bf16 v[208:211], a[44:47], v[20:23], v[208:211]
    ds_read_b128 v[88:91], v5 offset:10240
    v_mfma_f32_16x16x32_bf16 v[172:175], a[48:51], v[24:27], v[172:175]
    ds_read_b128 v[92:95], v5 offset:11264
    v_cvt_pk_bf16_f32 v116, v168, v169
    v_mfma_f32_16x16x32_bf16 v[208:211], a[52:55], v[24:27], v[208:211]
    v_cvt_pk_bf16_f32 v117, v170, v171
    v_cvt_pk_bf16_f32 v118, v204, v205
    v_mfma_f32_16x16x32_bf16 v[172:175], a[56:59], v[28:31], v[172:175]
    v_cvt_pk_bf16_f32 v120, v206, v207
    buffer_store_dwordx4 v[116:119], v5, s[44:47], s81 offen offset:0 sc1
    v_mfma_f32_16x16x32_bf16 v[208:211], a[60:63], v[28:31], v[208:211]
    s_waitcnt vmcnt(14)
    s_barrier
    s_waitcnt lgkmcnt(4)
    v_mfma_f32_16x16x32_bf16 v[172:175], a[64:67], v[32:35], v[172:175]
    ds_read_b128 v[16:19], v5 offset:12288
    v_mfma_f32_16x16x32_bf16 v[208:211], a[68:71], v[32:35], v[208:211]
    ds_read_b128 v[20:23], v5 offset:13312
    v_mfma_f32_16x16x32_bf16 v[172:175], a[72:75], v[36:39], v[172:175]
    v_mfma_f32_16x16x32_bf16 v[208:211], a[76:79], v[36:39], v[208:211]
    ds_read_b128 v[24:27], v5 offset:14336
    s_add_u32 s62, s65, 32768
    s_and_b32 s62, s62, 0x7fff
    v_mfma_f32_16x16x32_bf16 v[172:175], a[80:83], v[40:43], v[172:175]
    ds_read_b128 v[28:31], v5 offset:15360
    s_add_u32 s63, s62, 36864
    s_add_u32 m0, s64, 49152
    v_mfma_f32_16x16x32_bf16 v[208:211], a[84:87], v[40:43], v[208:211]
    buffer_load_dwordx4 v242, s[40:43], s63 offen offset:0 sc1 lds
    v_mfma_f32_16x16x32_bf16 v[172:175], a[88:91], v[44:47], v[172:175]
    v_mfma_f32_16x16x32_bf16 v[208:211], a[92:95], v[44:47], v[208:211]
    s_waitcnt lgkmcnt(4)
    v_mfma_f32_16x16x32_bf16 v[172:175], a[96:99], v[80:83], v[172:175]
    ds_read_b128 v[32:35], v5 offset:16384
    v_mfma_f32_16x16x32_bf16 v[208:211], a[100:103], v[80:83], v[208:211]
    ds_read_b128 v[36:39], v5 offset:17408
    v_mfma_f32_16x16x32_bf16 v[172:175], a[104:107], v[84:87], v[172:175]
    v_mfma_f32_16x16x32_bf16 v[208:211], a[108:111], v[84:87], v[208:211]
    ds_read_b128 v[40:43], v5 offset:18432
    v_mfma_f32_16x16x32_bf16 v[172:175], a[112:115], v[88:91], v[172:175]
    ds_read_b128 v[44:47], v5 offset:19456
    v_mfma_f32_16x16x32_bf16 v[208:211], a[116:119], v[88:91], v[208:211]
    buffer_load_dwordx4 v243, s[40:43], s63 offen offset:1024 sc1 lds
    v_mfma_f32_16x16x32_bf16 v[172:175], a[120:123], v[92:95], v[172:175]
    v_mfma_f32_16x16x32_bf16 v[208:211], a[124:127], v[92:95], v[208:211]
    s_waitcnt lgkmcnt(4)
    v_mfma_f32_16x16x32_bf16 v[176:179], a[32:35], v[16:19], v[176:179]
    ds_read_b128 v[80:83], v5 offset:20480
    v_mfma_f32_16x16x32_bf16 v[212:215], a[36:39], v[16:19], v[212:215]
    ds_read_b128 v[84:87], v5 offset:21504
    v_mfma_f32_16x16x32_bf16 v[176:179], a[40:43], v[20:23], v[176:179]
    buffer_load_dwordx4 v244, s[40:43], s63 offen offset:2048 sc1 lds
    v_mfma_f32_16x16x32_bf16 v[212:215], a[44:47], v[20:23], v[212:215]
    ds_read_b128 v[88:91], v5 offset:22528
    v_mfma_f32_16x16x32_bf16 v[176:179], a[48:51], v[24:27], v[176:179]
    ds_read_b128 v[92:95], v5 offset:23552
    v_cvt_pk_bf16_f32 v112, v172, v173
    v_mfma_f32_16x16x32_bf16 v[212:215], a[52:55], v[24:27], v[212:215]
    v_cvt_pk_bf16_f32 v113, v174, v175
    v_cvt_pk_bf16_f32 v114, v208, v209
    v_mfma_f32_16x16x32_bf16 v[176:179], a[56:59], v[28:31], v[176:179]
    v_cvt_pk_bf16_f32 v121, v210, v211
    buffer_store_dwordx4 v[112:115], v5, s[44:47], s81 offen offset:1024 sc1
    v_mfma_f32_16x16x32_bf16 v[212:215], a[60:63], v[28:31], v[212:215]
    buffer_store_dwordx4 v[120:123], v5, s[44:47], s81 offen offset:2048 sc1
    s_waitcnt lgkmcnt(4)
    v_mfma_f32_16x16x32_bf16 v[176:179], a[64:67], v[32:35], v[176:179]
    ds_read_b128 v[16:19], v236 offset:20480
    v_mfma_f32_16x16x32_bf16 v[212:215], a[68:71], v[32:35], v[212:215]
    ds_read_b128 v[20:23], v236 offset:21504
    v_mfma_f32_16x16x32_bf16 v[176:179], a[72:75], v[36:39], v[176:179]
    v_mfma_f32_16x16x32_bf16 v[212:215], a[76:79], v[36:39], v[212:215]
    ds_read_b128 v[24:27], v236 offset:22528
    v_mfma_f32_16x16x32_bf16 v[176:179], a[80:83], v[40:43], v[176:179]
    ds_read_b128 v[28:31], v236 offset:23552
    v_mfma_f32_16x16x32_bf16 v[212:215], a[84:87], v[40:43], v[212:215]
    v_mfma_f32_16x16x32_bf16 v[176:179], a[88:91], v[44:47], v[176:179]
    v_mfma_f32_16x16x32_bf16 v[212:215], a[92:95], v[44:47], v[212:215]
    s_waitcnt lgkmcnt(4)
    v_mfma_f32_16x16x32_bf16 v[176:179], a[96:99], v[80:83], v[176:179]
    ds_read_b128 v[32:35], v236 offset:24576
    s_mul_i32 s71, s79, 49152
    v_mfma_f32_16x16x32_bf16 v[212:215], a[100:103], v[80:83], v[212:215]
    ds_read_b128 v[36:39], v236 offset:25600
    s_lshl_b32 s61, s3, 12
    v_mfma_f32_16x16x32_bf16 v[176:179], a[104:107], v[84:87], v[176:179]
    s_add_u32 s71, s71, s61
    v_mfma_f32_16x16x32_bf16 v[212:215], a[108:111], v[84:87], v[212:215]
    ds_read_b128 v[40:43], v236 offset:26624
    s_lshl_b32 s62, s76, 15
    v_mfma_f32_16x16x32_bf16 v[176:179], a[112:115], v[88:91], v[176:179]
    ds_read_b128 v[44:47], v236 offset:27648
    s_cmp_eq_u32 s3, s76
    s_cselect_b32 s63, 0, 0x80000000
    s_cselect_b32 s70, s4, 0
    v_mfma_f32_16x16x32_bf16 v[212:215], a[116:119], v[88:91], v[212:215]
    v_mfma_f32_16x16x32_bf16 v[176:179], a[120:123], v[92:95], v[176:179]
    v_mfma_f32_16x16x32_bf16 v[212:215], a[124:127], v[92:95], v[212:215]
    buffer_load_dword v2, v10, s[44:47], s71 offen sc1
    s_waitcnt lgkmcnt(4)
    v_mfma_f32_16x16x32_bf16 v[180:183], a[32:35], v[16:19], v[180:183]
    ds_read_b128 v[80:83], v236 offset:28672
    v_mfma_f32_16x16x32_bf16 v[216:219], a[36:39], v[16:19], v[216:219]
    ds_read_b128 v[84:87], v236 offset:29696
    v_mfma_f32_16x16x32_bf16 v[180:183], a[40:43], v[20:23], v[180:183]
    v_mfma_f32_16x16x32_bf16 v[216:219], a[44:47], v[20:23], v[216:219]
    ds_read_b128 v[88:91], v236 offset:30720
    v_mfma_f32_16x16x32_bf16 v[180:183], a[48:51], v[24:27], v[180:183]
    ds_read_b128 v[92:95], v236 offset:31744
    v_cvt_pk_bf16_f32 v116, v176, v177
    v_mfma_f32_16x16x32_bf16 v[216:219], a[52:55], v[24:27], v[216:219]
    v_cvt_pk_bf16_f32 v117, v178, v179
    v_cvt_pk_bf16_f32 v118, v212, v213
    v_mfma_f32_16x16x32_bf16 v[180:183], a[56:59], v[28:31], v[180:183]
    v_cvt_pk_bf16_f32 v120, v214, v215
    buffer_store_dwordx4 v[116:119], v5, s[44:47], s82 offen offset:0 sc1
    v_mfma_f32_16x16x32_bf16 v[216:219], a[60:63], v[28:31], v[216:219]
    s_waitcnt vmcnt(13)
    s_barrier
    s_waitcnt lgkmcnt(4)
    v_mfma_f32_16x16x32_bf16 v[180:183], a[64:67], v[32:35], v[180:183]
    ds_read_b128 v[16:19], v237 offset:4096
    v_mfma_f32_16x16x32_bf16 v[216:219], a[68:71], v[32:35], v[216:219]
    ds_read_b128 v[20:23], v237 offset:5120
    v_mfma_f32_16x16x32_bf16 v[180:183], a[72:75], v[36:39], v[180:183]
    v_mfma_f32_16x16x32_bf16 v[216:219], a[76:79], v[36:39], v[216:219]
    ds_read_b128 v[24:27], v237 offset:6144
    v_mfma_f32_16x16x32_bf16 v[180:183], a[80:83], v[40:43], v[180:183]
    ds_read_b128 v[28:31], v237 offset:7168
    v_mfma_f32_16x16x32_bf16 v[216:219], a[84:87], v[40:43], v[216:219]
    v_mfma_f32_16x16x32_bf16 v[180:183], a[88:91], v[44:47], v[180:183]
    v_mfma_f32_16x16x32_bf16 v[216:219], a[92:95], v[44:47], v[216:219]
    s_waitcnt lgkmcnt(4)
    v_mfma_f32_16x16x32_bf16 v[180:183], a[96:99], v[80:83], v[180:183]
    ds_read_b128 v[32:35], v237 offset:8192
    v_mfma_f32_16x16x32_bf16 v[216:219], a[100:103], v[80:83], v[216:219]
    ds_read_b128 v[36:39], v237 offset:9216
    v_mfma_f32_16x16x32_bf16 v[180:183], a[104:107], v[84:87], v[180:183]
    v_mfma_f32_16x16x32_bf16 v[216:219], a[108:111], v[84:87], v[216:219]
    ds_read_b128 v[40:43], v237 offset:10240
    v_mfma_f32_16x16x32_bf16 v[180:183], a[112:115], v[88:91], v[180:183]
    ds_read_b128 v[44:47], v237 offset:11264
    v_mfma_f32_16x16x32_bf16 v[216:219], a[116:119], v[88:91], v[216:219]
    v_mfma_f32_16x16x32_bf16 v[180:183], a[120:123], v[92:95], v[180:183]
    v_mfma_f32_16x16x32_bf16 v[216:219], a[124:127], v[92:95], v[216:219]
    s_waitcnt lgkmcnt(4)
    v_mfma_f32_16x16x32_bf16 v[184:187], a[160:163], v[16:19], v[184:187]
    ds_read_b128 v[80:83], v237 offset:12288
    v_mfma_f32_16x16x32_bf16 v[220:223], a[164:167], v[16:19], v[220:223]
    ds_read_b128 v[84:87], v237 offset:13312
    v_mfma_f32_16x16x32_bf16 v[184:187], a[168:171], v[20:23], v[184:187]
    v_mfma_f32_16x16x32_bf16 v[220:223], a[172:175], v[20:23], v[220:223]
    ds_read_b128 v[88:91], v237 offset:14336
    v_mfma_f32_16x16x32_bf16 v[184:187], a[176:179], v[24:27], v[184:187]
    ds_read_b128 v[92:95], v237 offset:15360
    v_cvt_pk_bf16_f32 v112, v180, v181
    v_mfma_f32_16x16x32_bf16 v[220:223], a[180:183], v[24:27], v[220:223]
    v_cvt_pk_bf16_f32 v113, v182, v183
    v_cvt_pk_bf16_f32 v114, v216, v217
    v_mfma_f32_16x16x32_bf16 v[184:187], a[184:187], v[28:31], v[184:187]
    v_cvt_pk_bf16_f32 v121, v218, v219
    buffer_store_dwordx4 v[112:115], v5, s[44:47], s82 offen offset:1024 sc1
    v_mfma_f32_16x16x32_bf16 v[220:223], a[188:191], v[28:31], v[220:223]
    buffer_store_dwordx4 v[120:123], v5, s[44:47], s82 offen offset:2048 sc1
    s_waitcnt lgkmcnt(4)
    v_mfma_f32_16x16x32_bf16 v[184:187], a[192:195], v[32:35], v[184:187]
    ds_read_b128 v[16:19], v237 offset:16384
    v_mfma_f32_16x16x32_bf16 v[220:223], a[196:199], v[32:35], v[220:223]
    ds_read_b128 v[20:23], v237 offset:17408
    v_mfma_f32_16x16x32_bf16 v[184:187], a[200:203], v[36:39], v[184:187]
    v_mfma_f32_16x16x32_bf16 v[220:223], a[204:207], v[36:39], v[220:223]
    ds_read_b128 v[24:27], v237 offset:18432
    v_mfma_f32_16x16x32_bf16 v[184:187], a[208:211], v[40:43], v[184:187]
    ds_read_b128 v[28:31], v237 offset:19456
    v_mfma_f32_16x16x32_bf16 v[220:223], a[212:215], v[40:43], v[220:223]
    v_mfma_f32_16x16x32_bf16 v[184:187], a[216:219], v[44:47], v[184:187]
    v_mfma_f32_16x16x32_bf16 v[220:223], a[220:223], v[44:47], v[220:223]
    s_waitcnt lgkmcnt(4)
    v_mfma_f32_16x16x32_bf16 v[184:187], a[224:227], v[80:83], v[184:187]
    ds_read_b128 v[32:35], v237 offset:20480
    v_mfma_f32_16x16x32_bf16 v[220:223], a[228:231], v[80:83], v[220:223]
    ds_read_b128 v[36:39], v237 offset:21504
    v_mfma_f32_16x16x32_bf16 v[184:187], a[232:235], v[84:87], v[184:187]
    v_mfma_f32_16x16x32_bf16 v[220:223], a[236:239], v[84:87], v[220:223]
    ds_read_b128 v[40:43], v237 offset:22528
    v_mfma_f32_16x16x32_bf16 v[184:187], a[240:243], v[88:91], v[184:187]
    ds_read_b128 v[44:47], v237 offset:23552
    v_mfma_f32_16x16x32_bf16 v[220:223], a[244:247], v[88:91], v[220:223]
    v_mfma_f32_16x16x32_bf16 v[184:187], a[248:251], v[92:95], v[184:187]
    v_mfma_f32_16x16x32_bf16 v[220:223], a[252:255], v[92:95], v[220:223]
    s_waitcnt lgkmcnt(4)
    v_mfma_f32_16x16x32_bf16 v[188:191], a[160:163], v[16:19], v[188:191]
    ds_read_b128 v[80:83], v237 offset:24576
    v_mfma_f32_16x16x32_bf16 v[224:227], a[164:167], v[16:19], v[224:227]
    ds_read_b128 v[84:87], v237 offset:25600
    v_mfma_f32_16x16x32_bf16 v[188:191], a[168:171], v[20:23], v[188:191]
    v_mfma_f32_16x16x32_bf16 v[224:227], a[172:175], v[20:23], v[224:227]
    ds_read_b128 v[88:91], v237 offset:26624
    v_mfma_f32_16x16x32_bf16 v[188:191], a[176:179], v[24:27], v[188:191]
    ds_read_b128 v[92:95], v237 offset:27648
    v_mfma_f32_16x16x32_bf16 v[224:227], a[180:183], v[24:27], v[224:227]
    v_mfma_f32_16x16x32_bf16 v[188:191], a[184:187], v[28:31], v[188:191]
    v_mfma_f32_16x16x32_bf16 v[224:227], a[188:191], v[28:31], v[224:227]
    s_waitcnt vmcnt(6)
    s_barrier
    s_waitcnt lgkmcnt(4)
    v_mfma_f32_16x16x32_bf16 v[188:191], a[192:195], v[32:35], v[188:191]
    ds_read_b128 v[16:19], v236 offset:32768
    v_mfma_f32_16x16x32_bf16 v[224:227], a[196:199], v[32:35], v[224:227]
    ds_read_b128 v[20:23], v236 offset:33792
    v_mfma_f32_16x16x32_bf16 v[188:191], a[200:203], v[36:39], v[188:191]
    v_mfma_f32_16x16x32_bf16 v[224:227], a[204:207], v[36:39], v[224:227]
    ds_read_b128 v[24:27], v236 offset:34816
    v_mfma_f32_16x16x32_bf16 v[188:191], a[208:211], v[40:43], v[188:191]
    ds_read_b128 v[28:31], v236 offset:35840
    v_mfma_f32_16x16x32_bf16 v[224:227], a[212:215], v[40:43], v[224:227]
    v_mfma_f32_16x16x32_bf16 v[188:191], a[216:219], v[44:47], v[188:191]
    v_mfma_f32_16x16x32_bf16 v[224:227], a[220:223], v[44:47], v[224:227]
    s_waitcnt lgkmcnt(4)
    v_mfma_f32_16x16x32_bf16 v[188:191], a[224:227], v[80:83], v[188:191]
    ds_read_b128 v[32:35], v236 offset:36864
    v_mfma_f32_16x16x32_bf16 v[224:227], a[228:231], v[80:83], v[224:227]
    ds_read_b128 v[36:39], v236 offset:37888
    v_mfma_f32_16x16x32_bf16 v[188:191], a[232:235], v[84:87], v[188:191]
    v_mfma_f32_16x16x32_bf16 v[224:227], a[236:239], v[84:87], v[224:227]
    ds_read_b128 v[40:43], v236 offset:38912
    v_mfma_f32_16x16x32_bf16 v[188:191], a[240:243], v[88:91], v[188:191]
    ds_read_b128 v[44:47], v236 offset:39936
    v_mfma_f32_16x16x32_bf16 v[224:227], a[244:247], v[88:91], v[224:227]
    v_mfma_f32_16x16x32_bf16 v[188:191], a[248:251], v[92:95], v[188:191]
    v_mfma_f32_16x16x32_bf16 v[224:227], a[252:255], v[92:95], v[224:227]
    s_waitcnt vmcnt(3)
    v_cmp_ne_u32 vcc, s4, v2
    s_cbranch_vccz L_get
    buffer_load_dword v2, v10, s[44:47], s71 offen sc1
L_got:
    s_waitcnt lgkmcnt(4)
    v_mfma_f32_16x16x32_bf16 v[184:187], a[32:35], v[16:19], v[184:187]
    ds_read_b128 v[80:83], v236 offset:40960
    v_mfma_f32_16x16x32_bf16 v[220:223], a[36:39], v[16:19], v[220:223]
    ds_read_b128 v[84:87], v236 offset:41984
    v_mfma_f32_16x16x32_bf16 v[184:187], a[40:43], v[20:23], v[184:187]
    v_mfma_f32_16x16x32_bf16 v[220:223], a[44:47], v[20:23], v[220:223]
    ds_read_b128 v[88:91], v236 offset:43008
    v_mfma_f32_16x16x32_bf16 v[184:187], a[48:51], v[24:27], v[184:187]
    ds_read_b128 v[92:95], v236 offset:44032
    v_mfma_f32_16x16x32_bf16 v[220:223], a[52:55], v[24:27], v[220:223]
    v_mfma_f32_16x16x32_bf16 v[184:187], a[56:59], v[28:31], v[184:187]
    v_mfma_f32_16x16x32_bf16 v[220:223], a[60:63], v[28:31], v[220:223]
    s_waitcnt lgkmcnt(4)
    v_mfma_f32_16x16x32_bf16 v[184:187], a[64:67], v[32:35], v[184:187]
    ds_read_b128 v[16:19], v5 offset:49152
    v_mfma_f32_16x16x32_bf16 v[220:223], a[68:71], v[32:35], v[220:223]
    ds_read_b128 v[20:23], v5 offset:50176
    v_mfma_f32_16x16x32_bf16 v[184:187], a[72:75], v[36:39], v[184:187]
    v_mfma_f32_16x16x32_bf16 v[220:223], a[76:79], v[36:39], v[220:223]
    ds_read_b128 v[24:27], v5 offset:51200
    v_mfma_f32_16x16x32_bf16 v[184:187], a[80:83], v[40:43], v[184:187]
    ds_read_b128 v[28:31], v5 offset:52224
    v_mfma_f32_16x16x32_bf16 v[220:223], a[84:87], v[40:43], v[220:223]
    v_mfma_f32_16x16x32_bf16 v[184:187], a[88:91], v[44:47], v[184:187]
    v_mfma_f32_16x16x32_bf16 v[220:223], a[92:95], v[44:47], v[220:223]
    s_waitcnt lgkmcnt(4)
    v_mfma_f32_16x16x32_bf16 v[184:187], a[96:99], v[80:83], v[184:187]
    ds_read_b128 v[32:35], v5 offset:53248
    v_mfma_f32_16x16x32_bf16 v[220:223], a[100:103], v[80:83], v[220:223]
    ds_read_b128 v[36:39], v5 offset:54272
    v_mfma_f32_16x16x32_bf16 v[184:187], a[104:107], v[84:87], v[184:187]
    v_mfma_f32_16x16x32_bf16 v[220:223], a[108:111], v[84:87], v[220:223]
    ds_read_b128 v[40:43], v5 offset:55296
    v_mfma_f32_16x16x32_bf16 v[184:187], a[112:115], v[88:91], v[184:187]
    ds_read_b128 v[44:47], v5 offset:56320
    v_mfma_f32_16x16x32_bf16 v[220:223], a[116:119], v[88:91], v[220:223]
    v_mfma_f32_16x16x32_bf16 v[184:187], a[120:123], v[92:95], v[184:187]
    v_mfma_f32_16x16x32_bf16 v[220:223], a[124:127], v[92:95], v[220:223]
    s_waitcnt lgkmcnt(4)
    v_mfma_f32_16x16x32_bf16 v[188:191], a[32:35], v[16:19], v[188:191]
    ds_read_b128 v[80:83], v5 offset:57344
    v_mfma_f32_16x16x32_bf16 v[224:227], a[36:39], v[16:19], v[224:227]
    ds_read_b128 v[84:87], v5 offset:58368
    v_mfma_f32_16x16x32_bf16 v[188:191], a[40:43], v[20:23], v[188:191]
    v_mfma_f32_16x16x32_bf16 v[224:227], a[44:47], v[20:23], v[224:227]
    ds_read_b128 v[88:91], v5 offset:59392
    v_mfma_f32_16x16x32_bf16 v[188:191], a[48:51], v[24:27], v[188:191]
    ds_read_b128 v[92:95], v5 offset:60416
    v_mfma_f32_16x16x32_bf16 v[224:227], a[52:55], v[24:27], v[224:227]
    v_mfma_f32_16x16x32_bf16 v[188:191], a[56:59], v[28:31], v[188:191]
    v_mfma_f32_16x16x32_bf16 v[224:227], a[60:63], v[28:31], v[224:227]
    s_waitcnt lgkmcnt(4)
    v_mfma_f32_16x16x32_bf16 v[188:191], a[64:67], v[32:35], v[188:191]
    v_mfma_f32_16x16x32_bf16 v[224:227], a[68:71], v[32:35], v[224:227]
    v_mfma_f32_16x16x32_bf16 v[188:191], a[72:75], v[36:39], v[188:191]
    v_mfma_f32_16x16x32_bf16 v[224:227], a[76:79], v[36:39], v[224:227]
    v_mfma_f32_16x16x32_bf16 v[188:191], a[80:83], v[40:43], v[188:191]
    v_mfma_f32_16x16x32_bf16 v[224:227], a[84:87], v[40:43], v[224:227]
    v_mfma_f32_16x16x32_bf16 v[188:191], a[88:91], v[44:47], v[188:191]
    v_mfma_f32_16x16x32_bf16 v[224:227], a[92:95], v[44:47], v[224:227]
    s_waitcnt lgkmcnt(0)
    v_mfma_f32_16x16x32_bf16 v[188:191], a[96:99], v[80:83], v[188:191]
    v_mfma_f32_16x16x32_bf16 v[224:227], a[100:103], v[80:83], v[224:227]
    v_mfma_f32_16x16x32_bf16 v[188:191], a[104:107], v[84:87], v[188:191]
    v_mfma_f32_16x16x32_bf16 v[224:227], a[108:111], v[84:87], v[224:227]
    v_mfma_f32_16x16x32_bf16 v[188:191], a[112:115], v[88:91], v[188:191]
    v_mfma_f32_16x16x32_bf16 v[224:227], a[116:119], v[88:91], v[224:227]
    v_mfma_f32_16x16x32_bf16 v[188:191], a[120:123], v[92:95], v[188:191]
    v_mfma_f32_16x16x32_bf16 v[224:227], a[124:127], v[92:95], v[224:227]
    s_cbranch_vccz L_have
L_poll2:
    s_waitcnt vmcnt(0)
    v_cmp_ne_u32 vcc, s4, v2
    s_cbranch_vccnz L_poll2b
L_poll2r:
    s_add_u32 s60, s71, 0
    s_or_b32 s61, s60, s63
    buffer_load_dwordx4 v[112:115], v5, s[44:47], s60 offen offset:0 sc1
    buffer_load_dwordx4 v[116:119], v5, s[44:47], s60 offen offset:1024 sc1
    buffer_load_dwordx4 v[120:123], v5, s[44:47], s60 offen offset:2048 sc1
    buffer_load_dwordx4 v[124:127], v5, s[44:47], s61 offen offset:3072 sc1
    s_add_u32 s60, s71, 16384
    s_or_b32 s61, s60, s63
    buffer_load_dwordx4 v[128:131], v5, s[44:47], s60 offen offset:0 sc1
    buffer_load_dwordx4 v[132:135], v5, s[44:47], s60 offen offset:1024 sc1
    buffer_load_dwordx4 v[136:139], v5, s[44:47], s60 offen offset:2048 sc1
    buffer_load_dwordx4 v[140:143], v5, s[44:47], s61 offen offset:3072 sc1
    s_add_u32 s60, s71, 32768
    s_or_b32 s61, s60, s63
    buffer_load_dwordx4 v[144:147], v5, s[44:47], s60 offen offset:0 sc1
    buffer_load_dwordx4 v[148:151], v5, s[44:47], s60 offen offset:1024 sc1
    buffer_load_dwordx4 v[152:155], v5, s[44:47], s60 offen offset:2048 sc1
    buffer_load_dwordx4 v[156:159], v5, s[44:47], s61 offen offset:3072 sc1
L_have:
    s_waitcnt vmcnt(8)
L_ck0:
    v_xor_b32 v2, s4, v115
    v_xor_b32 v3, s4, v119
    v_xor_b32 v4, s4, v123
    v_xor_b32 v13, s70, v127
    v_or3_b32 v2, v2, v3, v4
    v_or_b32 v2, v2, v13
    v_cmp_ne_u32 vcc, 0, v2
    s_cbranch_vccnz L_re0
L_ok0r:
    v_mov_b32 v115, v120
    v_mov_b32 v119, v121
    v_mov_b32 v127, v122
    s_nop 0
    v_mfma_f32_16x16x32_bf16 v[184:187], v[96:99], v[112:115], v[184:187]
    v_mfma_f32_16x16x32_bf16 v[220:223], v[100:103], v[112:115], v[220:223]
    v_mfma_f32_16x16x32_bf16 v[188:191], v[96:99], v[116:119], v[188:191]
    v_mfma_f32_16x16x32_bf16 v[224:227], v[100:103], v[116:119], v[224:227]
    v_mfma_f32_16x16x32_bf16 v[192:195], v[96:99], v[124:127], v[192:195]
    v_mfma_f32_16x16x32_bf16 v[228:231], v[100:103], v[124:127], v[228:231]
    s_waitcnt vmcnt(4)
L_ck1:
    v_xor_b32 v2, s4, v131
    v_xor_b32 v3, s4, v135
    v_xor_b32 v4, s4, v139
    v_xor_b32 v13, s70, v143
    v_or3_b32 v2, v2, v3, v4
    v_or_b32 v2, v2, v13
    v_cmp_ne_u32 vcc, 0, v2
    s_cbranch_vccnz L_re1
L_ok1r:
    v_mov_b32 v131, v136
    v_mov_b32 v135, v137
    v_mov_b32 v143, v138
    s_nop 0
    v_mfma_f32_16x16x32_bf16 v[184:187], v[96:99], v[128:131], v[184:187]
    v_mfma_f32_16x16x32_bf16 v[220:223], v[100:103], v[128:131], v[220:223]
    v_mfma_f32_16x16x32_bf16 v[188:191], v[96:99], v[132:135], v[188:191]
    v_mfma_f32_16x16x32_bf16 v[224:227], v[100:103], v[132:135], v[224:227]
    v_mfma_f32_16x16x32_bf16 v[192:195], v[96:99], v[140:143], v[192:195]
    v_mfma_f32_16x16x32_bf16 v[228:231], v[100:103], v[140:143], v[228:231]
    s_waitcnt vmcnt(0)
L_ck2:
    v_xor_b32 v2, s4, v147
    v_xor_b32 v3, s4, v151
    v_xor_b32 v4, s4, v155
    v_xor_b32 v13, s70, v159
    v_or3_b32 v2, v2, v3, v4
    v_or_b32 v2, v2, v13
    v_cmp_ne_u32 vcc, 0, v2
    s_cbranch_vccnz L_re2
L_ok2r:
    v_mov_b32 v147, v152
    v_mov_b32 v151, v153
    v_mov_b32 v159, v154
    s_nop 0
    v_mfma_f32_16x16x32_bf16 v[184:187], v[96:99], v[144:147], v[184:187]
    v_mfma_f32_16x16x32_bf16 v[220:223], v[100:103], v[144:147], v[220:223]
    v_mfma_f32_16x16x32_bf16 v[188:191], v[96:99], v[148:151], v[188:191]
    v_mfma_f32_16x16x32_bf16 v[224:227], v[100:103], v[148:151], v[224:227]
    v_mfma_f32_16x16x32_bf16 v[192:195], v[96:99], v[156:159], v[192:195]
    v_mfma_f32_16x16x32_bf16 v[228:231], v[100:103], v[156:159], v[228:231]
    s_add_u32 s61, s62, 16384
    s_or_b32 s63, s63, 131072
    s_nop 1
    v_cvt_pk_bf16_f32 v16, v184, v185
    v_cvt_pk_bf16_f32 v17, v186, v187
    v_cvt_pk_bf16_f32 v18, v220, v221
    v_cvt_pk_bf16_f32 v19, v222, v223
    buffer_store_dwordx4 v[16:19], v12, s[48:51], s62 offen
    v_cvt_pk_bf16_f32 v20, v188, v189
    v_cvt_pk_bf16_f32 v21, v190, v191
    v_cvt_pk_bf16_f32 v22, v224, v225
    v_cvt_pk_bf16_f32 v23, v226, v227
    buffer_store_dwordx4 v[20:23], v12, s[48:51], s61 offen
    s_nop 1
    v_cvt_pk_bf16_f32 v24, v192, v193
    v_cvt_pk_bf16_f32 v25, v194, v195
    v_cvt_pk_bf16_f32 v26, v228, v229
    v_cvt_pk_bf16_f32 v27, v230, v231
    buffer_store_dwordx4 v[24:27], v12, s[48:51], s63 offen
    s_endpgm
L_pc84:
    s_sub_i32 s75, s75, 1
    s_cmp_lt_i32 s75, 0
    s_cbranch_scc1 L_pc84r
    ds_read_b32 v8, v7
    s_waitcnt lgkmcnt(0)
    v_cmp_gt_u32 vcc, 1, v8
    s_cbranch_vccnz L_pc84
    s_branch L_pc84r
L_pc85:
    s_sub_i32 s75, s75, 1
    s_cmp_lt_i32 s75, 0
    s_cbranch_scc1 L_pc85r
    ds_read_b32 v8, v7
    s_waitcnt lgkmcnt(0)
    v_cmp_gt_u32 vcc, 2, v8
    s_cbranch_vccnz L_pc85
    s_branch L_pc85r
L_pc86:
    s_sub_i32 s75, s75, 1
    s_cmp_lt_i32 s75, 0
    s_cbranch_scc1 L_pc86r
    ds_read_b32 v8, v7
    s_waitcnt lgkmcnt(0)
    v_cmp_gt_u32 vcc, 3, v8
    s_cbranch_vccnz L_pc86
    s_branch L_pc86r
L_pc87:
    s_sub_i32 s75, s75, 1
    s_cmp_lt_i32 s75, 0
    s_cbranch_scc1 L_pc87r
    ds_read_b32 v8, v7
    s_waitcnt lgkmcnt(0)
    v_cmp_gt_u32 vcc, 4, v8
    s_cbranch_vccnz L_pc87
    s_branch L_pc87r
L_pc88:
    s_sub_i32 s75, s75, 1
    s_cmp_lt_i32 s75, 0
    s_cbranch_scc1 L_pc88r
    ds_read_b32 v8, v7
    s_waitcnt lgkmcnt(0)
    v_cmp_gt_u32 vcc, 5, v8
    s_cbranch_vccnz L_pc88
    s_branch L_pc88r
L_pc89:
    s_sub_i32 s75, s75, 1
    s_cmp_lt_i32 s75, 0
    s_cbranch_scc1 L_pc89r
    ds_read_b32 v8, v7
    s_waitcnt lgkmcnt(0)
    v_cmp_gt_u32 vcc, 6, v8
    s_cbranch_vccnz L_pc89
    s_branch L_pc89r
L_pc90:
    s_sub_i32 s75, s75, 1
    s_cmp_lt_i32 s75, 0
    s_cbranch_scc1 L_pc90r
    ds_read_b32 v8, v7
    s_waitcnt lgkmcnt(0)
    v_cmp_gt_u32 vcc, 7, v8
    s_cbranch_vccnz L_pc90
    s_branch L_pc90r
L_pc91:
    s_sub_i32 s75, s75, 1
    s_cmp_lt_i32 s75, 0
    s_cbranch_scc1 L_pc91r
    ds_read_b32 v8, v7
    s_waitcnt lgkmcnt(0)
    v_cmp_gt_u32 vcc, 8, v8
    s_cbranch_vccnz L_pc91
    s_branch L_pc91r
L_pc92:
    s_sub_i32 s75, s75, 1
    s_cmp_lt_i32 s75, 0
    s_cbranch_scc1 L_pc92r
    ds_read_b32 v8, v7
    s_waitcnt lgkmcnt(0)
    v_cmp_gt_u32 vcc, 9, v8
    s_cbranch_vccnz L_pc92
    s_branch L_pc92r
L_pc93:
    s_sub_i32 s75, s75, 1
    s_cmp_lt_i32 s75, 0
    s_cbranch_scc1 L_pc93r
    ds_read_b32 v8, v7
    s_waitcnt lgkmcnt(0)
    v_cmp_gt_u32 vcc, 10, v8
    s_cbranch_vccnz L_pc93
    s_branch L_pc93r
L_pc94:
    s_sub_i32 s75, s75, 1
    s_cmp_lt_i32 s75, 0
    s_cbranch_scc1 L_pc94r
    ds_read_b32 v8, v7
    s_waitcnt lgkmcnt(0)
    v_cmp_gt_u32 vcc, 12, v8
    s_cbranch_vccnz L_pc94
    s_branch L_pc94r
L_pc95:
    s_sub_i32 s75, s75, 1
    s_cmp_lt_i32 s75, 0
    s_cbranch_scc1 L_pc95r
    ds_read_b32 v8, v7
    s_waitcnt lgkmcnt(0)
    v_cmp_gt_u32 vcc, 16, v8
    s_cbranch_vccnz L_pc95
    s_branch L_pc95r
L_pc96:
    s_sub_i32 s75, s75, 1
    s_cmp_lt_i32 s75, 0
    s_cbranch_scc1 L_pc96r
    ds_read_b32 v8, v7
    s_waitcnt lgkmcnt(0)
    v_cmp_gt_u32 vcc, s67, v8
    s_cbranch_vccnz L_pc96
    s_branch L_pc96r
L_pc97:
    s_sub_i32 s75, s75, 1
    s_cmp_lt_i32 s75, 0
    s_cbranch_scc1 L_pc97r
    ds_read_b32 v8, v7
    s_waitcnt lgkmcnt(0)
    v_cmp_gt_u32 vcc, s67, v8
    s_cbranch_vccnz L_pc97
    s_branch L_pc97r
L_pc98:
    s_sub_i32 s75, s75, 1
    s_cmp_lt_i32 s75, 0
    s_cbranch_scc1 L_pc98r
    ds_read_b32 v8, v7
    s_waitcnt lgkmcnt(0)
    v_cmp_gt_u32 vcc, s67, v8
    s_cbranch_vccnz L_pc98
    s_branch L_pc98r
L_pc99:
    s_sub_i32 s75, s75, 1
    s_cmp_lt_i32 s75, 0
    s_cbranch_scc1 L_pc99r
    ds_read_b32 v8, v7
    s_waitcnt lgkmcnt(0)
    v_cmp_gt_u32 vcc, s67, v8
    s_cbranch_vccnz L_pc99
    s_branch L_pc99r
L_pc100:
    s_sub_i32 s75, s75, 1
    s_cmp_lt_i32 s75, 0
    s_cbranch_scc1 L_pc100r
    ds_read_b32 v8, v7
    s_waitcnt lgkmcnt(0)
    v_cmp_gt_u32 vcc, s67, v8
    s_cbranch_vccnz L_pc100
    s_branch L_pc100r
L_pc101:
    s_sub_i32 s75, s75, 1
    s_cmp_lt_i32 s75, 0
    s_cbranch_scc1 L_pc101r
    ds_read_b32 v8, v7
    s_waitcnt lgkmcnt(0)
    v_cmp_gt_u32 vcc, s67, v8
    s_cbranch_vccnz L_pc101
    s_branch L_pc101r
L_pc102:
    s_sub_i32 s75, s75, 1
    s_cmp_lt_i32 s75, 0
    s_cbranch_scc1 L_pc102r
    ds_read_b32 v8, v7
    s_waitcnt lgkmcnt(0)
    v_cmp_gt_u32 vcc, s67, v8
    s_cbranch_vccnz L_pc102
    s_branch L_pc102r
L_pc103:
    s_sub_i32 s75, s75, 1
    s_cmp_lt_i32 s75, 0
    s_cbranch_scc1 L_pc103r
    ds_read_b32 v8, v7
    s_waitcnt lgkmcnt(0)
    v_cmp_gt_u32 vcc, s67, v8
    s_cbranch_vccnz L_pc103
    s_branch L_pc103r
L_pc104:
    s_sub_i32 s75, s75, 1
    s_cmp_lt_i32 s75, 0
    s_cbranch_scc1 L_pc104r
    ds_read_b32 v8, v7
    s_waitcnt lgkmcnt(0)
    v_cmp_gt_u32 vcc, s67, v8
    s_cbranch_vccnz L_pc104
    s_branch L_pc104r
L_pc105:
    s_sub_i32 s75, s75, 1
    s_cmp_lt_i32 s75, 0
    s_cbranch_scc1 L_pc105r
    ds_read_b32 v8, v7
    s_waitcnt lgkmcnt(0)
    v_cmp_gt_u32 vcc, s67, v8
    s_cbranch_vccnz L_pc105
    s_branch L_pc105r
L_pc106:
    s_sub_i32 s75, s75, 1
    s_cmp_lt_i32 s75, 0
    s_cbranch_scc1 L_pc106r
    ds_read_b32 v8, v7
    s_waitcnt lgkmcnt(0)
    v_cmp_gt_u32 vcc, s67, v8
    s_cbranch_vccnz L_pc106
    s_branch L_pc106r
L_pc107:
    s_sub_i32 s75, s75, 1
    s_cmp_lt_i32 s75, 0
    s_cbranch_scc1 L_pc107r
    ds_read_b32 v8, v7
    s_waitcnt lgkmcnt(0)
    v_cmp_gt_u32 vcc, s67, v8
    s_cbranch_vccnz L_pc107
    s_branch L_pc107r
L_pc108:
    s_sub_i32 s75, s75, 1
    s_cmp_lt_i32 s75, 0
    s_cbranch_scc1 L_pc108r
    ds_read_b32 v8, v7
    s_waitcnt lgkmcnt(0)
    v_cmp_gt_u32 vcc, s67, v8
    s_cbranch_vccnz L_pc108
    s_branch L_pc108r
L_pc109:
    s_sub_i32 s75, s75, 1
    s_cmp_lt_i32 s75, 0
    s_cbranch_scc1 L_pc109r
    ds_read_b32 v8, v7
    s_waitcnt lgkmcnt(0)
    v_cmp_gt_u32 vcc, s67, v8
    s_cbranch_vccnz L_pc109
    s_branch L_pc109r
L_pc110:
    s_sub_i32 s75, s75, 1
    s_cmp_lt_i32 s75, 0
    s_cbranch_scc1 L_pc110r
    ds_read_b32 v8, v7
    s_waitcnt lgkmcnt(0)
    v_cmp_gt_u32 vcc, s67, v8
    s_cbranch_vccnz L_pc110
    s_branch L_pc110r
L_pc111:
    s_sub_i32 s75, s75, 1
    s_cmp_lt_i32 s75, 0
    s_cbranch_scc1 L_pc111r
    ds_read_b32 v8, v7
    s_waitcnt lgkmcnt(0)
    v_cmp_gt_u32 vcc, s67, v8
    s_cbranch_vccnz L_pc111
    s_branch L_pc111r
L_pc112:
    s_sub_i32 s75, s75, 1
    s_cmp_lt_i32 s75, 0
    s_cbranch_scc1 L_pc112r
    v_and_b32 v30, 3, v1
    v_lshlrev_b32 v30, 2, v30
    v_add_u32 v30, 163584, v30
    ds_read_b32 v30, v30
    ds_read_b32 v8, v7
    s_waitcnt lgkmcnt(0)
    v_cmp_eq_u32 vcc, 2, v30
    s_cbranch_vccnz L_hredo
    v_cmp_gt_u32 vcc, s67, v8
    s_cbranch_vccnz L_pc112
    s_branch L_pc112r
L_pc113:
    s_sub_i32 s75, s75, 1
    s_cmp_lt_i32 s75, 0
    s_cbranch_scc1 L_pc113r
    ds_read_b32 v8, v7
    s_waitcnt lgkmcnt(0)
    v_cmp_gt_u32 vcc, s67, v8
    s_cbranch_vccnz L_pc113
    s_branch L_pc113r
L_pc114:
    s_sub_i32 s75, s75, 1
    s_cmp_lt_i32 s75, 0
    s_cbranch_scc1 L_pc114r
    s_max_u32 s6, s6, 832
    v_max_u32 v9, 52, v9
    ds_write_b32 v6, v9
    ds_read_b32 v8, v7
    s_waitcnt lgkmcnt(0)
    v_cmp_gt_u32 vcc, 52, v8
    s_cbranch_vccnz L_pc114
    s_branch L_pc114r
L_tok2:
    s_sub_i32 s75, s75, 1
    s_cmp_lt_i32 s75, 0
    s_cbranch_scc1 L_tokok
    buffer_load_dwordx2 v[56:57], v54, s[56:59], 0 offen sc1
    s_waitcnt vmcnt(0)
    s_branch L_tok
L_pc115:
    s_sub_i32 s75, s75, 1
    s_cmp_lt_i32 s75, 0
    s_cbranch_scc1 L_pc115r
    s_max_u32 s6, s6, 880
    v_max_u32 v9, 55, v9
    ds_write_b32 v6, v9
    ds_read_b32 v8, v7
    s_waitcnt lgkmcnt(0)
    v_cmp_gt_u32 vcc, 55, v8
    s_cbranch_vccnz L_pc115
    s_branch L_pc115r
L_pc116:
    s_sub_i32 s75, s75, 1
    s_cmp_lt_i32 s75, 0
    s_cbranch_scc1 L_pc116r
    s_max_u32 s6, s6, 848
    v_max_u32 v9, 53, v9
    ds_write_b32 v6, v9
    ds_read_b32 v8, v7
    s_waitcnt lgkmcnt(0)
    v_cmp_gt_u32 vcc, 53, v8
    s_cbranch_vccnz L_pc116
    s_branch L_pc116r
L_pc120:
    s_sub_i32 s75, s75, 1
    s_cmp_lt_i32 s75, 0
    s_cbranch_scc1 L_pc120r
    s_max_u32 s6, s6, 864
    v_max_u32 v9, 54, v9
    ds_write_b32 v6, v9
    ds_read_b32 v8, v7
    s_waitcnt lgkmcnt(0)
    v_cmp_gt_u32 vcc, 54, v8
    s_cbranch_vccnz L_pc120
    s_branch L_pc120r
L_pc123:
    s_sub_i32 s75, s75, 1
    s_cmp_lt_i32 s75, 0
    s_cbranch_scc1 L_pc123r
    s_max_u32 s6, s6, 928
    v_max_u32 v9, 58, v9
    ds_write_b32 v6, v9
    ds_read_b32 v8, v7
    s_waitcnt lgkmcnt(0)
    v_cmp_gt_u32 vcc, 58, v8
    s_cbranch_vccnz L_pc123
    s_branch L_pc123r
L_pc126:
    s_sub_i32 s75, s75, 1
    s_cmp_lt_i32 s75, 0
    s_cbranch_scc1 L_pc126r
    s_max_u32 s6, s6, 896
    v_max_u32 v9, 56, v9
    ds_write_b32 v6, v9
    ds_read_b32 v8, v7
    s_waitcnt lgkmcnt(0)
    v_cmp_gt_u32 vcc, 56, v8
    s_cbranch_vccnz L_pc126
    s_branch L_pc126r
L_pc131:
    s_sub_i32 s75, s75, 1
    s_cmp_lt_i32 s75, 0
    s_cbranch_scc1 L_pc131r
    s_max_u32 s6, s6, 912
    v_max_u32 v9, 57, v9
    ds_write_b32 v6, v9
    ds_read_b32 v8, v7
    s_waitcnt lgkmcnt(0)
    v_cmp_gt_u32 vcc, 57, v8
    s_cbranch_vccnz L_pc131
    s_branch L_pc131r
L_pc135:
    s_sub_i32 s75, s75, 1
    s_cmp_lt_i32 s75, 0
    s_cbranch_scc1 L_pc135r
    s_max_u32 s6, s6, 1008
    v_max_u32 v9, 63, v9
    ds_write_b32 v6, v9
    ds_read_b32 v8, v7
    s_waitcnt lgkmcnt(0)
    v_cmp_gt_u32 vcc, 63, v8
    s_cbranch_vccnz L_pc135
    s_branch L_pc135r
L_pc137:
    s_sub_i32 s75, s75, 1
    s_cmp_lt_i32 s75, 0
    s_cbranch_scc1 L_pc137r
    s_max_u32 s6, s6, 944
    v_max_u32 v9, 59, v9
    ds_write_b32 v6, v9
    ds_read_b32 v8, v7
    s_waitcnt lgkmcnt(0)
    v_cmp_gt_u32 vcc, 59, v8
    s_cbranch_vccnz L_pc137
    s_branch L_pc137r
L_pc142:
    s_sub_i32 s75, s75, 1
    s_cmp_lt_i32 s75, 0
    s_cbranch_scc1 L_pc142r
    s_max_u32 s6, s6, 960
    v_max_u32 v9, 60, v9
    ds_write_b32 v6, v9
    ds_read_b32 v8, v7
    s_waitcnt lgkmcnt(0)
    v_cmp_gt_u32 vcc, 60, v8
    s_cbranch_vccnz L_pc142
    s_branch L_pc142r
L_pc147:
    s_sub_i32 s75, s75, 1
    s_cmp_lt_i32 s75, 0
    s_cbranch_scc1 L_pc147r
    s_max_u32 s6, s6, 976
    v_max_u32 v9, 61, v9
    ds_write_b32 v6, v9
    ds_read_b32 v8, v7
    s_waitcnt lgkmcnt(0)
    v_cmp_gt_u32 vcc, 61, v8
    s_cbranch_vccnz L_pc147
    s_branch L_pc147r
L_pc148:
    s_sub_i32 s75, s75, 1
    s_cmp_lt_i32 s75, 0
    s_cbranch_scc1 L_pc148r
    s_max_u32 s6, s6, 1056
    v_max_u32 v9, 66, v9
    ds_write_b32 v6, v9
    ds_read_b32 v8, v7
    s_waitcnt lgkmcnt(0)
    v_cmp_gt_u32 vcc, 66, v8
    s_cbranch_vccnz L_pc148
    s_branch L_pc148r
L_pc153:
    s_sub_i32 s75, s75, 1
    s_cmp_lt_i32 s75, 0
    s_cbranch_scc1 L_pc153r
    s_max_u32 s6, s6, 992
    v_max_u32 v9, 62, v9
    ds_write_b32 v6, v9
    ds_read_b32 v8, v7
    s_waitcnt lgkmcnt(0)
    v_cmp_gt_u32 vcc, 62, v8
    s_cbranch_vccnz L_pc153
    s_branch L_pc153r
L_pc158:
    s_sub_i32 s75, s75, 1
    s_cmp_lt_i32 s75, 0
    s_cbranch_scc1 L_pc158r
    s_max_u32 s6, s6, 1024
    v_max_u32 v9, 64, v9
    ds_write_b32 v6, v9
    ds_read_b32 v8, v7
    s_waitcnt lgkmcnt(0)
    v_cmp_gt_u32 vcc, 64, v8
    s_cbranch_vccnz L_pc158
    s_branch L_pc158r
L_pc160:
    s_sub_i32 s75, s75, 1
    s_cmp_lt_i32 s75, 0
    s_cbranch_scc1 L_pc160r
    s_max_u32 s6, s6, 1104
    v_max_u32 v9, 69, v9
    ds_write_b32 v6, v9
    ds_read_b32 v8, v7
    s_waitcnt lgkmcnt(0)
    v_cmp_gt_u32 vcc, 69, v8
    s_cbranch_vccnz L_pc160
    s_branch L_pc160r
L_pc164:
    s_sub_i32 s75, s75, 1
    s_cmp_lt_i32 s75, 0
    s_cbranch_scc1 L_pc164r
    s_max_u32 s6, s6, 1040
    v_max_u32 v9, 65, v9
    ds_write_b32 v6, v9
    ds_read_b32 v8, v7
    s_waitcnt lgkmcnt(0)
    v_cmp_gt_u32 vcc, 65, v8
    s_cbranch_vccnz L_pc164
    s_branch L_pc164r
L_pc169:
    s_sub_i32 s75, s75, 1
    s_cmp_lt_i32 s75, 0
    s_cbranch_scc1 L_pc169r
    s_max_u32 s6, s6, 1072
    v_max_u32 v9, 67, v9
    ds_write_b32 v6, v9
    ds_read_b32 v8, v7
    s_waitcnt lgkmcnt(0)
    v_cmp_gt_u32 vcc, 67, v8
    s_cbranch_vccnz L_pc169
    s_branch L_pc169r
L_pc172:
    s_sub_i32 s75, s75, 1
    s_cmp_lt_i32 s75, 0
    s_cbranch_scc1 L_pc172r
    s_max_u32 s6, s6, 1152
    v_max_u32 v9, 72, v9
    ds_write_b32 v6, v9
    ds_read_b32 v8, v7
    s_waitcnt lgkmcnt(0)
    v_cmp_gt_u32 vcc, 72, v8
    s_cbranch_vccnz L_pc172
    s_branch L_pc172r
L_pc175:
    s_sub_i32 s75, s75, 1
    s_cmp_lt_i32 s75, 0
    s_cbranch_scc1 L_pc175r
    s_max_u32 s6, s6, 1088
    v_max_u32 v9, 68, v9
    ds_write_b32 v6, v9
    ds_read_b32 v8, v7
    s_waitcnt lgkmcnt(0)
    v_cmp_gt_u32 vcc, 68, v8
    s_cbranch_vccnz L_pc175
    s_branch L_pc175r
L_pc180:
    s_sub_i32 s75, s75, 1
    s_cmp_lt_i32 s75, 0
    s_cbranch_scc1 L_pc180r
    s_max_u32 s6, s6, 1120
    v_max_u32 v9, 70, v9
    ds_write_b32 v6, v9
    ds_read_b32 v8, v7
    s_waitcnt lgkmcnt(0)
    v_cmp_gt_u32 vcc, 70, v8
    s_cbranch_vccnz L_pc180
    s_branch L_pc180r
L_pc185:
    s_sub_i32 s75, s75, 1
    s_cmp_lt_i32 s75, 0
    s_cbranch_scc1 L_pc185r
    s_max_u32 s6, s6, 1136
    v_max_u32 v9, 71, v9
    ds_write_b32 v6, v9
    ds_read_b32 v8, v7
    s_waitcnt lgkmcnt(0)
    v_cmp_gt_u32 vcc, 71, v8
    s_cbranch_vccnz L_pc185
    s_branch L_pc185r
L_pc186:
    s_sub_i32 s75, s75, 1
    s_cmp_lt_i32 s75, 0
    s_cbranch_scc1 L_pc186r
    s_max_u32 s6, s6, 1200
    v_max_u32 v9, 75, v9
    ds_write_b32 v6, v9
    ds_read_b32 v8, v7
    s_waitcnt lgkmcnt(0)
    v_cmp_gt_u32 vcc, 75, v8
    s_cbranch_vccnz L_pc186
    s_branch L_pc186r
L_pc191:
    s_sub_i32 s75, s75, 1
    s_cmp_lt_i32 s75, 0
    s_cbranch_scc1 L_pc191r
    s_max_u32 s6, s6, 1168
    v_max_u32 v9, 73, v9
    ds_write_b32 v6, v9
    ds_read_b32 v8, v7
    s_waitcnt lgkmcnt(0)
    v_cmp_gt_u32 vcc, 73, v8
    s_cbranch_vccnz L_pc191
    s_branch L_pc191r
L_pc196:
    s_sub_i32 s75, s75, 1
    s_cmp_lt_i32 s75, 0
    s_cbranch_scc1 L_pc196r
    s_max_u32 s6, s6, 1184
    v_max_u32 v9, 74, v9
    ds_write_b32 v6, v9
    ds_read_b32 v8, v7
    s_waitcnt lgkmcnt(0)
    v_cmp_gt_u32 vcc, 74, v8
    s_cbranch_vccnz L_pc196
    s_branch L_pc196r
L_pc201:
    s_sub_i32 s75, s75, 1
    s_cmp_lt_i32 s75, 0
    s_cbranch_scc1 L_pc201r
    s_max_u32 s6, s6, 1216
    v_max_u32 v9, 76, v9
    ds_write_b32 v6, v9
    ds_read_b32 v8, v7
    s_waitcnt lgkmcnt(0)
    v_cmp_gt_u32 vcc, 76, v8
    s_cbranch_vccnz L_pc201
    s_branch L_pc201r
L_pc206:
    s_sub_i32 s75, s75, 1
    s_cmp_lt_i32 s75, 0
    s_cbranch_scc1 L_pc206r
    s_max_u32 s6, s6, 1264
    v_max_u32 v9, 79, v9
    ds_write_b32 v6, v9
    ds_read_b32 v8, v7
    s_waitcnt lgkmcnt(0)
    v_cmp_gt_u32 vcc, 79, v8
    s_cbranch_vccnz L_pc206
    s_branch L_pc206r
L_pc211:
    s_sub_i32 s75, s75, 1
    s_cmp_lt_i32 s75, 0
    s_cbranch_scc1 L_pc211r
    s_max_u32 s6, s6, 1280
    v_max_u32 v9, 80, v9
    ds_write_b32 v6, v9
    ds_read_b32 v8, v7
    s_waitcnt lgkmcnt(0)
    v_cmp_gt_u32 vcc, 80, v8
    s_cbranch_vccnz L_pc211
    s_branch L_pc211r
L_pc212:
    s_sub_i32 s75, s75, 1
    s_cmp_lt_i32 s75, 0
    s_cbranch_scc1 L_pc212r
    s_max_u32 s6, s6, 1248
    v_max_u32 v9, 78, v9
    ds_write_b32 v6, v9
    ds_read_b32 v8, v7
    s_waitcnt lgkmcnt(0)
    v_cmp_gt_u32 vcc, 78, v8
    s_cbranch_vccnz L_pc212
    s_branch L_pc212r
L_pc217:
    s_sub_i32 s75, s75, 1
    s_cmp_lt_i32 s75, 0
    s_cbranch_scc1 L_pc217r
    s_max_u32 s6, s6, 1296
    v_max_u32 v9, 81, v9
    ds_write_b32 v6, v9
    ds_read_b32 v8, v7
    s_waitcnt lgkmcnt(0)
    v_cmp_gt_u32 vcc, 81, v8
    s_cbranch_vccnz L_pc217
    s_branch L_pc217r
L_pc222:
    s_sub_i32 s75, s75, 1
    s_cmp_lt_i32 s75, 0
    s_cbranch_scc1 L_pc222r
    s_max_u32 s6, s6, 1312
    v_max_u32 v9, 82, v9
    ds_write_b32 v6, v9
    ds_read_b32 v8, v7
    s_waitcnt lgkmcnt(0)
    v_cmp_gt_u32 vcc, 82, v8
    s_cbranch_vccnz L_pc222
    s_branch L_pc222r
L_pc227:
    s_sub_i32 s75, s75, 1
    s_cmp_lt_i32 s75, 0
    s_cbranch_scc1 L_pc227r
    ds_read_b32 v8, v7
    s_waitcnt lgkmcnt(0)
    v_cmp_gt_u32 vcc, 83, v8
    s_cbranch_vccnz L_pc227
    s_branch L_pc227r
L_pc228:
    s_sub_i32 s75, s75, 1
    s_cmp_lt_i32 s75, 0
    s_cbranch_scc1 L_pc228r
    ds_read_b32 v8, v7
    s_waitcnt lgkmcnt(0)
    v_cmp_gt_u32 vcc, 84, v8
    s_cbranch_vccnz L_pc228
    s_branch L_pc228r
L_pc229:
    s_sub_i32 s75, s75, 1
    s_cmp_lt_i32 s75, 0
    s_cbranch_scc1 L_pc229r
    ds_read_b32 v8, v7
    s_waitcnt lgkmcnt(0)
    v_cmp_gt_u32 vcc, 85, v8
    s_cbranch_vccnz L_pc229
    s_branch L_pc229r
L_pc230:
    s_sub_i32 s75, s75, 1
    s_cmp_lt_i32 s75, 0
    s_cbranch_scc1 L_pc230r
    ds_read_b32 v8, v7
    s_waitcnt lgkmcnt(0)
    v_cmp_gt_u32 vcc, 86, v8
    s_cbranch_vccnz L_pc230
    s_branch L_pc230r
L_pc231:
    s_sub_i32 s75, s75, 1
    s_cmp_lt_i32 s75, 0
    s_cbranch_scc1 L_pc231r
    ds_read_b32 v8, v7
    s_waitcnt lgkmcnt(0)
    v_cmp_gt_u32 vcc, 90, v8
    s_cbranch_vccnz L_pc231
    s_branch L_pc231r
L_poll0b:
    s_sub_i32 s75, s75, 1
    s_cmp_lt_i32 s75, 0
    s_cbranch_scc1 L_poll0r
    buffer_load_dwordx2 v[58:59], v53, s[52:55], s83 offen sc1
    s_waitcnt vmcnt(0)
    s_branch L_poll0
L_pc232:
    s_sub_i32 s75, s75, 1
    s_cmp_lt_i32 s75, 0
    s_cbranch_scc1 L_pc232r
    ds_read_b32 v8, v7
    s_waitcnt lgkmcnt(0)
    v_cmp_gt_u32 vcc, s67, v8
    s_cbranch_vccnz L_pc232
    s_branch L_pc232r
L_pc233:
    s_sub_i32 s75, s75, 1
    s_cmp_lt_i32 s75, 0
    s_cbranch_scc1 L_pc233r
    ds_read_b32 v8, v7
    s_waitcnt lgkmcnt(0)
    v_cmp_gt_u32 vcc, 89, v8
    s_cbranch_vccnz L_pc233
    s_branch L_pc233r
L_sp234:
    s_sub_i32 s75, s75, 1
    s_cmp_lt_i32 s75, 0
    s_cbranch_scc1 L_sp234r
    ds_read_b32 v9, v6
    s_waitcnt lgkmcnt(0)
    v_cmp_gt_u32 vcc, v9, v8
    s_cbranch_vccz L_sp234
    s_branch L_sp234r
L_sp235:
    s_sub_i32 s75, s75, 1
    s_cmp_lt_i32 s75, 0
    s_cbranch_scc1 L_sp235r
    ds_read_b32 v9, v6
    s_waitcnt lgkmcnt(0)
    v_cmp_gt_u32 vcc, v9, v8
    s_cbranch_vccz L_sp235
    s_branch L_sp235r
L_sp236:
    s_sub_i32 s75, s75, 1
    s_cmp_lt_i32 s75, 0
    s_cbranch_scc1 L_sp236r
    ds_read_b32 v9, v6
    s_waitcnt lgkmcnt(0)
    v_cmp_gt_u32 vcc, v9, v8
    s_cbranch_vccz L_sp236
    s_branch L_sp236r
L_sp237:
    s_sub_i32 s75, s75, 1
    s_cmp_lt_i32 s75, 0
    s_cbranch_scc1 L_sp237r
    ds_read_b32 v9, v6
    s_waitcnt lgkmcnt(0)
    v_cmp_gt_u32 vcc, v9, v8
    s_cbranch_vccz L_sp237
    s_branch L_sp237r
L_sp238:
    s_sub_i32 s75, s75, 1
    s_cmp_lt_i32 s75, 0
    s_cbranch_scc1 L_sp238r
    ds_read_b32 v9, v6
    s_waitcnt lgkmcnt(0)
    v_cmp_gt_u32 vcc, v9, v8
    s_cbranch_vccz L_sp238
    s_branch L_sp238r
L_sp239:
    s_sub_i32 s75, s75, 1
    s_cmp_lt_i32 s75, 0
    s_cbranch_scc1 L_sp239r
    ds_read_b32 v9, v6
    s_waitcnt lgkmcnt(0)
    v_cmp_gt_u32 vcc, v9, v8
    s_cbranch_vccz L_sp239
    s_branch L_sp239r
L_sp240:
    s_sub_i32 s75, s75, 1
    s_cmp_lt_i32 s75, 0
    s_cbranch_scc1 L_sp240r
    ds_read_b32 v9, v6
    s_waitcnt lgkmcnt(0)
    v_cmp_gt_u32 vcc, v9, v8
    s_cbranch_vccz L_sp240
    s_branch L_sp240r
L_sp241:
    s_sub_i32 s75, s75, 1
    s_cmp_lt_i32 s75, 0
    s_cbranch_scc1 L_sp241r
    ds_read_b32 v9, v6
    s_waitcnt lgkmcnt(0)
    v_cmp_gt_u32 vcc, v9, v8
    s_cbranch_vccz L_sp241
    s_branch L_sp241r
L_sp242:
    s_sub_i32 s75, s75, 1
    s_cmp_lt_i32 s75, 0
    s_cbranch_scc1 L_sp242r
    ds_read_b32 v9, v6
    s_waitcnt lgkmcnt(0)
    v_cmp_gt_u32 vcc, v9, v8
    s_cbranch_vccz L_sp242
    s_branch L_sp242r
L_sp243:
    s_sub_i32 s75, s75, 1
    s_cmp_lt_i32 s75, 0
    s_cbranch_scc1 L_sp243r
    ds_read_b32 v9, v6
    s_waitcnt lgkmcnt(0)
    v_cmp_gt_u32 vcc, v9, v8
    s_cbranch_vccz L_sp243
    s_branch L_sp243r
L_sp244:
    s_sub_i32 s75, s75, 1
    s_cmp_lt_i32 s75, 0
    s_cbranch_scc1 L_sp244r
    ds_read_b32 v9, v6
    s_waitcnt lgkmcnt(0)
    v_cmp_gt_u32 vcc, v9, v8
    s_cbranch_vccz L_sp244
    s_branch L_sp244r
L_sp245:
    s_sub_i32 s75, s75, 1
    s_cmp_lt_i32 s75, 0
    s_cbranch_scc1 L_sp245r
    ds_read_b32 v9, v6
    s_waitcnt lgkmcnt(0)
    v_cmp_gt_u32 vcc, v9, v8
    s_cbranch_vccz L_sp245
    s_branch L_sp245r
L_sp246:
    s_sub_i32 s75, s75, 1
    s_cmp_lt_i32 s75, 0
    s_cbranch_scc1 L_sp246r
    ds_read_b32 v9, v6
    s_waitcnt lgkmcnt(0)
    v_cmp_gt_u32 vcc, v9, v8
    s_cbranch_vccz L_sp246
    s_branch L_sp246r
L_sp247:
    s_sub_i32 s75, s75, 1
    s_cmp_lt_i32 s75, 0
    s_cbranch_scc1 L_sp247r
    ds_read_b32 v9, v6
    s_waitcnt lgkmcnt(0)
    v_cmp_gt_u32 vcc, v9, v8
    s_cbranch_vccz L_sp247
    s_branch L_sp247r
L_sp248:
    s_sub_i32 s75, s75, 1
    s_cmp_lt_i32 s75, 0
    s_cbranch_scc1 L_sp248r
    ds_read_b32 v9, v6
    s_waitcnt lgkmcnt(0)
    v_cmp_gt_u32 vcc, v9, v8
    s_cbranch_vccz L_sp248
    s_branch L_sp248r
L_sp249:
    s_sub_i32 s75, s75, 1
    s_cmp_lt_i32 s75, 0
    s_cbranch_scc1 L_sp249r
    ds_read_b32 v9, v6
    s_waitcnt lgkmcnt(0)
    v_cmp_gt_u32 vcc, v9, v8
    s_cbranch_vccz L_sp249
    s_branch L_sp249r
L_sp250:
    s_sub_i32 s75, s75, 1
    s_cmp_lt_i32 s75, 0
    s_cbranch_scc1 L_sp250r
    ds_read_b32 v9, v6
    s_waitcnt lgkmcnt(0)
    v_cmp_gt_u32 vcc, v9, v8
    s_cbranch_vccz L_sp250
    s_branch L_sp250r
L_sp251:
    s_sub_i32 s75, s75, 1
    s_cmp_lt_i32 s75, 0
    s_cbranch_scc1 L_sp251r
    ds_read_b32 v9, v6
    s_waitcnt lgkmcnt(0)
    v_cmp_gt_u32 vcc, v9, v8
    s_cbranch_vccz L_sp251
    s_branch L_sp251r
L_sp252:
    s_sub_i32 s75, s75, 1
    s_cmp_lt_i32 s75, 0
    s_cbranch_scc1 L_sp252r
    ds_read_b32 v9, v6
    s_waitcnt lgkmcnt(0)
    v_cmp_gt_u32 vcc, v9, v8
    s_cbranch_vccz L_sp252
    s_branch L_sp252r
L_init:
    v_mov_b32 v4, 0
    s_cmp_lg_u32 s68, 0
    s_cbranch_scc1 L_pub0
    s_bitcmp1_b32 s74, 5
    s_cbranch_scc1 L_init2
    s_add_u32 s74, s74, 33
    buffer_load_dwordx2 v[2:3], v4, s[40:43], 0 offen sc1
    s_branch L_initr
L_init2:
    s_mov_b32 s74, 64
    v_lshlrev_b32 v59, 7, v1
    s_mov_b32 s60, 2097152
    buffer_store_dword v4, v59, s[52:55], s60 offen sc1
    s_waitcnt vmcnt(0)
    v_add_u32 v2, 1, v2
    v_or_b32 v3, 1, v3
    s_mov_b64 exec, 1
    buffer_store_dwordx2 v[2:3], v4, s[40:43], 0 offen sc1
    buffer_store_dwordx2 v[2:3], v4, s[56:59], 0 offen sc1
    s_mov_b64 exec, -1
    s_branch L_initr
L_pub0:
    v_add_u32 v250, s66, v252
    v_add_u32 v251, s66, v253
    s_waitcnt lgkmcnt(0)
L_wsp:
    v_cmp_gt_u32 vcc, v9, v8
    s_cbranch_vccnz L_wa
    s_sub_i32 s75, s75, 1
    s_cmp_lt_i32 s75, 0
    s_cbranch_scc1 L_wa
    ds_read_b32 v9, v6
    s_waitcnt lgkmcnt(0)
    s_branch L_wsp
L_wa:
    s_cmp_lg_u32 s74, 4
    s_cbranch_scc1 L_wa1
    s_cmp_lg_u32 s3, 0
    s_cbranch_scc1 L_wak0
    s_mov_b64 exec, 1
    s_and_b32 s60, s78, 7
    s_lshl_b32 s60, s60, 10
    s_add_u32 s60, s60, 2097152
    v_mov_b32 v2, 8
    buffer_atomic_add v2, v4, s[52:55], s60 offen offset:0 sc0 sc1
    s_mov_b64 exec, -1
L_wak0:
    ds_read_b64_tr_b16 a[128:129], v250 offset:0
    ds_read_b64_tr_b16 a[130:131], v251 offset:0
    ds_read_b64_tr_b16 a[132:133], v250 offset:8
    ds_read_b64_tr_b16 a[134:135], v251 offset:8
    ds_read_b64_tr_b16 a[136:137], v250 offset:8192
    ds_read_b64_tr_b16 a[138:139], v251 offset:8192
    ds_read_b64_tr_b16 a[140:141], v250 offset:8200
    ds_read_b64_tr_b16 a[142:143], v251 offset:8200
    s_mov_b32 s74, 5
    s_branch L_wax
L_wa1:
    s_cmp_lg_u32 s74, 5
    s_cbranch_scc1 L_wa2
    s_cmp_lg_u32 s3, 1
    s_cbranch_scc1 L_wak1
    s_mov_b64 exec, 1
    s_and_b32 s60, s78, 7
    s_lshl_b32 s60, s60, 10
    s_add_u32 s60, s60, 2097152
    v_mov_b32 v2, 8
    buffer_atomic_add v2, v4, s[52:55], s60 offen offset:128 sc0 sc1
    s_mov_b64 exec, -1
L_wak1:
    ds_read_b64_tr_b16 a[144:145], v250 offset:0
    ds_read_b64_tr_b16 a[146:147], v251 offset:0
    ds_read_b64_tr_b16 a[148:149], v250 offset:8
    ds_read_b64_tr_b16 a[150:151], v251 offset:8
    ds_read_b64_tr_b16 a[152:153], v250 offset:8192
    ds_read_b64_tr_b16 a[154:155], v251 offset:8192
    ds_read_b64_tr_b16 a[156:157], v250 offset:8200
    ds_read_b64_tr_b16 a[158:159], v251 offset:8200
    s_mov_b32 s74, 6
    s_branch L_wax
L_wa2:
    s_cmp_lg_u32 s74, 6
    s_cbranch_scc1 L_wa3
    s_cmp_lg_u32 s3, 0
    s_cbranch_scc1 L_wak2
    s_mov_b64 exec, 1
    v_mov_b32 v3, 163648
    s_waitcnt vmcnt(0)
    ds_write_b32 v3, v2
    s_and_b32 s60, s78, 7
    s_lshl_b32 s60, s60, 10
    s_add_u32 s60, s60, 2097152
    v_mov_b32 v2, 8
    buffer_atomic_add v2, v4, s[52:55], s60 offen offset:256 sc0 sc1
    s_mov_b64 exec, -1
L_wak2:
    ds_read_b64_tr_b16 a[160:161], v250 offset:0
    ds_read_b64_tr_b16 a[162:163], v251 offset:0
    ds_read_b64_tr_b16 a[164:165], v250 offset:8
    ds_read_b64_tr_b16 a[166:167], v251 offset:8
    ds_read_b64_tr_b16 a[168:169], v250 offset:8192
    ds_read_b64_tr_b16 a[170:171], v251 offset:8192
    ds_read_b64_tr_b16 a[172:173], v250 offset:8200
    ds_read_b64_tr_b16 a[174:175], v251 offset:8200
    s_mov_b32 s74, 8
    s_branch L_wax
L_wa3:
    s_cmp_lg_u32 s74, 8
    s_cbranch_scc1 L_wa4
    s_cmp_lg_u32 s3, 1
    s_cbranch_scc1 L_wak3
    s_mov_b64 exec, 1
    v_mov_b32 v3, 163648
    s_waitcnt vmcnt(0)
    ds_write_b32 v3, v2
    s_and_b32 s60, s78, 7
    s_lshl_b32 s60, s60, 10
    s_add_u32 s60, s60, 2097152
    v_mov_b32 v2, 8
    buffer_atomic_add v2, v4, s[52:55], s60 offen offset:384 sc0 sc1
    s_mov_b64 exec, -1
L_wak3:
    ds_read_b64_tr_b16 a[176:177], v250 offset:0
    ds_read_b64_tr_b16 a[178:179], v251 offset:0
    ds_read_b64_tr_b16 a[180:181], v250 offset:8
    ds_read_b64_tr_b16 a[182:183], v251 offset:8
    ds_read_b64_tr_b16 a[184:185], v250 offset:8192
    ds_read_b64_tr_b16 a[186:187], v251 offset:8192
    ds_read_b64_tr_b16 a[188:189], v250 offset:8200
    ds_read_b64_tr_b16 a[190:191], v251 offset:8200
    s_mov_b32 s74, 9
    s_branch L_wax
L_wa4:
    s_cmp_lg_u32 s74, 9
    s_cbranch_scc1 L_wa5
    s_cmp_lg_u32 s3, 0
    s_cbranch_scc1 L_wak4
    s_mov_b64 exec, 1
    v_mov_b32 v3, 163648
    s_waitcnt vmcnt(0)
    ds_write_b32 v3, v2
    s_and_b32 s60, s78, 7
    s_lshl_b32 s60, s60, 10
    s_add_u32 s60, s60, 2097152
    v_mov_b32 v2, 8
    buffer_atomic_add v2, v4, s[52:55], s60 offen offset:512 sc0 sc1
    s_mov_b64 exec, -1
L_wak4:
    ds_read_b64_tr_b16 a[192:193], v250 offset:0
    ds_read_b64_tr_b16 a[194:195], v251 offset:0
    ds_read_b64_tr_b16 a[196:197], v250 offset:8
    ds_read_b64_tr_b16 a[198:199], v251 offset:8
    ds_read_b64_tr_b16 a[200:201], v250 offset:8192
    ds_read_b64_tr_b16 a[202:203], v251 offset:8192
    ds_read_b64_tr_b16 a[204:205], v250 offset:8200
    ds_read_b64_tr_b16 a[206:207], v251 offset:8200
    s_mov_b32 s74, 10
    s_branch L_wax
L_wa5:
    s_cmp_lg_u32 s74, 10
    s_cbranch_scc1 L_wa6
    s_cmp_lg_u32 s3, 1
    s_cbranch_scc1 L_wak5
    s_mov_b64 exec, 1
    v_mov_b32 v3, 163648
    s_waitcnt vmcnt(0)
    ds_write_b32 v3, v2
    s_and_b32 s60, s78, 7
    s_lshl_b32 s60, s60, 10
    s_add_u32 s60, s60, 2097152
    v_mov_b32 v2, 8
    buffer_atomic_add v2, v4, s[52:55], s60 offen offset:640 sc0 sc1
    s_mov_b64 exec, -1
L_wak5:
    ds_read_b64_tr_b16 a[208:209], v250 offset:0
    ds_read_b64_tr_b16 a[210:211], v251 offset:0
    ds_read_b64_tr_b16 a[212:213], v250 offset:8
    ds_read_b64_tr_b16 a[214:215], v251 offset:8
    ds_read_b64_tr_b16 a[216:217], v250 offset:8192
    ds_read_b64_tr_b16 a[218:219], v251 offset:8192
    ds_read_b64_tr_b16 a[220:221], v250 offset:8200
    ds_read_b64_tr_b16 a[222:223], v251 offset:8200
    s_mov_b32 s74, 11
    s_branch L_wax
L_wa6:
    s_cmp_lg_u32 s74, 11
    s_cbranch_scc1 L_wa7
    s_cmp_lg_u32 s3, 0
    s_cbranch_scc1 L_wak6
    s_mov_b64 exec, 1
    v_mov_b32 v3, 163648
    s_waitcnt vmcnt(0)
    ds_write_b32 v3, v2
    s_mov_b64 exec, -1
L_wak6:
    ds_read_b64_tr_b16 a[224:225], v250 offset:0
    ds_read_b64_tr_b16 a[226:227], v251 offset:0
    ds_read_b64_tr_b16 a[228:229], v250 offset:8
    ds_read_b64_tr_b16 a[230:231], v251 offset:8
    ds_read_b64_tr_b16 a[232:233], v250 offset:8192
    ds_read_b64_tr_b16 a[234:235], v251 offset:8192
    ds_read_b64_tr_b16 a[236:237], v250 offset:8200
    ds_read_b64_tr_b16 a[238:239], v251 offset:8200
    s_mov_b32 s74, 12
    s_mov_b32 s100, 114688
    s_branch L_wax
L_wa7:
    s_cmp_lg_u32 s3, 1
    s_cbranch_scc1 L_wak7
    s_mov_b64 exec, 1
    v_mov_b32 v3, 163648
    s_waitcnt vmcnt(0)
    ds_write_b32 v3, v2
    s_mov_b64 exec, -1
L_wak7:
    ds_read_b64_tr_b16 a[240:241], v250 offset:0
    ds_read_b64_tr_b16 a[242:243], v251 offset:0
    ds_read_b64_tr_b16 a[244:245], v250 offset:8
    ds_read_b64_tr_b16 a[246:247], v251 offset:8
    ds_read_b64_tr_b16 a[248:249], v250 offset:8192
    ds_read_b64_tr_b16 a[250:251], v251 offset:8192
    ds_read_b64_tr_b16 a[252:253], v250 offset:8200
    ds_read_b64_tr_b16 a[254:255], v251 offset:8200
    s_mov_b32 s74, 64
L_wax:
    v_add_u32 v8, 1, v8
    ds_write_b32 v7, v8
    s_add_u32 s66, s66, 16384
    s_cmp_eq_u32 s66, s100
    s_cselect_b32 s66, 0, s66
    v_add_u32 v10, s66, v13
    v_add_u32 v11, s66, v14
    v_add_u32 v12, s66, v15
    ds_read_b32 v9, v6
    s_branch L_initr
L_sp253:
    s_sub_i32 s75, s75, 1
    s_cmp_lt_i32 s75, 0
    s_cbranch_scc1 L_sp253r
    ds_read_b32 v9, v6
    s_waitcnt lgkmcnt(0)
    v_cmp_gt_u32 vcc, v9, v8
    s_cbranch_vccz L_sp253
    s_branch L_sp253r
L_sp254:
    s_sub_i32 s75, s75, 1
    s_cmp_lt_i32 s75, 0
    s_cbranch_scc1 L_sp254r
    ds_read_b32 v9, v6
    s_waitcnt lgkmcnt(0)
    v_cmp_gt_u32 vcc, v9, v8
    s_cbranch_vccz L_sp254
    s_branch L_sp254r
L_sp255:
    s_sub_i32 s75, s75, 1
    s_cmp_lt_i32 s75, 0
    s_cbranch_scc1 L_sp255r
    ds_read_b32 v9, v6
    s_waitcnt lgkmcnt(0)
    v_cmp_gt_u32 vcc, v9, v8
    s_cbranch_vccz L_sp255
    s_branch L_sp255r
L_sp256:
    s_sub_i32 s75, s75, 1
    s_cmp_lt_i32 s75, 0
    s_cbranch_scc1 L_sp256r
    ds_read_b32 v9, v6
    s_waitcnt lgkmcnt(0)
    v_cmp_gt_u32 vcc, v9, v8
    s_cbranch_vccz L_sp256
    s_branch L_sp256r
L_sp257:
    s_sub_i32 s75, s75, 1
    s_cmp_lt_i32 s75, 0
    s_cbranch_scc1 L_sp257r
    ds_read_b32 v9, v6
    s_waitcnt lgkmcnt(0)
    v_cmp_gt_u32 vcc, v9, v8
    s_cbranch_vccz L_sp257
    s_branch L_sp257r
L_sp258:
    s_sub_i32 s75, s75, 1
    s_cmp_lt_i32 s75, 0
    s_cbranch_scc1 L_sp258r
    ds_read_b32 v9, v6
    s_waitcnt lgkmcnt(0)
    v_cmp_gt_u32 vcc, v9, v8
    s_cbranch_vccz L_sp258
    s_branch L_sp258r
L_sp259:
    s_sub_i32 s75, s75, 1
    s_cmp_lt_i32 s75, 0
    s_cbranch_scc1 L_sp259r
    ds_read_b32 v9, v6
    s_waitcnt lgkmcnt(0)
    v_cmp_gt_u32 vcc, v9, v8
    s_cbranch_vccz L_sp259
    s_branch L_sp259r
L_p1b:
    s_sub_i32 s75, s75, 1
    s_cmp_lt_i32 s75, 0
    s_cbranch_scc1 L_p1ok
    buffer_load_dwordx2 v[2:3], v232, s[52:55], s68 offen offset:2048 sc1
    s_waitcnt vmcnt(0)
    s_branch L_p1
L_get:
    s_add_u32 s60, s71, 0
    s_or_b32 s61, s60, s63
    buffer_load_dwordx4 v[112:115], v5, s[44:47], s60 offen offset:0 sc1
    buffer_load_dwordx4 v[116:119], v5, s[44:47], s60 offen offset:1024 sc1
    buffer_load_dwordx4 v[120:123], v5, s[44:47], s60 offen offset:2048 sc1
    buffer_load_dwordx4 v[124:127], v5, s[44:47], s61 offen offset:3072 sc1
    s_add_u32 s60, s71, 16384
    s_or_b32 s61, s60, s63
    buffer_load_dwordx4 v[128:131], v5, s[44:47], s60 offen offset:0 sc1
    buffer_load_dwordx4 v[132:135], v5, s[44:47], s60 offen offset:1024 sc1
    buffer_load_dwordx4 v[136:139], v5, s[44:47], s60 offen offset:2048 sc1
    buffer_load_dwordx4 v[140:143], v5, s[44:47], s61 offen offset:3072 sc1
    s_add_u32 s60, s71, 32768
    s_or_b32 s61, s60, s63
    buffer_load_dwordx4 v[144:147], v5, s[44:47], s60 offen offset:0 sc1
    buffer_load_dwordx4 v[148:151], v5, s[44:47], s60 offen offset:1024 sc1
    buffer_load_dwordx4 v[152:155], v5, s[44:47], s60 offen offset:2048 sc1
    buffer_load_dwordx4 v[156:159], v5, s[44:47], s61 offen offset:3072 sc1
    s_branch L_got
L_poll2b:
    s_sub_i32 s75, s75, 1
    s_cmp_lt_i32 s75, 0
    s_cbranch_scc1 L_poll2r
    buffer_load_dword v2, v10, s[44:47], s71 offen sc1
    s_branch L_poll2
L_re0:
    s_sub_i32 s75, s75, 1
    s_cmp_lt_i32 s75, 0
    s_cbranch_scc1 L_ok0r
    s_add_u32 s60, s71, 0
    s_or_b32 s61, s60, s63
    buffer_load_dwordx4 v[112:115], v5, s[44:47], s60 offen offset:0 sc1
    buffer_load_dwordx4 v[116:119], v5, s[44:47], s60 offen offset:1024 sc1
    buffer_load_dwordx4 v[120:123], v5, s[44:47], s60 offen offset:2048 sc1
    buffer_load_dwordx4 v[124:127], v5, s[44:47], s61 offen offset:3072 sc1
    s_waitcnt vmcnt(0)
    s_branch L_ck0
L_re1:
    s_sub_i32 s75, s75, 1
    s_cmp_lt_i32 s75, 0
    s_cbranch_scc1 L_ok1r
    s_add_u32 s60, s71, 16384
    s_or_b32 s61, s60, s63
    buffer_load_dwordx4 v[128:131], v5, s[44:47], s60 offen offset:0 sc1
    buffer_load_dwordx4 v[132:135], v5, s[44:47], s60 offen offset:1024 sc1
    buffer_load_dwordx4 v[136:139], v5, s[44:47], s60 offen offset:2048 sc1
    buffer_load_dwordx4 v[140:143], v5, s[44:47], s61 offen offset:3072 sc1
    s_waitcnt vmcnt(0)
    s_branch L_ck1
L_re2:
    s_sub_i32 s75, s75, 1
    s_cmp_lt_i32 s75, 0
    s_cbranch_scc1 L_ok2r
    s_add_u32 s60, s71, 32768
    s_or_b32 s61, s60, s63
    buffer_load_dwordx4 v[144:147], v5, s[44:47], s60 offen offset:0 sc1
    buffer_load_dwordx4 v[148:151], v5, s[44:47], s60 offen offset:1024 sc1
    buffer_load_dwordx4 v[152:155], v5, s[44:47], s60 offen offset:2048 sc1
    buffer_load_dwordx4 v[156:159], v5, s[44:47], s61 offen offset:3072 sc1
    s_waitcnt vmcnt(0)
    s_branch L_ck2
L_end:
    s_endpgm
.section .rodata,"a"
.p2align 6
.amdhsa_kernel standalone__gqa_block_cached__near_ridge_kernel
  .amdhsa_next_free_vgpr 512
  .amdhsa_next_free_sgpr 102
  .amdhsa_accum_offset 256
  .amdhsa_group_segment_fixed_size 0
  .amdhsa_kernarg_size 64
  .amdhsa_user_sgpr_count 2
  .amdhsa_user_sgpr_kernarg_segment_ptr 1
  .amdhsa_system_sgpr_workgroup_id_x 1
.end_amdhsa_kernel
```
